```python
import torch

def _softmax(x, axis=-1):
    return torch.softmax(x, dim=axis)
def _gelu(x):
    return torch.nn.functional.gelu(x, approximate="tanh")
def _silu(x):
    return torch.nn.functional.silu(x)
def _sigmoid(x):
    return torch.sigmoid(x)
def _layernorm(x, axis=-1, eps=1e-5):
    m = x.mean(dim=axis, keepdim=True)
    v = x.var(dim=axis, keepdim=True, unbiased=False)
    return (x - m) / torch.sqrt(v + eps)
def _scatter_add(tgt, idx, src, axis=0):
    return tgt.clone().index_add_(axis, idx, src)
def _segment_sum(src, seg, n):
    out = torch.zeros((n,) + src.shape[1:], dtype=src.dtype)
    return out.index_add_(0, seg, src)
def _pad(x, pw):
    flat = tuple(v for pair in reversed(pw) for v in pair)
    return torch.nn.functional.pad(x, flat)

kernel_name = 'parallel_sum__ssm_conv_s5__dense_activation_relu__prompt'

def setup_inputs():

    _w = (lambda a: (lambda t: t.to(torch.bfloat16) if t.is_floating_point() else t)(torch.as_tensor(a)))
    def _A_setup():
        B, S, D = 1, 2048, 512
        P = D
        Lambda_re = -0.5 * (lambda _x: torch.exp(torch.as_tensor(_x)))((lambda *s: torch.randn(*s, dtype=torch.bfloat16) * 0.8)(P))
        Lambda_im = (lambda *s: torch.randn(*s, dtype=torch.bfloat16) * 0.8)(P) * 1.0
        B_re = (lambda *s: torch.randn(*s, dtype=torch.bfloat16) * 0.8)(P, D) * (D ** -0.5)
        B_im = (lambda *s: torch.randn(*s, dtype=torch.bfloat16) * 0.8)(P, D) * (D ** -0.5)
        C_re = (lambda *s: torch.randn(*s, dtype=torch.bfloat16) * 0.8)(D, P) * (P ** -0.5)
        C_im = (lambda *s: torch.randn(*s, dtype=torch.bfloat16) * 0.8)(D, P) * (P ** -0.5)
        log_dt = (lambda *s: torch.randn(*s, dtype=torch.bfloat16) * 0.8)(P) * 0.3 - 2.0
        Dskip = (lambda *s: torch.randn(*s, dtype=torch.bfloat16) * 0.8)(D)
        return {
            "x": _w((lambda *s: torch.randn(*s, dtype=torch.bfloat16) * 0.05)(B, S, D)),
            "Lambda_re": _w(Lambda_re),
            "Lambda_im": _w(Lambda_im),
            "B_re": _w(B_re),
            "B_im": _w(B_im),
            "C_re": _w(C_re),
            "C_im": _w(C_im),
            "log_dt": _w(log_dt),
            "Dskip": _w(Dskip),
        }
    _A_in = _A_setup()

    def _B_setup():
        B, S, D, Dff = 1, 2048, 512, 1792
        return {
            "x": _w((lambda *s: torch.randn(*s, dtype=torch.bfloat16) * 0.05)(B, S, D)),
            "w1": _w((lambda *s: torch.randn(*s, dtype=torch.bfloat16) * 0.05)(D, Dff)),
            "w2": _w((lambda *s: torch.randn(*s, dtype=torch.bfloat16) * 0.05)(Dff, D)),
        }
    _B_in = _B_setup()

    return {
        "A_x": _A_in["x"],
        "A_Lambda_re": _A_in["Lambda_re"],
        "A_Lambda_im": _A_in["Lambda_im"],
        "A_B_re": _A_in["B_re"],
        "A_B_im": _A_in["B_im"],
        "A_C_re": _A_in["C_re"],
        "A_C_im": _A_in["C_im"],
        "A_log_dt": _A_in["log_dt"],
        "A_Dskip": _A_in["Dskip"],
        "B_x": _B_in["x"],
        "B_w1": _B_in["w1"],
        "B_w2": _B_in["w2"],
    }

def reference(A_x, A_Lambda_re, A_Lambda_im, A_B_re, A_B_im, A_C_re, A_C_im, A_log_dt, A_Dskip, B_x, B_w1, B_w2):
    def _A_ref(x, Lambda_re, Lambda_im, B_re, B_im, C_re, C_im, log_dt, Dskip):
        Bsz, L, H = x.shape
        Lam = Lambda_re + 1j * Lambda_im
        Bmat = B_re + 1j * B_im
        Cmat = C_re + 1j * C_im
        dt = torch.exp(log_dt)
        Lam_bar = torch.exp(dt * Lam)
        B_bar = ((Lam_bar - 1.0) / Lam)[:, None] * Bmat
        Bu = torch.einsum("bld,pd->blp", x + 0j, B_bar)
        h = torch.zeros_like(Bu[:, 0, :])
        hs = []
        for t in range(L):
            h = Lam_bar[None, :] * h + Bu[:, t, :]
            hs.append(h)
        hseq = torch.stack(hs, 1)
        y = 2.0 * torch.einsum("blp,dp->bld", hseq, Cmat).real + x * Dskip[None, None, :]
        return y

    def _B_ref(x, w1, w2):
        h = torch.einsum("bsd,df->bsf", x, w1)
        zero = torch.zeros_like(h)
        h = torch.maximum(h, zero)
        return torch.einsum("bsf,fd->bsd", h, w2)

    x = A_x
    xn = _layernorm(x, axis=-1)
    return x + _A_ref(xn, A_Lambda_re, A_Lambda_im, A_B_re, A_B_im, A_C_re, A_C_im, A_log_dt, A_Dskip) + _B_ref(xn, B_w1, B_w2)
```

```asm
; @launch grid=(256,1,1) block=(256,1,1) lds=163840
.amdgcn_target "amdgcn-amd-amdhsa--gfx950"
.text
.globl parallel_sum__ssm_conv_s5__dense_activation_relu__prompt_kernel
.p2align 8
.type parallel_sum__ssm_conv_s5__dense_activation_relu__prompt_kernel,@function
parallel_sum__ssm_conv_s5__dense_activation_relu__prompt_kernel:
  s_cmp_ge_u32 s2, 256
  s_cbranch_scc1 L_end
  s_load_dwordx16 s[40:55], s[0:1], 0
  s_load_dwordx2 s[20:21], s[0:1], 112
  s_load_dwordx8 s[56:63], s[0:1], 64
  s_load_dwordx2 s[64:65], s[0:1], 96
  v_lshrrev_b32 v1, 6, v0
  v_lshlrev_b32 v79, 4, v0
  v_readfirstlane_b32 s3, v1
  v_and_b32 v0, 63, v0
  s_getpc_b64 s[80:81]
  s_add_u32 s6, s80, tbl_v@rel32@lo+4
  s_addc_u32 s7, s81, tbl_v@rel32@hi+12
  s_lshl_b32 s76, s2, 9
  v_lshl_add_u32 v2, v1, 7, s76
  global_load_dword v219, v2, s[6:7]
  s_lshl_b32 s67, s3, 7
  s_add_u32 s67, s67, s76
  s_lshr_b32 s73, s2, 3
  s_and_b32 s80, s80, 0xffffff00
  s_and_b32 s74, s73, 7
  s_lshl_b32 s74, s74, 12
  s_min_u32 s74, s74, (L_end-parallel_sum__ssm_conv_s5__dense_activation_relu__prompt_kernel-4096)&0xfffff0
  s_add_u32 s80, s80, s74
  s_addc_u32 s81, s81, 0
  global_load_dwordx4 v[220:223], v79, s[80:81]
  s_and_b32 s72, s2, 7
  s_lshr_b32 s74, s72, 1
  s_lshl_b32 s74, s74, 2
  s_and_b32 s75, s73, 3
  s_add_u32 s68, s74, s75
  s_and_b32 s74, s72, 1
  s_lshl_b32 s74, s74, 3
  s_lshr_b32 s75, s73, 2
  s_add_u32 s69, s74, s75
  s_lshl_b32 s66, s72, 7
  s_lshr_b32 s70, s3, 1
  s_and_b32 s71, s3, 1
  v_lshrrev_b32 v1, 3, v0
  v_lshrrev_b32 v2, 4, v0
  v_and_b32 v3, 7, v0
  v_xor_b32 v3, v3, v2
  v_lshlrev_b32 v3, 4, v3
  v_lshl_add_u32 v8, v1, 10, v3
  v_xor_b32 v9, 64, v8
  v_add_u32 v9, 7168, v9
  v_add_u32 v10, 14336, v8
  v_add_u32 v11, 14336, v9
  s_lshl_b32 s4, s3, 12
  s_lshl_b32 s74, s3, 11
  s_add_u32 s5, s74, 65536
  s_lshl_b32 s75, s68, 17
  s_lshl_b32 s76, s69, 13
  s_add_u32 s76, s76, s75
  s_add_u32 s76, s76, s74
  v_lshrrev_b32 v6, 5, v0
  v_lshlrev_b32 v4, 5, v6
  v_add_lshl_u32 v4, v4, v0, 4
  v_add_u32 v4, s76, v4
  s_lshl_b32 s77, s69, 6
  s_lshl_b32 s78, s71, 5
  s_add_u32 s77, s77, s78
  v_and_b32 v1, 15, v0
  v_lshl_add_u32 v5, v1, 1, s77
  s_lshl_b32 s77, s3, 15
  s_add_u32 s77, s77, s75
  s_lshl_b32 s75, s69, 15
  s_lshl_b32 s76, s70, 14
  s_add_u32 s75, s75, s76
  s_mov_b32 s10, 32768
  s_mov_b32 s11, 0x20000
  s_mov_b32 s14, 16384
  s_mov_b32 s15, 0x20000
  s_mov_b32 s22, 268435456
  s_mov_b32 s23, 0x20000
  s_mov_b32 s16, 11927552
  s_cmp_eq_u32 s71, 0
  s_waitcnt lgkmcnt(0)
  s_cselect_b64 s[12:13], s[46:47], s[48:49]
  global_load_dwordx4 v[160:163], v4, s[40:41]
  global_load_dwordx4 v[164:167], v4, s[40:41] offset:512
  s_add_u32 s8, s40, s77
  s_addc_u32 s9, s41, 0
  s_add_u32 s12, s12, s75
  s_addc_u32 s13, s13, 0
  s_load_dword s58, s[20:21], s16
  s_load_dwordx16 s[68:83], s[6:7], s67
  s_add_u32 s67, s67, 64
  s_load_dwordx16 s[84:99], s[6:7], s67
  s_add_u32 m0, s4, 0
  s_nop 0
  buffer_load_dwordx4 v8, s[8:11], s66 offen lds
  buffer_load_dwordx4 v9, s[8:11], s66 offen offset:1024 lds
  buffer_load_dwordx4 v10, s[8:11], s66 offen offset:2048 lds
  buffer_load_dwordx4 v11, s[8:11], s66 offen offset:3072 lds
  s_add_u32 m0, s5, 0
  s_nop 0
  buffer_load_dwordx4 v8, s[12:15], s66 offen lds
  buffer_load_dwordx4 v9, s[12:15], s66 offen offset:1024 lds
  s_add_u32 s66, s66, 128
  s_and_b32 s66, s66, 1023
  global_load_ushort v168, v5, s[42:43]
  global_load_ushort v169, v5, s[44:45]
  global_load_ushort v170, v5, s[54:55]
  s_add_u32 m0, s4, 16384
  s_nop 0
  buffer_load_dwordx4 v8, s[8:11], s66 offen lds
  buffer_load_dwordx4 v9, s[8:11], s66 offen offset:1024 lds
  buffer_load_dwordx4 v10, s[8:11], s66 offen offset:2048 lds
  buffer_load_dwordx4 v11, s[8:11], s66 offen offset:3072 lds
  s_add_u32 m0, s5, 8192
  s_nop 0
  buffer_load_dwordx4 v8, s[12:15], s66 offen lds
  buffer_load_dwordx4 v9, s[12:15], s66 offen offset:1024 lds
  s_add_u32 s66, s66, 128
  s_and_b32 s66, s66, 1023
  s_mov_b32 s42, 0xffff0000
  s_mov_b32 s43, 0x07060302
  s_lshr_b32 s45, s3, 1
  s_and_b32 s67, s3, 1
  v_bfe_u32 v1, v0, 2, 1
  v_and_b32 v2, 3, v0
  v_lshl_add_u32 v1, v1, 4, v2
  v_bfe_u32 v3, v0, 3, 2
  v_lshl_add_u32 v2, v3, 2, v1
  v_bfe_u32 v1, v2, 1, 3
  v_xor_b32 v1, v1, v6
  v_lshlrev_b32 v1, 4, v1
  v_lshl_add_u32 v1, v2, 7, v1
  s_mul_i32 s49, s45, 8224
  v_xor_b32 v48, s49, v1
  s_lshl_b32 s49, s45, 8
  s_add_u32 s49, s49, 147456
  v_lshl_add_u32 v51, v2, 2, s49
  v_and_b32 v2, 31, v0
  v_bfe_u32 v1, v0, 1, 3
  v_xor_b32 v1, v1, v6
  v_lshlrev_b32 v1, 4, v1
  v_lshl_add_u32 v1, v2, 7, v1
  v_add_u32 v56, s4, v1
  s_lshl_b32 s49, s67, 12
  s_lshl_b32 s54, s45, 5
  s_add_u32 s49, s49, s54
  s_add_u32 s49, s49, 65536
  v_xor_b32 v49, s49, v1
  v_lshrrev_b32 v1, 2, v0
  v_xor_b32 v1, v1, v0
  v_bfe_i32 v1, v1, 2, 1
  v_not_b32 v1, v1
  v_and_b32 v50, 0x3f803f80, v1
  v_bfe_u32 v200, v0, 2, 2
  v_bfe_u32 v1, v0, 4, 1
  v_bfe_u32 v2, v0, 1, 1
  v_lshl_add_u32 v201, v1, 1, v2
  v_and_b32 v202, 1, v0
  v_lshl_add_u32 v3, v1, 1, v6
  s_lshl_b32 s49, s45, 2
  v_add_u32 v58, s49, v3
  v_lshl_add_u32 v1, v202, 1, v1
  v_xor_b32 v1, v1, v200
  v_lshlrev_b32 v2, 3, v2
  v_lshl_add_u32 v1, v1, 4, v2
  v_lshl_add_u32 v2, v6, 3, v200
  v_lshl_add_u32 v1, v2, 7, v1
  s_add_u32 s49, s4, 65536
  v_add_u32 v61, s49, v1
  v_lshlrev_b32 v3, 1, v3
  v_and_b32 v1, 7, v0
  v_xor_b32 v3, v3, v1
  v_and_b32 v1, 15, v0
  v_lshl_add_u32 v1, v1, 7, s49
  v_lshl_add_u32 v60, v3, 4, v1
  v_lshlrev_b32 v3, 2, v200
  v_xor_b32 v3, v3, v201
  v_lshlrev_b32 v202, 3, v202
  v_lshl_add_u32 v3, v3, 4, v202
  v_lshl_add_u32 v3, v2, 8, v3
  s_lshl_b32 s49, s45, 12
  s_lshl_b32 s54, s67, 7
  s_add_u32 s49, s49, s54
  s_add_u32 s49, s49, 81920
  v_xor_b32 v53, s49, v3
  v_bfe_u32 v3, v0, 3, 1
  v_xor_b32 v3, s67, v3
  v_lshl_add_u32 v3, v3, 2, v201
  v_lshl_add_u32 v3, v3, 4, v202
  v_lshl_add_u32 v2, v6, 2, v200
  v_lshl_add_u32 v3, v2, 7, v3
  v_add_u32 v55, s4, v3
  v_lshrrev_b32 v2, 4, v0
  v_and_b32 v3, 15, v0
  v_lshlrev_b32 v1, 2, v2
  v_xor_b32 v1, v1, v3
  v_mul_u32_u24 v2, 3584, v2
  v_lshl_add_u32 v52, v1, 4, v2
  v_and_b32 v1, 7, v1
  v_lshrrev_b32 v2, 3, v0
  v_lshlrev_b32 v2, 10, v2
  v_lshl_add_u32 v54, v1, 4, v2
  s_lshl_b32 s49, s67, 11
  s_add_u32 s49, s49, 151552
  v_lshl_add_u32 v3, v3, 3, s49
  v_lshl_add_u32 v57, v58, 7, v3
  s_mul_i32 s54, s45, 384
  s_add_u32 s49, s49, s54
  v_lshl_add_u32 v59, v0, 3, s49
  v_and_b32 v1, 31, v0
  v_lshlrev_b32 v2, 13, v6
  v_add_lshl_u32 v62, v2, v1, 1
  s_lshl_b32 s49, s3, 7
  s_add_u32 s49, s49, 147456
  v_lshl_add_u32 v242, v1, 2, s49
  v_lshlrev_b32 v243, 6, v58
  v_add_u32 v243, 147968, v243
  s_lshl_b32 s49, s3, 9
  s_add_u32 s49, s49, 149504
  v_lshl_add_u32 v240, v0, 2, s49
  v_lshlrev_b32 v63, 4, v0
  s_lshl_b32 s49, s45, 10
  v_add_u32 v241, s49, v63
  v_and_b32 v2, 31, v0
  v_mov_b32 v1, 0x80000000
  v_cmp_eq_u32 vcc, 0, v0
  s_add_u32 s44, s4, 81920
  s_mov_b32 s48, 0x3f803f80
  v_cndmask_b32 v76, v1, v0, vcc
  v_cmp_eq_u32 vcc, 0, v2
  v_lshlrev_b32 v2, 3, v6
  v_xor_b32 v21, 32, v48
  v_xor_b32 v25, 32, v49
  v_xor_b32 v22, 64, v48
  v_xor_b32 v26, 64, v49
  v_xor_b32 v23, 96, v48
  v_xor_b32 v27, 96, v49
  v_cndmask_b32 v3, v1, v2, vcc
  s_add_u32 m0, s4, 32768
  s_nop 0
  buffer_load_dwordx4 v8, s[8:11], s66 offen lds
  buffer_load_dwordx4 v9, s[8:11], s66 offen offset:1024 lds
  buffer_load_dwordx4 v10, s[8:11], s66 offen offset:2048 lds
  buffer_load_dwordx4 v11, s[8:11], s66 offen offset:3072 lds
  s_add_u32 m0, s5, 16384
  s_nop 0
  buffer_load_dwordx4 v8, s[12:15], s66 offen lds
  buffer_load_dwordx4 v9, s[12:15], s66 offen offset:1024 lds
  s_add_u32 s66, s66, 128
  s_and_b32 s66, s66, 1023
  s_waitcnt lgkmcnt(0)
  s_add_u32 s58, s58, 2654435769
  v_mov_b32 v251, s58
  s_mov_b32 s59, s58
  v_mov_b32 v5, s58
  s_waitcnt vmcnt(15)
  s_barrier
  s_add_u32 m0, s4, 49152
  s_nop 0
  buffer_load_dwordx4 v8, s[8:11], s66 offen lds
  ds_read_b128 a[0:3], v48 offset:0
  ds_read_b128 v[80:83], v49 offset:0
  v_dot2_f32_bf16 v172, v160, s48, 0
  v_dot2_f32_bf16 v173, v160, v160, 0
  v_dot2_f32_bf16 v174, v161, s48, 0
  v_dot2_f32_bf16 v175, v161, v161, 0
  v_dot2_f32_bf16 v172, v162, s48, v172
  v_dot2_f32_bf16 v173, v162, v162, v173
  v_dot2_f32_bf16 v174, v163, s48, v174
  buffer_load_dwordx4 v9, s[8:11], s66 offen offset:1024 lds
  ds_read_b128 a[4:7], v48 offset:4096
  ds_read_b128 a[8:11], v21 offset:0
  v_dot2_f32_bf16 v175, v163, v163, v175
  v_dot2_f32_bf16 v172, v164, s48, v172
  v_dot2_f32_bf16 v173, v164, v164, v173
  v_dot2_f32_bf16 v174, v165, s48, v174
  v_dot2_f32_bf16 v175, v165, v165, v175
  v_dot2_f32_bf16 v172, v166, s48, v172
  v_dot2_f32_bf16 v173, v166, v166, v173
  v_dot2_f32_bf16 v174, v167, s48, v174
  buffer_load_dwordx4 v10, s[8:11], s66 offen offset:2048 lds
  ds_read_b128 v[84:87], v25 offset:0
  ds_read_b128 a[12:15], v21 offset:4096
  v_dot2_f32_bf16 v175, v167, v167, v175
  v_mov_b32 v32, v50
  v_mov_b32 v33, v50
  v_mov_b32 v34, v50
  v_mov_b32 v35, v50
  v_pk_add_f32 v[172:173], v[172:173], v[174:175]
  s_nop 1
  v_add_f32 v172, v172, v172 row_ror:8 row_mask:0xf bank_mask:0xf
  v_add_f32 v173, v173, v173 row_ror:8 row_mask:0xf bank_mask:0xf
  buffer_load_dwordx4 v11, s[8:11], s66 offen offset:3072 lds
  s_add_u32 m0, s5, 24576
  ds_read_b128 a[16:19], v22 offset:0
  ds_read_b128 v[88:91], v26 offset:0
  v_add_f32 v172, v172, v172 row_ror:4 row_mask:0xf bank_mask:0xf
  v_add_f32 v173, v173, v173 row_ror:4 row_mask:0xf bank_mask:0xf
  s_nop 0
  v_add_f32 v172, v172, v172 row_ror:2 row_mask:0xf bank_mask:0xf
  v_add_f32 v173, v173, v173 row_ror:2 row_mask:0xf bank_mask:0xf
  s_nop 0
  v_add_f32 v172, v172, v172 row_ror:1 row_mask:0xf bank_mask:0xf
  v_add_f32 v173, v173, v173 row_ror:1 row_mask:0xf bank_mask:0xf
  v_mov_b32 v174, v172
  buffer_load_dwordx4 v8, s[12:15], s66 offen lds
  ds_read_b128 a[20:23], v22 offset:4096
  ds_read_b128 a[24:27], v23 offset:0
  v_mov_b32 v175, v173
  v_permlane16_swap_b32 v172, v174
  s_nop 0
  v_permlane16_swap_b32 v173, v175
  v_pk_add_f32 v[172:173], v[172:173], v[174:175]
  v_mul_f32 v172, 0x3b000000, v172
  v_mul_f32 v173, 0x3b000000, v173
  v_fma_f32 v173, -v172, v172, v173
  v_max_f32 v173, 0, v173
  buffer_load_dwordx4 v9, s[12:15], s66 offen offset:1024 lds
  s_add_u32 s66, s66, 128
  s_and_b32 s66, s66, 1023
  ds_read_b128 v[92:95], v27 offset:0
  ds_read_b128 a[28:31], v23 offset:4096
  v_cvt_pk_bf16_f32 v173, v173, v173
  v_and_b32 v173, s42, v173
  v_add_f32 v173, 0x3727c5ac, v173
  v_cvt_pk_bf16_f32 v173, v173, v173
  v_and_b32 v173, s42, v173
  v_sqrt_f32 v173, v173
  s_nop 0
  v_cvt_pk_bf16_f32 v250, v172, v173
  buffer_store_dwordx2 v[250:251], v3, s[20:23], s92 offen sc1
  s_waitcnt vmcnt(13) lgkmcnt(0)
  s_barrier
  v_mfma_f32_32x32x16_bf16 v[128:143], a[0:3], v[80:83], 0
  s_add_u32 m0, s4, 0
  s_nop 0
  buffer_load_dwordx4 v8, s[8:11], s66 offen lds
  ds_read_b128 a[32:35], v48 offset:16384
  ds_read_b128 v[96:99], v49 offset:8192
  s_add_u32 s16, s60, s68
  s_addc_u32 s17, s61, 0
  v_mfma_f32_32x32x16_bf16 v[144:159], a[4:7], v[80:83], 0
  s_mov_b32 s18, s69
  s_mov_b32 s19, 0x20000
  buffer_load_dwordx4 v9, s[8:11], s66 offen offset:1024 lds
  v_mfma_f32_32x32x16_bf16 v[128:143], a[8:11], v[84:87], v[128:143]
  ds_read_b128 a[36:39], v48 offset:20480
  ds_read_b128 a[40:43], v21 offset:16384
  s_add_u32 s32, s62, s72
  s_addc_u32 s33, s63, 0
  s_mov_b32 s34, 1834112
  s_mov_b32 s35, 0x20000
  buffer_load_dwordx4 v10, s[8:11], s66 offen offset:2048 lds
  v_mfma_f32_32x32x16_bf16 v[144:159], a[12:15], v[84:87], v[144:159]
  ds_read_b128 v[100:103], v25 offset:8192
  ds_read_b128 a[44:47], v21 offset:20480
  s_bitcmp1_b32 s84, 11
  s_cselect_b64 s[24:25], s[52:53], s[50:51]
  s_cselect_b64 s[28:29], s[50:51], s[52:53]
  v_mfma_f32_32x32x16_bf16 v[128:143], a[16:19], v[88:91], v[128:143]
  s_add_u32 s24, s24, s73
  s_addc_u32 s25, s25, 0
  s_mov_b32 s26, 64640
  buffer_load_dwordx4 v11, s[8:11], s66 offen offset:3072 lds
  s_add_u32 m0, s5, 0
  v_mfma_f32_32x32x16_bf16 v[144:159], a[20:23], v[88:91], v[144:159]
  ds_read_b128 a[48:51], v22 offset:16384
  ds_read_b128 v[104:107], v26 offset:8192
  s_mov_b32 s27, 0x20000
  s_add_u32 s28, s28, s73
  s_addc_u32 s29, s29, 0
  v_mfma_f32_32x32x16_bf16 v[128:143], a[24:27], v[92:95], v[128:143]
  s_mov_b32 s30, 64640
  buffer_load_dwordx4 v8, s[12:15], s66 offen lds
  ds_read_b128 a[52:55], v22 offset:20480
  ds_read_b128 a[56:59], v23 offset:16384
  v_mfma_f32_32x32x16_bf16 v[144:159], a[28:31], v[92:95], v[144:159]
  s_mov_b32 s31, 0x20000
  s_add_u32 s50, s20, s82
  s_addc_u32 s51, s21, 0
  s_and_b32 s73, s3, 1
  buffer_load_dwordx4 v9, s[12:15], s66 offen offset:1024 lds
  s_add_u32 s66, s66, 128
  s_and_b32 s66, s66, 1023
  v_mfma_f32_16x16x32_bf16 v[36:39], v[32:35], v[80:83], 0
  v_mfma_f32_16x16x32_bf16 v[36:39], v[32:35], v[84:87], v[36:39]
  ds_read_b128 v[108:111], v27 offset:8192
  ds_read_b128 a[60:63], v23 offset:20480
  v_mfma_f32_16x16x32_bf16 v[36:39], v[32:35], v[88:91], v[36:39]
  s_lshl_b32 s73, s73, 15
  s_lshr_b32 s49, s84, 7
  v_mfma_f32_16x16x32_bf16 v[36:39], v[32:35], v[92:95], v[36:39]
  s_and_b32 s49, s49, 0x60
  v_xor_b32 v56, s49, v56
  s_waitcnt vmcnt(13) lgkmcnt(0)
  s_barrier
  v_mfma_f32_32x32x16_bf16 v[128:143], a[32:35], v[96:99], v[128:143]
  s_add_u32 m0, s4, 16384
  s_nop 0
  buffer_load_dwordx4 v8, s[8:11], s66 offen lds
  ds_read_b128 a[64:67], v48 offset:32768
  ds_read_b128 v[80:83], v49 offset:16384
  v_add_u32 v13, 13312, v52
  v_mfma_f32_32x32x16_bf16 v[144:159], a[36:39], v[96:99], v[144:159]
  v_add_u32 v17, 7168, v54
  v_xor_b32 v16, 32, v56
  v_add_u32 v14, 26624, v52
  buffer_load_dwordx4 v9, s[8:11], s66 offen offset:1024 lds
  v_mfma_f32_32x32x16_bf16 v[128:143], a[40:43], v[100:103], v[128:143]
  ds_read_b128 a[68:71], v48 offset:36864
  ds_read_b128 a[72:75], v21 offset:32768
  v_add_u32 v18, 14336, v54
  v_xor_b32 v28, 64, v56
  v_add_u32 v15, 39936, v52
  v_add_u32 v19, 21504, v54
  v_mfma_f32_32x32x16_bf16 v[144:159], a[44:47], v[100:103], v[144:159]
  buffer_load_dwordx4 v10, s[8:11], s66 offen offset:2048 lds
  ds_read_b128 v[84:87], v25 offset:16384
  ds_read_b128 a[76:79], v21 offset:36864
  v_xor_b32 v4, 96, v56
  v_xor_b32 v29, 4096, v53
  v_mfma_f32_32x32x16_bf16 v[128:143], a[48:51], v[104:107], v[128:143]
  v_xor_b32 v30, 64, v53
  v_xor_b32 v31, 4160, v53
  buffer_load_dwordx4 v11, s[8:11], s66 offen offset:3072 lds
  s_add_u32 m0, s5, 8192
  v_mfma_f32_32x32x16_bf16 v[144:159], a[52:55], v[104:107], v[144:159]
  ds_read_b128 a[80:83], v22 offset:32768
  ds_read_b128 v[88:91], v26 offset:16384
  v_xor_b32 v12, 64, v55
  v_mov_b32 v248, 0
  v_mov_b32 v249, 0
  ds_write_b64 v59, v[248:249]
  v_mfma_f32_32x32x16_bf16 v[128:143], a[56:59], v[108:111], v[128:143]
  buffer_load_dwordx4 v8, s[12:15], s66 offen lds
  ds_read_b128 a[84:87], v22 offset:36864
  ds_read_b128 a[88:91], v23 offset:32768
  v_and_b32 v1, 15, v0
  v_lshl_add_u32 v59, v1, 4, s75
  v_mfma_f32_32x32x16_bf16 v[144:159], a[60:63], v[108:111], v[144:159]
  v_xor_b32 v50, 1024, v240
  v_xor_b32 v77, 1024, v241
  buffer_load_dwordx4 v9, s[12:15], s66 offen offset:1024 lds
  s_add_u32 s66, s66, 128
  s_and_b32 s66, s66, 1023
  v_mfma_f32_16x16x32_bf16 v[36:39], v[32:35], v[96:99], v[36:39]
  ds_read_b128 v[92:95], v27 offset:16384
  v_mfma_f32_16x16x32_bf16 v[36:39], v[32:35], v[100:103], v[36:39]
  ds_read_b128 a[92:95], v23 offset:36864
  v_mov_b32 v78, 0x80000000
  v_mfma_f32_16x16x32_bf16 v[36:39], v[32:35], v[104:107], v[36:39]
  v_writelane_b32 v78, s80, 0
  v_writelane_b32 v78, s81, 1
  v_mfma_f32_16x16x32_bf16 v[36:39], v[32:35], v[108:111], v[36:39]
  v_lshlrev_b32 v168, 16, v168
  v_lshlrev_b32 v169, 16, v169
  s_waitcnt vmcnt(13) lgkmcnt(0)
  s_barrier
  v_mfma_f32_32x32x16_bf16 v[128:143], a[64:67], v[80:83], v[128:143]
  s_add_u32 m0, s4, 32768
  s_nop 0
  buffer_load_dwordx4 v8, s[8:11], s66 offen lds
  ds_read_b128 a[96:99], v48 offset:49152
  ds_read_b128 v[96:99], v49 offset:24576
  v_lshlrev_b32 v170, 16, v170
  v_mfma_f32_32x32x16_bf16 v[144:159], a[68:71], v[80:83], v[144:159]
  v_mul_f32 v170, 0x3fb8aa3b, v170
  v_exp_f32 v170, v170
  v_mul_f32 v180, v168, v168
  buffer_load_dwordx4 v9, s[8:11], s66 offen offset:1024 lds
  v_mfma_f32_32x32x16_bf16 v[128:143], a[72:75], v[84:87], v[128:143]
  ds_read_b128 a[100:103], v48 offset:53248
  ds_read_b128 a[104:107], v21 offset:49152
  v_cvt_pk_bf16_f32 v170, v170, v170
  v_and_b32 v170, s42, v170
  v_mul_f32 v176, v170, v168
  v_mul_f32 v177, v170, v169
  buffer_load_dwordx4 v10, s[8:11], s66 offen offset:2048 lds
  v_mfma_f32_32x32x16_bf16 v[144:159], a[76:79], v[84:87], v[144:159]
  ds_read_b128 v[100:103], v25 offset:24576
  ds_read_b128 a[108:111], v21 offset:53248
  v_mul_f32 v176, 0x3fb8aa3b, v176
  v_exp_f32 v176, v176
  v_mfma_f32_32x32x16_bf16 v[128:143], a[80:83], v[88:91], v[128:143]
  v_mul_f32 v177, 0.15915494, v177
  v_rndne_f32 v178, v177
  v_sub_f32 v177, v177, v178
  buffer_load_dwordx4 v11, s[8:11], s66 offen offset:3072 lds
  s_add_u32 m0, s5, 16384
  v_mfma_f32_32x32x16_bf16 v[144:159], a[84:87], v[88:91], v[144:159]
  ds_read_b128 a[112:115], v22 offset:49152
  ds_read_b128 v[104:107], v26 offset:24576
  v_cos_f32 v178, v177
  v_sin_f32 v179, v177
  v_fmac_f32 v180, v169, v169
  v_mul_f32 v64, v176, v178
  v_mfma_f32_32x32x16_bf16 v[128:143], a[88:91], v[92:95], v[128:143]
  buffer_load_dwordx4 v8, s[12:15], s66 offen lds
  ds_read_b128 a[116:119], v22 offset:53248
  ds_read_b128 a[120:123], v23 offset:49152
  v_mul_f32 v65, -v176, v179
  v_mfma_f32_32x32x16_bf16 v[144:159], a[92:95], v[92:95], v[144:159]
  v_rcp_f32 v180, v180
  v_add_f32 v178, -1.0, v64
  v_mul_f32 v181, v178, v168
  buffer_load_dwordx4 v9, s[12:15], s66 offen offset:1024 lds
  s_add_u32 s66, s66, 128
  s_and_b32 s66, s66, 1023
  v_mfma_f32_16x16x32_bf16 v[36:39], v[32:35], v[80:83], v[36:39]
  ds_read_b128 v[108:111], v27 offset:24576
  v_mfma_f32_16x16x32_bf16 v[36:39], v[32:35], v[84:87], v[36:39]
  ds_read_b128 a[124:127], v23 offset:53248
  v_fma_f32 v181, -v65, v169, v181
  v_mfma_f32_16x16x32_bf16 v[36:39], v[32:35], v[88:91], v[36:39]
  v_mul_f32 v182, v65, v168
  v_fmac_f32 v182, v178, v169
  v_mfma_f32_16x16x32_bf16 v[36:39], v[32:35], v[92:95], v[36:39]
  v_add_f32 v180, v180, v180
  v_mul_f32 v74, v181, v180
  s_waitcnt vmcnt(12) lgkmcnt(0)
  s_barrier
  v_mfma_f32_32x32x16_bf16 v[128:143], a[96:99], v[96:99], v[128:143]
  v_and_b32 v252, 31, v0
  v_lshlrev_b32 v252, 3, v252
  buffer_load_dwordx2 v[250:251], v252, s[20:23], s71 offen sc1
  ds_read_b128 a[128:131], v48 offset:0
  ds_read_b128 v[80:83], v49 offset:0
  v_mfma_f32_32x32x16_bf16 v[144:159], a[100:103], v[96:99], v[144:159]
  v_mul_f32 v75, v182, v180
  v_mul_f32 v184, v64, v64
  v_mul_f32 v185, v64, v65
  s_add_u32 m0, s4, 49152
  s_nop 0
  buffer_load_dwordx4 v8, s[8:11], s66 offen lds
  v_mfma_f32_32x32x16_bf16 v[128:143], a[104:107], v[100:103], v[128:143]
  ds_read_b128 a[132:135], v48 offset:4096
  ds_read_b128 a[136:139], v21 offset:0
  v_fma_f32 v184, -v65, v65, v184
  v_add_f32 v185, v185, v185
  v_mul_f32 v186, v184, v184
  v_mul_f32 v187, v184, v185
  buffer_load_dwordx4 v9, s[8:11], s66 offen offset:1024 lds
  v_mfma_f32_32x32x16_bf16 v[144:159], a[108:111], v[100:103], v[144:159]
  ds_read_b128 v[84:87], v25 offset:0
  ds_read_b128 a[140:143], v21 offset:4096
  v_fma_f32 v186, -v185, v185, v186
  v_add_f32 v187, v187, v187
  v_mul_f32 v184, v186, v186
  v_mfma_f32_32x32x16_bf16 v[128:143], a[112:115], v[104:107], v[128:143]
  v_mul_f32 v185, v186, v187
  buffer_load_dwordx4 v10, s[8:11], s66 offen offset:2048 lds
  ds_read_b128 a[144:147], v22 offset:0
  v_fma_f32 v184, -v187, v187, v184
  v_add_f32 v185, v185, v185
  v_mfma_f32_32x32x16_bf16 v[144:159], a[116:119], v[104:107], v[144:159]
  v_mul_f32 v66, v184, v184
  buffer_load_dwordx4 v11, s[8:11], s66 offen offset:3072 lds
  s_add_u32 m0, s5, 24576
  ds_read_b128 v[88:91], v26 offset:0
  ds_read_b128 a[148:151], v22 offset:4096
  v_mfma_f32_32x32x16_bf16 v[128:143], a[120:123], v[108:111], v[128:143]
  v_mul_f32 v67, v184, v185
  v_fma_f32 v66, -v185, v185, v66
  v_add_f32 v67, v67, v67
  v_mul_f32 v190, v66, v66
  buffer_load_dwordx4 v8, s[12:15], s66 offen lds
  v_mfma_f32_32x32x16_bf16 v[144:159], a[124:127], v[108:111], v[144:159]
  ds_read_b128 a[152:155], v23 offset:0
  ds_read_b128 v[92:95], v27 offset:0
  v_mul_f32 v191, v66, v67
  v_fma_f32 v190, -v67, v67, v190
  v_add_f32 v191, v191, v191
  v_and_b32 v1, 1, v58
  buffer_load_dwordx4 v9, s[12:15], s66 offen offset:1024 lds
  s_add_u32 s66, s66, 128
  s_and_b32 s66, s66, 1023
  v_mfma_f32_16x16x32_bf16 v[36:39], v[32:35], v[96:99], v[36:39]
  v_mfma_f32_16x16x32_bf16 v[36:39], v[32:35], v[100:103], v[36:39]
  ds_read_b128 a[156:159], v23 offset:4096
  v_mfma_f32_16x16x32_bf16 v[36:39], v[32:35], v[104:107], v[36:39]
  v_cmp_ne_u32 vcc, 0, v1
  s_nop 1
  v_cndmask_b32 v184, 1.0, v66, vcc
  v_mfma_f32_16x16x32_bf16 v[36:39], v[32:35], v[108:111], v[36:39]
  v_cndmask_b32 v185, 0, v67, vcc
  v_and_b32 v1, 2, v58
  s_waitcnt vmcnt(13) lgkmcnt(0)
  s_barrier
  v_mfma_f32_32x32x16_bf16 v[128:143], a[128:131], v[80:83], v[128:143]
  s_add_u32 m0, s44, 16384
  s_nop 0
  buffer_load_dwordx4 v52, s[16:19], s70 offen lds
  ds_read_b128 a[160:163], v48 offset:16384
  ds_read_b128 v[96:99], v49 offset:8192
  v_cmp_ne_u32 vcc, 0, v1
  v_mfma_f32_32x32x16_bf16 v[144:159], a[132:135], v[80:83], v[144:159]
  s_nop 0
  v_cndmask_b32 v186, 1.0, v190, vcc
  v_cndmask_b32 v187, 0, v191, vcc
  v_mul_f32 v188, v184, v186
  buffer_load_dwordx4 v13, s[16:19], s70 offen offset:1024 lds
  ds_read_b128 a[164:167], v48 offset:20480
  v_mfma_f32_32x32x16_bf16 v[128:143], a[136:139], v[84:87], v[128:143]
  ds_read_b128 a[168:171], v21 offset:16384
  v_mul_f32 v189, v184, v187
  v_fma_f32 v188, -v185, v187, v188
  v_fmac_f32 v189, v185, v186
  v_mul_f32 v192, v190, v190
  s_add_u32 m0, s44, 16384
  s_nop 0
  buffer_load_dwordx4 v14, s[16:19], s70 offen offset:2048 lds
  v_mfma_f32_32x32x16_bf16 v[144:159], a[140:143], v[84:87], v[144:159]
  ds_read_b128 v[100:103], v25 offset:8192
  ds_read_b128 a[172:175], v21 offset:20480
  v_mul_f32 v193, v190, v191
  v_fma_f32 v192, -v191, v191, v192
  v_mfma_f32_32x32x16_bf16 v[128:143], a[144:147], v[88:91], v[128:143]
  v_add_f32 v193, v193, v193
  v_and_b32 v1, 4, v58
  v_cmp_ne_u32 vcc, 0, v1
  buffer_load_dwordx4 v15, s[16:19], s70 offen offset:3072 lds
  s_add_u32 s70, s70, 229376
  s_cmp_eq_u32 s70, 1835008
  s_cselect_b32 s70, 0, s70
  v_mfma_f32_32x32x16_bf16 v[144:159], a[148:151], v[88:91], v[144:159]
  ds_read_b128 a[176:179], v22 offset:16384
  ds_read_b128 v[104:107], v26 offset:8192
  v_cndmask_b32 v184, 1.0, v192, vcc
  v_cndmask_b32 v185, 0, v193, vcc
  v_mul_f32 v68, v188, v184
  v_mfma_f32_32x32x16_bf16 v[128:143], a[152:155], v[92:95], v[128:143]
  v_mul_f32 v69, v188, v185
  s_add_u32 m0, s4, 0
  s_xor_b32 s46, s73, 0
  buffer_load_dwordx4 v8, s[24:27], s46 offen offset:0 lds
  ds_read_b128 a[180:183], v22 offset:20480
  v_mfma_f32_32x32x16_bf16 v[144:159], a[156:159], v[92:95], v[144:159]
  ds_read_b128 a[184:187], v23 offset:16384
  v_fma_f32 v68, -v189, v185, v68
  v_fmac_f32 v69, v189, v184
  v_mul_f32 v190, v192, v192
  v_mul_f32 v191, v192, v193
  buffer_load_dwordx4 v9, s[24:27], s46 offen offset:1024 lds
  v_mfma_f32_16x16x32_bf16 v[36:39], v[32:35], v[80:83], v[36:39]
  ds_read_b128 v[108:111], v27 offset:8192
  v_mfma_f32_16x16x32_bf16 v[36:39], v[32:35], v[84:87], v[36:39]
  ds_read_b128 a[188:191], v23 offset:20480
  v_fma_f32 v190, -v193, v193, v190
  v_mfma_f32_16x16x32_bf16 v[36:39], v[32:35], v[88:91], v[36:39]
  v_add_f32 v191, v191, v191
  v_mul_f32 v192, v190, v190
  v_mfma_f32_16x16x32_bf16 v[36:39], v[32:35], v[92:95], v[36:39]
  v_mul_f32 v193, v190, v191
  v_fma_f32 v192, -v191, v191, v192
  s_waitcnt vmcnt(13) lgkmcnt(0)
  s_barrier
  v_mfma_f32_32x32x16_bf16 v[128:143], a[160:163], v[96:99], v[128:143]
  s_add_u32 m0, s44, 32768
  s_nop 0
  buffer_load_dwordx4 v52, s[16:19], s70 offen lds
  ds_read_b128 a[192:195], v48 offset:32768
  ds_read_b128 v[80:83], v49 offset:16384
  v_mfma_f32_32x32x16_bf16 v[144:159], a[164:167], v[96:99], v[144:159]
  v_add_f32 v193, v193, v193
  v_mul_f32 v72, v192, v192
  buffer_load_dwordx4 v13, s[16:19], s70 offen offset:1024 lds
  ds_read_b128 a[196:199], v48 offset:36864
  v_mfma_f32_32x32x16_bf16 v[128:143], a[168:171], v[100:103], v[128:143]
  ds_read_b128 a[200:203], v21 offset:32768
  v_mul_f32 v73, v192, v193
  v_fma_f32 v72, -v193, v193, v72
  v_add_f32 v73, v73, v73
  s_add_u32 m0, s44, 32768
  s_nop 0
  buffer_load_dwordx4 v14, s[16:19], s70 offen offset:2048 lds
  v_mfma_f32_32x32x16_bf16 v[144:159], a[172:175], v[100:103], v[144:159]
  ds_read_b128 v[84:87], v25 offset:16384
  ds_read_b128 a[204:207], v21 offset:36864
  v_and_b32 v1, 16, v0
  v_cmp_ne_u32 vcc, 0, v1
  v_mfma_f32_32x32x16_bf16 v[128:143], a[176:179], v[104:107], v[128:143]
  s_nop 0
  v_cndmask_b32 v184, 1.0, v190, vcc
  buffer_load_dwordx4 v15, s[16:19], s70 offen offset:3072 lds
  s_add_u32 s70, s70, 229376
  s_cmp_eq_u32 s70, 1835008
  s_cselect_b32 s70, 0, s70
  v_mfma_f32_32x32x16_bf16 v[144:159], a[180:183], v[104:107], v[144:159]
  ds_read_b128 a[208:211], v22 offset:32768
  ds_read_b128 v[88:91], v26 offset:16384
  v_cndmask_b32 v185, 0, v191, vcc
  v_and_b32 v1, 32, v0
  v_mfma_f32_32x32x16_bf16 v[128:143], a[184:187], v[108:111], v[128:143]
  v_cmp_ne_u32 vcc, 0, v1
  s_add_u32 m0, s4, 0
  s_xor_b32 s46, s73, 0
  buffer_load_dwordx4 v10, s[24:27], s46 offen offset:2048 lds
  v_mfma_f32_32x32x16_bf16 v[144:159], a[188:191], v[108:111], v[144:159]
  ds_read_b128 a[212:215], v22 offset:36864
  ds_read_b128 a[216:219], v23 offset:32768
  v_cndmask_b32 v186, 1.0, v192, vcc
  v_cndmask_b32 v187, 0, v193, vcc
  v_mul_f32 v70, v184, v186
  buffer_load_dwordx4 v11, s[24:27], s46 offen offset:3072 lds
  v_mfma_f32_16x16x32_bf16 v[36:39], v[32:35], v[96:99], v[36:39]
  v_mfma_f32_16x16x32_bf16 v[36:39], v[32:35], v[100:103], v[36:39]
  ds_read_b128 v[92:95], v27 offset:16384
  ds_read_b128 a[220:223], v23 offset:36864
  v_mfma_f32_16x16x32_bf16 v[36:39], v[32:35], v[104:107], v[36:39]
  v_mul_f32 v71, v184, v187
  v_fma_f32 v70, -v185, v187, v70
  v_mfma_f32_16x16x32_bf16 v[36:39], v[32:35], v[108:111], v[36:39]
  v_fmac_f32 v71, v185, v186
  s_waitcnt vmcnt(12) lgkmcnt(0)
  s_barrier
  v_mfma_f32_32x32x16_bf16 v[128:143], a[192:195], v[80:83], v[128:143]
  s_add_u32 m0, s44, 49152
  s_nop 0
  buffer_load_dwordx4 v52, s[16:19], s70 offen lds
  ds_read_b128 a[224:227], v48 offset:49152
  ds_read_b128 v[96:99], v49 offset:24576
  v_mfma_f32_32x32x16_bf16 v[144:159], a[196:199], v[80:83], v[144:159]
  buffer_load_dwordx4 v13, s[16:19], s70 offen offset:1024 lds
  ds_read_b128 a[228:231], v48 offset:53248
  ds_read_b128 a[232:235], v21 offset:49152
  v_mfma_f32_32x32x16_bf16 v[128:143], a[200:203], v[84:87], v[128:143]
  s_add_u32 m0, s44, 49152
  s_nop 0
  buffer_load_dwordx4 v14, s[16:19], s70 offen offset:2048 lds
  ds_read_b128 v[100:103], v25 offset:24576
  ds_read_b128 a[236:239], v21 offset:53248
  v_mfma_f32_32x32x16_bf16 v[144:159], a[204:207], v[84:87], v[144:159]
  buffer_load_dwordx4 v15, s[16:19], s70 offen offset:3072 lds
  s_add_u32 s70, s70, 229376
  s_cmp_eq_u32 s70, 1835008
  s_cselect_b32 s70, 0, s70
  v_mfma_f32_32x32x16_bf16 v[128:143], a[208:211], v[88:91], v[128:143]
  ds_read_b128 a[240:243], v22 offset:49152
  ds_read_b128 v[104:107], v26 offset:24576
  s_add_u32 m0, s4, 16384
  s_xor_b32 s46, s73, 32768
  buffer_load_dwordx4 v8, s[24:27], s46 offen offset:0 lds
  v_mfma_f32_32x32x16_bf16 v[144:159], a[212:215], v[88:91], v[144:159]
  ds_read_b128 a[244:247], v22 offset:53248
  ds_read_b128 a[248:251], v23 offset:49152
  buffer_load_dwordx4 v9, s[24:27], s46 offen offset:1024 lds
  v_mfma_f32_32x32x16_bf16 v[128:143], a[216:219], v[92:95], v[128:143]
  ds_read_b128 v[108:111], v27 offset:24576
  ds_read_b128 a[252:255], v23 offset:53248
  s_mov_b32 s48, 0
L_st:
  v_cmp_ne_u32 vcc, s58, v251
  s_cbranch_vccz L_st_ok
  v_and_b32 v252, 31, v0
  v_lshlrev_b32 v252, 3, v252
  buffer_load_dwordx2 v[250:251], v252, s[20:23], s71 offen sc1
  s_add_u32 s48, s48, 1
  s_waitcnt vmcnt(0)
  s_cmp_lt_u32 s48, 0x20000
  s_cbranch_scc1 L_st
L_st_ok:
  v_and_b32 v251, s42, v250
  v_rcp_f32 v251, v251
  v_lshlrev_b32 v250, 16, v250
  ds_write2_b32 v242, v250, v251 offset0:0 offset1:128
  v_mfma_f32_32x32x16_bf16 v[144:159], a[220:223], v[92:95], v[144:159]
  v_mfma_f32_16x16x32_bf16 v[36:39], v[32:35], v[80:83], v[36:39]
  v_mfma_f32_16x16x32_bf16 v[36:39], v[32:35], v[84:87], v[36:39]
  v_mfma_f32_16x16x32_bf16 v[36:39], v[32:35], v[88:91], v[36:39]
  v_mfma_f32_16x16x32_bf16 v[36:39], v[32:35], v[92:95], v[36:39]
  s_waitcnt vmcnt(14) lgkmcnt(0)
  s_barrier
  v_mfma_f32_16x16x32_bf16 v[36:39], v[32:35], v[96:99], v[36:39]
  ds_read_b64_tr_b16 v[112:113], v53 offset:16384
  ds_read_b64_tr_b16 v[114:115], v53 offset:17408
  v_mfma_f32_16x16x32_bf16 v[36:39], v[32:35], v[100:103], v[36:39]
  ds_read_b64_tr_b16 v[116:117], v30 offset:16384
  v_mfma_f32_16x16x32_bf16 v[36:39], v[32:35], v[104:107], v[36:39]
  ds_read_b64_tr_b16 v[118:119], v30 offset:17408
  v_mfma_f32_16x16x32_bf16 v[36:39], v[32:35], v[108:111], v[36:39]
  ds_read2_b32 v[244:245], v51 offset0:0 offset1:128
  v_mfma_f32_32x32x16_bf16 v[128:143], a[224:227], v[96:99], v[128:143]
  ds_read2_b32 v[246:247], v51 offset0:32 offset1:160
  ds_read_b128 v[224:227], v243 offset:0
  ds_read_b128 v[228:231], v243 offset:16
  v_mfma_f32_32x32x16_bf16 v[144:159], a[228:231], v[96:99], v[144:159]
  ds_read_b128 v[232:235], v243 offset:32
  ds_read_b128 v[236:239], v243 offset:48
  v_cmp_gt_u32 vcc, 32, v0
  v_mfma_f32_32x32x16_bf16 v[128:143], a[232:235], v[100:103], v[128:143]
  v_mov_b32 v21, 0
  v_mov_b32 v25, 0
  v_mov_b32 v22, 0
  v_mfma_f32_32x32x16_bf16 v[144:159], a[236:239], v[100:103], v[144:159]
  v_mov_b32 v26, 0
  s_add_u32 m0, s4, 16384
  s_xor_b32 s46, s73, 32768
  buffer_load_dwordx4 v10, s[24:27], s46 offen offset:2048 lds
  buffer_load_dwordx4 v11, s[24:27], s46 offen offset:3072 lds
  v_mfma_f32_32x32x16_bf16 v[128:143], a[240:243], v[104:107], v[128:143]
  v_mov_b32 v23, 0
  v_mov_b32 v27, 0
  v_mfma_f32_32x32x16_bf16 v[144:159], a[244:247], v[104:107], v[144:159]
  s_waitcnt lgkmcnt(4)
  v_xor_b32 v1, 0x80000000, v244
  v_perm_b32 v1, v1, v1, s43
  v_cndmask_b32 v20, 0, v1, vcc
  v_mfma_f32_32x32x16_bf16 v[128:143], a[248:251], v[108:111], v[128:143]
  v_xor_b32 v1, 0x80000000, v246
  v_perm_b32 v1, v1, v1, s43
  v_cndmask_b32 v24, 0, v1, vcc
  v_mfma_f32_32x32x16_bf16 v[144:159], a[252:255], v[108:111], v[144:159]
  v_and_b32 v1, s42, v36
  v_sub_f32 v1, v36, v1
  v_perm_b32 v80, v1, v36, s43
  s_nop 1
  v_mfma_f32_32x32x16_bf16 v[128:143], v[20:23], v[80:83], v[128:143]
  v_mfma_f32_32x32x16_bf16 v[144:159], v[24:27], v[80:83], v[144:159]
  v_mfma_f32_16x16x32_bf16 v[40:43], v[32:35], v[112:115], 0
  ds_read_b64_tr_b16 v[120:121], v29 offset:16384
  v_mfma_f32_16x16x32_bf16 v[44:47], v[32:35], v[116:119], 0
  ds_read_b64_tr_b16 v[122:123], v29 offset:17408
  v_mfma_f32_32x32x16_bf16 v[160:175], v[112:115], a[0:3], 0
  ds_read_b64_tr_b16 v[124:125], v31 offset:16384
  ds_read_b64_tr_b16 v[126:127], v31 offset:17408
  v_mfma_f32_32x32x16_bf16 v[192:207], v[112:115], a[4:7], 0
  s_add_u32 m0, s44, 0
  s_nop 0
  buffer_load_dwordx4 v52, s[16:19], s70 offen lds
  v_mfma_f32_32x32x16_bf16 v[176:191], v[116:119], a[0:3], 0
  buffer_load_dwordx4 v13, s[16:19], s70 offen offset:1024 lds
  v_mfma_f32_32x32x16_bf16 v[208:223], v[116:119], a[4:7], 0
  s_waitcnt lgkmcnt(0)
  v_mfma_f32_32x32x16_bf16 v[160:175], v[120:123], a[8:11], v[160:175]
  ds_read_b64_tr_b16 v[112:113], v53 offset:24576
  ds_read_b64_tr_b16 v[114:115], v53 offset:25600
  ds_read_b64_tr_b16 v[116:117], v30 offset:24576
  ds_read_b64_tr_b16 v[118:119], v30 offset:25600
  v_permlane16_swap_b32 v128, v144
  v_permlane16_swap_b32 v129, v145
  v_permlane16_swap_b32 v130, v146
  s_add_u32 m0, s44, 0
  s_nop 0
  buffer_load_dwordx4 v14, s[16:19], s70 offen offset:2048 lds
  v_mfma_f32_32x32x16_bf16 v[192:207], v[120:123], a[12:15], v[192:207]
  v_permlane16_swap_b32 v131, v147
  v_permlane16_swap_b32 v132, v148
  v_permlane16_swap_b32 v133, v149
  buffer_load_dwordx4 v15, s[16:19], s70 offen offset:3072 lds
  s_add_u32 s70, s70, 229376
  s_cmp_eq_u32 s70, 1835008
  s_cselect_b32 s70, 0, s70
  v_mfma_f32_32x32x16_bf16 v[176:191], v[124:127], a[8:11], v[176:191]
  v_permlane16_swap_b32 v134, v150
  v_permlane16_swap_b32 v135, v151
  v_permlane16_swap_b32 v136, v152
  s_add_u32 m0, s4, 32768
  s_xor_b32 s46, s73, 0
  buffer_load_dwordx4 v8, s[28:31], s46 offen offset:0 lds
  v_permlane16_swap_b32 v137, v153
  v_mfma_f32_32x32x16_bf16 v[208:223], v[124:127], a[12:15], v[208:223]
  v_permlane16_swap_b32 v138, v154
  v_permlane16_swap_b32 v139, v155
  buffer_load_dwordx4 v9, s[28:31], s46 offen offset:1024 lds
  v_permlane16_swap_b32 v140, v156
  v_permlane16_swap_b32 v141, v157
  v_permlane16_swap_b32 v142, v158
  v_permlane16_swap_b32 v143, v159
  s_waitcnt lgkmcnt(0)
  v_mfma_f32_16x16x32_bf16 v[40:43], v[32:35], v[112:115], v[40:43]
  ds_read_b64_tr_b16 v[120:121], v29 offset:24576
  ds_read_b64_tr_b16 v[122:123], v29 offset:25600
  ds_read_b64_tr_b16 v[124:125], v31 offset:24576
  ds_read_b64_tr_b16 v[126:127], v31 offset:25600
  v_pk_mul_f32 v[80:81], v[128:129], v[74:75] op_sel:[0,0] op_sel_hi:[0,1]
  v_pk_fma_f32 v[80:81], v[144:145], v[74:75], v[80:81] op_sel:[0,1,0] op_sel_hi:[0,0,1] neg_hi:[0,1,0]
  v_pk_mul_f32 v[80:81], v[80:81], v[224:225] op_sel:[0,0] op_sel_hi:[1,0]
  v_pk_mul_f32 v[82:83], v[128:129], v[74:75] op_sel:[1,0] op_sel_hi:[1,1]
  v_pk_fma_f32 v[82:83], v[144:145], v[74:75], v[82:83] op_sel:[1,1,0] op_sel_hi:[1,0,1] neg_hi:[0,1,0]
  v_pk_mul_f32 v[82:83], v[82:83], v[224:225] op_sel:[0,1] op_sel_hi:[1,1]
  v_pk_fma_f32 v[248:249], v[80:81], v[64:65], v[82:83] op_sel:[0,0,0] op_sel_hi:[1,0,1]
  v_pk_fma_f32 v[248:249], v[80:81], v[64:65], v[248:249] op_sel:[1,1,0] op_sel_hi:[0,1,1] neg_lo:[0,1,0]
  v_pk_mul_f32 v[84:85], v[130:131], v[74:75] op_sel:[0,0] op_sel_hi:[0,1]
  v_pk_fma_f32 v[84:85], v[146:147], v[74:75], v[84:85] op_sel:[0,1,0] op_sel_hi:[0,0,1] neg_hi:[0,1,0]
  v_pk_mul_f32 v[84:85], v[84:85], v[226:227] op_sel:[0,0] op_sel_hi:[1,0]
  v_pk_fma_f32 v[250:251], v[248:249], v[64:65], v[84:85] op_sel:[0,0,0] op_sel_hi:[1,0,1]
  v_pk_fma_f32 v[250:251], v[248:249], v[64:65], v[250:251] op_sel:[1,1,0] op_sel_hi:[0,1,1] neg_lo:[0,1,0]
  v_pk_mul_f32 v[86:87], v[130:131], v[74:75] op_sel:[1,0] op_sel_hi:[1,1]
  v_pk_fma_f32 v[86:87], v[146:147], v[74:75], v[86:87] op_sel:[1,1,0] op_sel_hi:[1,0,1] neg_hi:[0,1,0]
  v_pk_mul_f32 v[86:87], v[86:87], v[226:227] op_sel:[0,1] op_sel_hi:[1,1]
  v_pk_fma_f32 v[248:249], v[250:251], v[64:65], v[86:87] op_sel:[0,0,0] op_sel_hi:[1,0,1]
  v_pk_fma_f32 v[248:249], v[250:251], v[64:65], v[248:249] op_sel:[1,1,0] op_sel_hi:[0,1,1] neg_lo:[0,1,0]
  v_pk_mul_f32 v[88:89], v[132:133], v[74:75] op_sel:[0,0] op_sel_hi:[0,1]
  v_pk_fma_f32 v[88:89], v[148:149], v[74:75], v[88:89] op_sel:[0,1,0] op_sel_hi:[0,0,1] neg_hi:[0,1,0]
  v_pk_mul_f32 v[88:89], v[88:89], v[228:229] op_sel:[0,0] op_sel_hi:[1,0]
  v_pk_fma_f32 v[250:251], v[248:249], v[64:65], v[88:89] op_sel:[0,0,0] op_sel_hi:[1,0,1]
  v_pk_fma_f32 v[250:251], v[248:249], v[64:65], v[250:251] op_sel:[1,1,0] op_sel_hi:[0,1,1] neg_lo:[0,1,0]
  v_pk_mul_f32 v[90:91], v[132:133], v[74:75] op_sel:[1,0] op_sel_hi:[1,1]
  v_pk_fma_f32 v[90:91], v[148:149], v[74:75], v[90:91] op_sel:[1,1,0] op_sel_hi:[1,0,1] neg_hi:[0,1,0]
  v_pk_mul_f32 v[90:91], v[90:91], v[228:229] op_sel:[0,1] op_sel_hi:[1,1]
  v_pk_fma_f32 v[248:249], v[250:251], v[64:65], v[90:91] op_sel:[0,0,0] op_sel_hi:[1,0,1]
  v_pk_fma_f32 v[248:249], v[250:251], v[64:65], v[248:249] op_sel:[1,1,0] op_sel_hi:[0,1,1] neg_lo:[0,1,0]
  v_pk_mul_f32 v[92:93], v[134:135], v[74:75] op_sel:[0,0] op_sel_hi:[0,1]
  v_pk_fma_f32 v[92:93], v[150:151], v[74:75], v[92:93] op_sel:[0,1,0] op_sel_hi:[0,0,1] neg_hi:[0,1,0]
  v_pk_mul_f32 v[92:93], v[92:93], v[230:231] op_sel:[0,0] op_sel_hi:[1,0]
  v_pk_fma_f32 v[250:251], v[248:249], v[64:65], v[92:93] op_sel:[0,0,0] op_sel_hi:[1,0,1]
  v_pk_fma_f32 v[250:251], v[248:249], v[64:65], v[250:251] op_sel:[1,1,0] op_sel_hi:[0,1,1] neg_lo:[0,1,0]
  v_pk_mul_f32 v[94:95], v[134:135], v[74:75] op_sel:[1,0] op_sel_hi:[1,1]
  v_pk_fma_f32 v[94:95], v[150:151], v[74:75], v[94:95] op_sel:[1,1,0] op_sel_hi:[1,0,1] neg_hi:[0,1,0]
  v_pk_mul_f32 v[94:95], v[94:95], v[230:231] op_sel:[0,1] op_sel_hi:[1,1]
  v_pk_fma_f32 v[248:249], v[250:251], v[64:65], v[94:95] op_sel:[0,0,0] op_sel_hi:[1,0,1]
  v_pk_fma_f32 v[248:249], v[250:251], v[64:65], v[248:249] op_sel:[1,1,0] op_sel_hi:[0,1,1] neg_lo:[0,1,0]
  v_pk_mul_f32 v[96:97], v[136:137], v[74:75] op_sel:[0,0] op_sel_hi:[0,1]
  v_pk_fma_f32 v[96:97], v[152:153], v[74:75], v[96:97] op_sel:[0,1,0] op_sel_hi:[0,0,1] neg_hi:[0,1,0]
  v_pk_mul_f32 v[96:97], v[96:97], v[232:233] op_sel:[0,0] op_sel_hi:[1,0]
  v_pk_fma_f32 v[250:251], v[248:249], v[64:65], v[96:97] op_sel:[0,0,0] op_sel_hi:[1,0,1]
  v_pk_fma_f32 v[250:251], v[248:249], v[64:65], v[250:251] op_sel:[1,1,0] op_sel_hi:[0,1,1] neg_lo:[0,1,0]
  v_pk_mul_f32 v[98:99], v[136:137], v[74:75] op_sel:[1,0] op_sel_hi:[1,1]
  v_pk_fma_f32 v[98:99], v[152:153], v[74:75], v[98:99] op_sel:[1,1,0] op_sel_hi:[1,0,1] neg_hi:[0,1,0]
  v_pk_mul_f32 v[98:99], v[98:99], v[232:233] op_sel:[0,1] op_sel_hi:[1,1]
  v_pk_fma_f32 v[248:249], v[250:251], v[64:65], v[98:99] op_sel:[0,0,0] op_sel_hi:[1,0,1]
  v_pk_fma_f32 v[248:249], v[250:251], v[64:65], v[248:249] op_sel:[1,1,0] op_sel_hi:[0,1,1] neg_lo:[0,1,0]
  v_pk_mul_f32 v[100:101], v[138:139], v[74:75] op_sel:[0,0] op_sel_hi:[0,1]
  v_pk_fma_f32 v[100:101], v[154:155], v[74:75], v[100:101] op_sel:[0,1,0] op_sel_hi:[0,0,1] neg_hi:[0,1,0]
  v_pk_mul_f32 v[100:101], v[100:101], v[234:235] op_sel:[0,0] op_sel_hi:[1,0]
  v_pk_fma_f32 v[250:251], v[248:249], v[64:65], v[100:101] op_sel:[0,0,0] op_sel_hi:[1,0,1]
  v_pk_fma_f32 v[250:251], v[248:249], v[64:65], v[250:251] op_sel:[1,1,0] op_sel_hi:[0,1,1] neg_lo:[0,1,0]
  v_pk_mul_f32 v[102:103], v[138:139], v[74:75] op_sel:[1,0] op_sel_hi:[1,1]
  v_pk_fma_f32 v[102:103], v[154:155], v[74:75], v[102:103] op_sel:[1,1,0] op_sel_hi:[1,0,1] neg_hi:[0,1,0]
  v_pk_mul_f32 v[102:103], v[102:103], v[234:235] op_sel:[0,1] op_sel_hi:[1,1]
  v_pk_fma_f32 v[248:249], v[250:251], v[64:65], v[102:103] op_sel:[0,0,0] op_sel_hi:[1,0,1]
  v_pk_fma_f32 v[248:249], v[250:251], v[64:65], v[248:249] op_sel:[1,1,0] op_sel_hi:[0,1,1] neg_lo:[0,1,0]
  v_pk_mul_f32 v[104:105], v[140:141], v[74:75] op_sel:[0,0] op_sel_hi:[0,1]
  v_pk_fma_f32 v[104:105], v[156:157], v[74:75], v[104:105] op_sel:[0,1,0] op_sel_hi:[0,0,1] neg_hi:[0,1,0]
  v_pk_mul_f32 v[104:105], v[104:105], v[236:237] op_sel:[0,0] op_sel_hi:[1,0]
  v_pk_fma_f32 v[250:251], v[248:249], v[64:65], v[104:105] op_sel:[0,0,0] op_sel_hi:[1,0,1]
  v_pk_fma_f32 v[250:251], v[248:249], v[64:65], v[250:251] op_sel:[1,1,0] op_sel_hi:[0,1,1] neg_lo:[0,1,0]
  v_pk_mul_f32 v[106:107], v[140:141], v[74:75] op_sel:[1,0] op_sel_hi:[1,1]
  v_pk_fma_f32 v[106:107], v[156:157], v[74:75], v[106:107] op_sel:[1,1,0] op_sel_hi:[1,0,1] neg_hi:[0,1,0]
  v_pk_mul_f32 v[106:107], v[106:107], v[236:237] op_sel:[0,1] op_sel_hi:[1,1]
  v_pk_fma_f32 v[248:249], v[250:251], v[64:65], v[106:107] op_sel:[0,0,0] op_sel_hi:[1,0,1]
  v_pk_fma_f32 v[248:249], v[250:251], v[64:65], v[248:249] op_sel:[1,1,0] op_sel_hi:[0,1,1] neg_lo:[0,1,0]
  v_pk_mul_f32 v[108:109], v[142:143], v[74:75] op_sel:[0,0] op_sel_hi:[0,1]
  v_pk_fma_f32 v[108:109], v[158:159], v[74:75], v[108:109] op_sel:[0,1,0] op_sel_hi:[0,0,1] neg_hi:[0,1,0]
  v_pk_mul_f32 v[108:109], v[108:109], v[238:239] op_sel:[0,0] op_sel_hi:[1,0]
  v_pk_fma_f32 v[250:251], v[248:249], v[64:65], v[108:109] op_sel:[0,0,0] op_sel_hi:[1,0,1]
  v_pk_fma_f32 v[250:251], v[248:249], v[64:65], v[250:251] op_sel:[1,1,0] op_sel_hi:[0,1,1] neg_lo:[0,1,0]
  v_pk_mul_f32 v[110:111], v[142:143], v[74:75] op_sel:[1,0] op_sel_hi:[1,1]
  v_pk_fma_f32 v[110:111], v[158:159], v[74:75], v[110:111] op_sel:[1,1,0] op_sel_hi:[1,0,1] neg_hi:[0,1,0]
  v_pk_mul_f32 v[110:111], v[110:111], v[238:239] op_sel:[0,1] op_sel_hi:[1,1]
  v_pk_fma_f32 v[248:249], v[250:251], v[64:65], v[110:111] op_sel:[0,0,0] op_sel_hi:[1,0,1]
  v_pk_fma_f32 v[248:249], v[250:251], v[64:65], v[248:249] op_sel:[1,1,0] op_sel_hi:[0,1,1] neg_lo:[0,1,0]
  ds_write_b64 v57, v[248:249] offset:896
  v_mfma_f32_16x16x32_bf16 v[44:47], v[32:35], v[116:119], v[44:47]
  v_mfma_f32_32x32x16_bf16 v[160:175], v[112:115], a[16:19], v[160:175]
  v_mfma_f32_32x32x16_bf16 v[192:207], v[112:115], a[20:23], v[192:207]
  v_mfma_f32_32x32x16_bf16 v[176:191], v[116:119], a[16:19], v[176:191]
  v_mfma_f32_32x32x16_bf16 v[208:223], v[116:119], a[20:23], v[208:223]
  s_waitcnt vmcnt(14)
  ds_read_b128 a[0:3], v56 offset:0
  ds_read_b128 a[4:7], v16 offset:0
  ds_read_b128 a[8:11], v28 offset:0
  s_add_u32 m0, s4, 32768
  s_xor_b32 s46, s73, 0
  buffer_load_dwordx4 v10, s[28:31], s46 offen offset:2048 lds
  buffer_load_dwordx4 v11, s[28:31], s46 offen offset:3072 lds
  s_waitcnt lgkmcnt(4)
  v_mfma_f32_32x32x16_bf16 v[160:175], v[120:123], a[24:27], v[160:175]
  s_waitcnt lgkmcnt(3)
  s_barrier
  ds_read_b64_tr_b16 v[112:113], v53 offset:32768
  ds_read_b64_tr_b16 v[114:115], v53 offset:33792
  ds_read_b64_tr_b16 v[116:117], v30 offset:32768
  ds_read_b64_tr_b16 v[118:119], v30 offset:33792
  ds_read_b64 v[128:129], v57 offset:0
  s_add_u32 m0, s44, 16384
  s_nop 0
  buffer_load_dwordx4 v52, s[16:19], s70 offen lds
  v_mfma_f32_32x32x16_bf16 v[192:207], v[120:123], a[28:31], v[192:207]
  ds_read_b64 v[130:131], v57 offset:128
  buffer_load_dwordx4 v13, s[16:19], s70 offen offset:1024 lds
  ds_read_b64 v[132:133], v57 offset:256
  v_mfma_f32_32x32x16_bf16 v[176:191], v[124:127], a[24:27], v[176:191]
  ds_read_b128 a[12:15], v4 offset:0
  ds_read_b64 v[134:135], v57 offset:384
  s_add_u32 m0, s4, 49152
  s_xor_b32 s46, s73, 32768
  buffer_load_dwordx4 v8, s[28:31], s46 offen offset:0 lds
  v_mfma_f32_32x32x16_bf16 v[208:223], v[124:127], a[28:31], v[208:223]
  ds_read_b64 v[136:137], v57 offset:512
  buffer_load_dwordx4 v9, s[28:31], s46 offen offset:1024 lds
  ds_read_b64 v[138:139], v57 offset:640
  ds_read_b64 v[140:141], v57 offset:768
  s_waitcnt lgkmcnt(8)
  v_mfma_f32_16x16x32_bf16 v[40:43], v[32:35], v[112:115], v[40:43]
  ds_read_b64_tr_b16 v[120:121], v29 offset:32768
  ds_read_b64_tr_b16 v[122:123], v29 offset:33792
  ds_read_b64_tr_b16 v[124:125], v31 offset:32768
  v_mfma_f32_16x16x32_bf16 v[44:47], v[32:35], v[116:119], v[44:47]
  ds_read_b64_tr_b16 v[126:127], v31 offset:33792
  v_cmp_eq_u32 vcc, 7, v58
  v_mfma_f32_32x32x16_bf16 v[160:175], v[112:115], a[32:35], v[160:175]
  v_mov_b32 v2, 0x80000000
  s_add_u32 m0, s4, 49152
  s_xor_b32 s46, s73, 32768
  buffer_load_dwordx4 v10, s[28:31], s46 offen offset:2048 lds
  v_mov_b32 v145, s58
  v_cndmask_b32 v2, v2, v59, vcc
  v_mfma_f32_32x32x16_bf16 v[192:207], v[112:115], a[36:39], v[192:207]
  buffer_load_dwordx4 v11, s[28:31], s46 offen offset:3072 lds
  v_mov_b32 v147, s58
  s_waitcnt lgkmcnt(4)
  v_pk_fma_f32 v[130:131], v[128:129], v[66:67], v[130:131] op_sel:[0,0,0] op_sel_hi:[1,0,1]
  v_pk_fma_f32 v[130:131], v[128:129], v[66:67], v[130:131] op_sel:[1,1,0] op_sel_hi:[0,1,1] neg_lo:[0,1,0]
  v_pk_fma_f32 v[132:133], v[130:131], v[66:67], v[132:133] op_sel:[0,0,0] op_sel_hi:[1,0,1]
  v_pk_fma_f32 v[132:133], v[130:131], v[66:67], v[132:133] op_sel:[1,1,0] op_sel_hi:[0,1,1] neg_lo:[0,1,0]
  v_pk_fma_f32 v[134:135], v[132:133], v[66:67], v[134:135] op_sel:[0,0,0] op_sel_hi:[1,0,1]
  v_pk_fma_f32 v[134:135], v[132:133], v[66:67], v[134:135] op_sel:[1,1,0] op_sel_hi:[0,1,1] neg_lo:[0,1,0]
  v_pk_fma_f32 v[136:137], v[134:135], v[66:67], v[136:137] op_sel:[0,0,0] op_sel_hi:[1,0,1]
  v_pk_fma_f32 v[136:137], v[134:135], v[66:67], v[136:137] op_sel:[1,1,0] op_sel_hi:[0,1,1] neg_lo:[0,1,0]
  v_pk_fma_f32 v[138:139], v[136:137], v[66:67], v[138:139] op_sel:[0,0,0] op_sel_hi:[1,0,1]
  v_pk_fma_f32 v[138:139], v[136:137], v[66:67], v[138:139] op_sel:[1,1,0] op_sel_hi:[0,1,1] neg_lo:[0,1,0]
  v_pk_fma_f32 v[252:253], v[138:139], v[66:67], v[140:141] op_sel:[0,0,0] op_sel_hi:[1,0,1]
  v_pk_fma_f32 v[252:253], v[138:139], v[66:67], v[252:253] op_sel:[1,1,0] op_sel_hi:[0,1,1] neg_lo:[0,1,0]
  v_pk_fma_f32 v[248:249], v[252:253], v[66:67], v[248:249] op_sel:[0,0,0] op_sel_hi:[1,0,1]
  v_pk_fma_f32 v[248:249], v[252:253], v[66:67], v[248:249] op_sel:[1,1,0] op_sel_hi:[0,1,1] neg_lo:[0,1,0]
  v_mov_b32 v144, v248
  v_mov_b32 v146, v249
  buffer_store_dwordx4 v[144:147], v2, s[20:23], s74 offen sc1
  v_mfma_f32_32x32x16_bf16 v[176:191], v[116:119], a[32:35], v[176:191]
  v_mfma_f32_32x32x16_bf16 v[208:223], v[116:119], a[36:39], v[208:223]
  s_waitcnt lgkmcnt(0)
  v_mfma_f32_32x32x16_bf16 v[160:175], v[120:123], a[40:43], v[160:175]
  ds_read_b64_tr_b16 v[112:113], v53 offset:40960
  ds_read_b64_tr_b16 v[114:115], v53 offset:41984
  ds_read_b64_tr_b16 v[116:117], v30 offset:40960
  ds_read_b64_tr_b16 v[118:119], v30 offset:41984
  v_and_b32 v1, 31, v0
  v_lshl_add_u32 v1, v1, 1, s88
  global_load_ushort v243, v1, s[56:57]
  v_mfma_f32_32x32x16_bf16 v[192:207], v[120:123], a[44:47], v[192:207]
  v_lshrrev_b32 v1, 4, v0
  s_add_u32 m0, s44, 16384
  s_nop 0
  buffer_load_dwordx4 v14, s[16:19], s70 offen offset:2048 lds
  v_lshlrev_b32 v1, 9, v1
  v_sub_u32 v1, v59, v1
  v_mfma_f32_32x32x16_bf16 v[176:191], v[124:127], a[40:43], v[176:191]
  v_subrev_u32 v148, 512, v1
  v_subrev_u32 v149, 2560, v1
  buffer_load_dwordx4 v15, s[16:19], s70 offen offset:3072 lds
  s_add_u32 s70, s70, 229376
  s_cmp_eq_u32 s70, 1835008
  s_cselect_b32 s70, 0, s70
  v_mfma_f32_32x32x16_bf16 v[208:223], v[124:127], a[44:47], v[208:223]
  v_subrev_u32 v150, 4608, v1
  v_subrev_u32 v151, 6656, v1
  v_cmp_le_i32 vcc, 0, v148
  s_nop 1
  v_cndmask_b32 v152, 0, v5, vcc
  v_cmp_le_i32 vcc, 0, v149
  s_nop 1
  v_cndmask_b32 v153, 0, v5, vcc
  s_waitcnt lgkmcnt(0)
  v_mfma_f32_16x16x32_bf16 v[40:43], v[32:35], v[112:115], v[40:43]
  ds_read_b64_tr_b16 v[120:121], v29 offset:40960
  ds_read_b64_tr_b16 v[122:123], v29 offset:41984
  v_mfma_f32_16x16x32_bf16 v[44:47], v[32:35], v[116:119], v[44:47]
  ds_read_b64_tr_b16 v[124:125], v31 offset:40960
  v_mfma_f32_32x32x16_bf16 v[160:175], v[112:115], a[48:51], v[160:175]
  ds_read_b64_tr_b16 v[126:127], v31 offset:41984
  v_cmp_le_i32 vcc, 0, v150
  s_add_u32 m0, s4, 0
  s_lshl_b32 s46, s93, 3
  buffer_load_dwordx4 v54, s[32:35], s46 offen offset:0 lds
  v_mfma_f32_32x32x16_bf16 v[192:207], v[112:115], a[52:55], v[192:207]
  v_mfma_f32_32x32x16_bf16 v[176:191], v[116:119], a[48:51], v[176:191]
  v_cndmask_b32 v154, 0, v5, vcc
  buffer_load_dwordx4 v17, s[32:35], s46 offen offset:1024 lds
  v_mfma_f32_32x32x16_bf16 v[208:223], v[116:119], a[52:55], v[208:223]
  v_cmp_le_i32 vcc, 0, v151
  s_nop 1
  v_cndmask_b32 v155, 0, v5, vcc
  s_waitcnt lgkmcnt(0)
  v_mfma_f32_32x32x16_bf16 v[160:175], v[120:123], a[56:59], v[160:175]
  s_waitcnt vmcnt(24)
  s_barrier
  ds_read_b64_tr_b16 v[112:113], v53 offset:49152
  ds_read_b64_tr_b16 v[114:115], v53 offset:50176
  ds_read_b64_tr_b16 v[116:117], v30 offset:49152
  ds_read_b64_tr_b16 v[118:119], v30 offset:50176
  s_add_u32 m0, s44, 32768
  s_nop 0
  buffer_load_dwordx4 v52, s[16:19], s70 offen lds
  v_mfma_f32_32x32x16_bf16 v[192:207], v[120:123], a[60:63], v[192:207]
  buffer_load_dwordx4 v13, s[16:19], s70 offen offset:1024 lds
  v_mfma_f32_32x32x16_bf16 v[176:191], v[124:127], a[56:59], v[176:191]
  s_add_u32 m0, s4, 2048
  s_lshl_b32 s46, s94, 3
  buffer_load_dwordx4 v54, s[32:35], s46 offen offset:0 lds
  v_mfma_f32_32x32x16_bf16 v[208:223], v[124:127], a[60:63], v[208:223]
  buffer_load_dwordx4 v17, s[32:35], s46 offen offset:1024 lds
  s_waitcnt lgkmcnt(0)
  v_mfma_f32_16x16x32_bf16 v[40:43], v[32:35], v[112:115], v[40:43]
  ds_read_b64_tr_b16 v[120:121], v29 offset:49152
  v_mfma_f32_16x16x32_bf16 v[44:47], v[32:35], v[116:119], v[44:47]
  v_mfma_f32_32x32x16_bf16 v[160:175], v[112:115], a[64:67], v[160:175]
  ds_read_b64_tr_b16 v[122:123], v29 offset:50176
  ds_read_b64_tr_b16 v[124:125], v31 offset:49152
  v_mfma_f32_32x32x16_bf16 v[192:207], v[112:115], a[68:71], v[192:207]
  ds_read_b64_tr_b16 v[126:127], v31 offset:50176
  v_mfma_f32_32x32x16_bf16 v[176:191], v[116:119], a[64:67], v[176:191]
  s_waitcnt vmcnt(24)
  ds_read_b128 a[16:19], v56 offset:16384
  ds_read_b128 a[20:23], v16 offset:16384
  v_mfma_f32_32x32x16_bf16 v[208:223], v[116:119], a[68:71], v[208:223]
  ds_read_b128 a[24:27], v28 offset:16384
  s_waitcnt lgkmcnt(3)
  v_mfma_f32_32x32x16_bf16 v[160:175], v[120:123], a[72:75], v[160:175]
  ds_read_b64_tr_b16 v[112:113], v53 offset:57344
  ds_read_b64_tr_b16 v[114:115], v53 offset:58368
  ds_read_b64_tr_b16 v[116:117], v30 offset:57344
  ds_read_b64_tr_b16 v[118:119], v30 offset:58368
  v_mfma_f32_32x32x16_bf16 v[192:207], v[120:123], a[76:79], v[192:207]
  s_add_u32 m0, s44, 32768
  s_nop 0
  buffer_load_dwordx4 v14, s[16:19], s70 offen offset:2048 lds
  v_mfma_f32_32x32x16_bf16 v[176:191], v[124:127], a[72:75], v[176:191]
  buffer_load_dwordx4 v15, s[16:19], s70 offen offset:3072 lds
  s_add_u32 s70, s70, 229376
  s_cmp_eq_u32 s70, 1835008
  s_cselect_b32 s70, 0, s70
  v_mfma_f32_32x32x16_bf16 v[208:223], v[124:127], a[76:79], v[208:223]
  ds_read_b128 a[28:31], v4 offset:16384
  s_waitcnt lgkmcnt(1)
  v_mfma_f32_16x16x32_bf16 v[40:43], v[32:35], v[112:115], v[40:43]
  ds_read_b64_tr_b16 v[120:121], v29 offset:57344
  v_mfma_f32_16x16x32_bf16 v[44:47], v[32:35], v[116:119], v[44:47]
  ds_read_b64_tr_b16 v[122:123], v29 offset:58368
  v_mfma_f32_32x32x16_bf16 v[160:175], v[112:115], a[80:83], v[160:175]
  ds_read_b64_tr_b16 v[124:125], v31 offset:57344
  ds_read_b64_tr_b16 v[126:127], v31 offset:58368
  buffer_load_dwordx4 v[128:131], v148, s[20:23], s74 offen sc1
  v_mfma_f32_32x32x16_bf16 v[192:207], v[112:115], a[84:87], v[192:207]
  s_waitcnt lgkmcnt(4)
  s_add_u32 m0, s4, 16384
  s_lshl_b32 s46, s95, 3
  buffer_load_dwordx4 v54, s[32:35], s46 offen offset:0 lds
  v_mfma_f32_32x32x16_bf16 v[176:191], v[116:119], a[80:83], v[176:191]
  buffer_load_dwordx4 v[132:135], v149, s[20:23], s74 offen sc1
  v_mfma_f32_32x32x16_bf16 v[208:223], v[116:119], a[84:87], v[208:223]
  buffer_load_dwordx4 v17, s[32:35], s46 offen offset:1024 lds
  s_waitcnt lgkmcnt(0)
  v_mfma_f32_32x32x16_bf16 v[160:175], v[120:123], a[88:91], v[160:175]
  s_waitcnt vmcnt(26)
  s_barrier
  ds_read_b64_tr_b16 v[112:113], v53 offset:0
  ds_read_b64_tr_b16 v[114:115], v53 offset:1024
  ds_read_b64_tr_b16 v[116:117], v30 offset:0
  ds_read_b64_tr_b16 v[118:119], v30 offset:1024
  v_mfma_f32_32x32x16_bf16 v[192:207], v[120:123], a[92:95], v[192:207]
  buffer_load_dwordx4 v[136:139], v150, s[20:23], s74 offen sc1
  s_add_u32 m0, s44, 49152
  s_nop 0
  buffer_load_dwordx4 v52, s[16:19], s70 offen lds
  v_mfma_f32_32x32x16_bf16 v[176:191], v[124:127], a[88:91], v[176:191]
  buffer_load_dwordx4 v[140:143], v151, s[20:23], s74 offen sc1
  buffer_load_dwordx4 v13, s[16:19], s70 offen offset:1024 lds
  v_mfma_f32_32x32x16_bf16 v[208:223], v[124:127], a[92:95], v[208:223]
  s_waitcnt vmcnt(26)
  ds_read_b128 a[32:35], v56 offset:32768
  ds_read_b128 a[36:39], v16 offset:32768
  ds_read_b128 a[40:43], v28 offset:32768
  s_waitcnt lgkmcnt(3)
  v_mfma_f32_16x16x32_bf16 v[40:43], v[32:35], v[112:115], v[40:43]
  ds_read_b64_tr_b16 v[120:121], v29 offset:0
  v_mfma_f32_16x16x32_bf16 v[44:47], v[32:35], v[116:119], v[44:47]
  ds_read_b64_tr_b16 v[122:123], v29 offset:1024
  v_mfma_f32_32x32x16_bf16 v[160:175], v[112:115], a[96:99], v[160:175]
  ds_read_b64_tr_b16 v[124:125], v31 offset:0
  ds_read_b64_tr_b16 v[126:127], v31 offset:1024
  ds_read_b128 a[44:47], v4 offset:32768
  v_mfma_f32_32x32x16_bf16 v[192:207], v[112:115], a[100:103], v[192:207]
  s_add_u32 m0, s4, 18432
  s_lshl_b32 s46, s96, 3
  buffer_load_dwordx4 v54, s[32:35], s46 offen offset:0 lds
  v_mfma_f32_32x32x16_bf16 v[176:191], v[116:119], a[96:99], v[176:191]
  buffer_load_dwordx4 v17, s[32:35], s46 offen offset:1024 lds
  v_mfma_f32_32x32x16_bf16 v[208:223], v[116:119], a[100:103], v[208:223]
  s_waitcnt lgkmcnt(1)
  v_mfma_f32_32x32x16_bf16 v[160:175], v[120:123], a[104:107], v[160:175]
  ds_read_b64_tr_b16 v[112:113], v53 offset:8192
  ds_read_b64_tr_b16 v[114:115], v53 offset:9216
  ds_read_b64_tr_b16 v[116:117], v30 offset:8192
  ds_read_b64_tr_b16 v[118:119], v30 offset:9216
  s_add_u32 m0, s44, 49152
  s_nop 0
  buffer_load_dwordx4 v14, s[16:19], s70 offen offset:2048 lds
  v_mfma_f32_32x32x16_bf16 v[192:207], v[120:123], a[108:111], v[192:207]
  buffer_load_dwordx4 v15, s[16:19], s70 offen offset:3072 lds
  s_add_u32 s70, s70, 229376
  s_cmp_eq_u32 s70, 1835008
  s_cselect_b32 s70, 0, s70
  v_mfma_f32_32x32x16_bf16 v[176:191], v[124:127], a[104:107], v[176:191]
  s_waitcnt vmcnt(24)
  ds_read_b128 a[48:51], v56 offset:49152
  ds_read_b128 a[52:55], v16 offset:49152
  ds_read_b128 a[56:59], v28 offset:49152
  s_waitcnt lgkmcnt(7)
  s_add_u32 m0, s4, 32768
  s_lshl_b32 s46, s97, 3
  buffer_load_dwordx4 v54, s[32:35], s46 offen offset:0 lds
  v_mfma_f32_32x32x16_bf16 v[208:223], v[124:127], a[108:111], v[208:223]
  buffer_load_dwordx4 v17, s[32:35], s46 offen offset:1024 lds
  s_waitcnt lgkmcnt(3)
  v_mfma_f32_16x16x32_bf16 v[40:43], v[32:35], v[112:115], v[40:43]
  ds_read_b64_tr_b16 v[120:121], v29 offset:8192
  v_mfma_f32_16x16x32_bf16 v[44:47], v[32:35], v[116:119], v[44:47]
  ds_read_b64_tr_b16 v[122:123], v29 offset:9216
  v_mfma_f32_32x32x16_bf16 v[160:175], v[112:115], a[112:115], v[160:175]
  ds_read_b64_tr_b16 v[124:125], v31 offset:8192
  ds_read_b64_tr_b16 v[126:127], v31 offset:9216
  ds_read_b128 a[60:63], v4 offset:49152
  v_mfma_f32_32x32x16_bf16 v[192:207], v[112:115], a[116:119], v[192:207]
  s_add_u32 m0, s4, 34816
  s_lshl_b32 s46, s98, 3
  buffer_load_dwordx4 v54, s[32:35], s46 offen offset:0 lds
  v_mfma_f32_32x32x16_bf16 v[176:191], v[116:119], a[112:115], v[176:191]
  buffer_load_dwordx4 v17, s[32:35], s46 offen offset:1024 lds
  v_mfma_f32_32x32x16_bf16 v[208:223], v[116:119], a[116:119], v[208:223]
  s_waitcnt lgkmcnt(1)
  v_mfma_f32_32x32x16_bf16 v[160:175], v[120:123], a[120:123], v[160:175]
  s_waitcnt vmcnt(24)
  s_barrier
  ds_read_b64_tr_b16 v[112:113], v53 offset:16384
  ds_read_b64_tr_b16 v[114:115], v53 offset:17408
  ds_read_b64_tr_b16 v[116:117], v30 offset:16384
  ds_read_b64_tr_b16 v[118:119], v30 offset:17408
  s_mov_b32 s48, 0
  s_waitcnt vmcnt(9)
L_lb:
  v_mov_b32 v3, 0
  v_xor_b32 v1, v129, v152
  v_xor_b32 v2, v131, v152
  v_or3_b32 v3, v1, v2, v3
  v_xor_b32 v1, v133, v153
  v_xor_b32 v2, v135, v153
  v_or3_b32 v3, v1, v2, v3
  v_xor_b32 v1, v137, v154
  v_xor_b32 v2, v139, v154
  v_or3_b32 v3, v1, v2, v3
  v_xor_b32 v1, v141, v155
  v_xor_b32 v2, v143, v155
  v_or3_b32 v3, v1, v2, v3
  v_cmp_ne_u32 vcc, 0, v3
  s_cbranch_vccz L_lb_ok
  buffer_load_dwordx4 v[128:131], v148, s[20:23], s74 offen sc1
  buffer_load_dwordx4 v[132:135], v149, s[20:23], s74 offen sc1
  buffer_load_dwordx4 v[136:139], v150, s[20:23], s74 offen sc1
  buffer_load_dwordx4 v[140:143], v151, s[20:23], s74 offen sc1
  s_add_u32 s48, s48, 1
  s_waitcnt vmcnt(0)
  s_cmp_lt_u32 s48, 0x20000
  s_cbranch_scc1 L_lb
L_lb_ok:
  s_nop 0
  v_mov_b32 v129, v130
  v_mov_b32 v133, v134
  v_mov_b32 v137, v138
  v_mov_b32 v141, v142
  v_pk_fma_f32 v[136:137], v[140:141], v[72:73], v[136:137] op_sel:[0,0,0] op_sel_hi:[1,0,1]
  v_pk_fma_f32 v[136:137], v[140:141], v[72:73], v[136:137] op_sel:[1,1,0] op_sel_hi:[0,1,1] neg_lo:[0,1,0]
  v_pk_fma_f32 v[132:133], v[136:137], v[72:73], v[132:133] op_sel:[0,0,0] op_sel_hi:[1,0,1]
  v_pk_fma_f32 v[132:133], v[136:137], v[72:73], v[132:133] op_sel:[1,1,0] op_sel_hi:[0,1,1] neg_lo:[0,1,0]
  v_pk_fma_f32 v[128:129], v[132:133], v[72:73], v[128:129] op_sel:[0,0,0] op_sel_hi:[1,0,1]
  v_pk_fma_f32 v[128:129], v[132:133], v[72:73], v[128:129] op_sel:[1,1,0] op_sel_hi:[0,1,1] neg_lo:[0,1,0]
  v_pk_mul_f32 v[248:249], v[128:129], v[70:71] op_sel:[0,0] op_sel_hi:[1,0]
  v_pk_fma_f32 v[248:249], v[128:129], v[70:71], v[248:249] op_sel:[1,1,0] op_sel_hi:[0,1,1] neg_lo:[0,1,0]
  v_mov_b32 v250, v248
  v_mov_b32 v251, v249
  v_xor_b32 v2, 16, v60
  v_permlane16_swap_b32 v248, v250
  v_permlane16_swap_b32 v249, v251
  v_pk_add_f32 v[248:249], v[248:249], v[250:251]
  v_mov_b32 v250, v248
  v_mov_b32 v251, v249
  v_xor_b32 v2, 16, v60
  v_permlane32_swap_b32 v248, v250
  v_permlane32_swap_b32 v249, v251
  v_pk_add_f32 v[248:249], v[248:249], v[250:251]
  v_pk_fma_f32 v[252:253], v[248:249], v[68:69], v[252:253] op_sel:[0,0,0] op_sel_hi:[1,0,1]
  v_pk_fma_f32 v[252:253], v[248:249], v[68:69], v[252:253] op_sel:[1,1,0] op_sel_hi:[0,1,1] neg_lo:[0,1,0]
  v_pk_fma_f32 v[80:81], v[252:253], v[64:65], v[80:81] op_sel:[0,0,0] op_sel_hi:[1,0,1]
  v_pk_fma_f32 v[80:81], v[252:253], v[64:65], v[80:81] op_sel:[1,1,0] op_sel_hi:[0,1,1] neg_lo:[0,1,0]
  v_pk_fma_f32 v[82:83], v[80:81], v[64:65], v[82:83] op_sel:[0,0,0] op_sel_hi:[1,0,1]
  v_pk_fma_f32 v[82:83], v[80:81], v[64:65], v[82:83] op_sel:[1,1,0] op_sel_hi:[0,1,1] neg_lo:[0,1,0]
  v_pk_fma_f32 v[84:85], v[82:83], v[64:65], v[84:85] op_sel:[0,0,0] op_sel_hi:[1,0,1]
  v_pk_fma_f32 v[84:85], v[82:83], v[64:65], v[84:85] op_sel:[1,1,0] op_sel_hi:[0,1,1] neg_lo:[0,1,0]
  v_pk_fma_f32 v[86:87], v[84:85], v[64:65], v[86:87] op_sel:[0,0,0] op_sel_hi:[1,0,1]
  v_pk_fma_f32 v[86:87], v[84:85], v[64:65], v[86:87] op_sel:[1,1,0] op_sel_hi:[0,1,1] neg_lo:[0,1,0]
  v_pk_fma_f32 v[88:89], v[86:87], v[64:65], v[88:89] op_sel:[0,0,0] op_sel_hi:[1,0,1]
  v_pk_fma_f32 v[88:89], v[86:87], v[64:65], v[88:89] op_sel:[1,1,0] op_sel_hi:[0,1,1] neg_lo:[0,1,0]
  v_pk_fma_f32 v[90:91], v[88:89], v[64:65], v[90:91] op_sel:[0,0,0] op_sel_hi:[1,0,1]
  v_pk_fma_f32 v[90:91], v[88:89], v[64:65], v[90:91] op_sel:[1,1,0] op_sel_hi:[0,1,1] neg_lo:[0,1,0]
  v_pk_fma_f32 v[92:93], v[90:91], v[64:65], v[92:93] op_sel:[0,0,0] op_sel_hi:[1,0,1]
  v_pk_fma_f32 v[92:93], v[90:91], v[64:65], v[92:93] op_sel:[1,1,0] op_sel_hi:[0,1,1] neg_lo:[0,1,0]
  v_pk_fma_f32 v[94:95], v[92:93], v[64:65], v[94:95] op_sel:[0,0,0] op_sel_hi:[1,0,1]
  v_pk_fma_f32 v[94:95], v[92:93], v[64:65], v[94:95] op_sel:[1,1,0] op_sel_hi:[0,1,1] neg_lo:[0,1,0]
  v_pk_fma_f32 v[96:97], v[94:95], v[64:65], v[96:97] op_sel:[0,0,0] op_sel_hi:[1,0,1]
  v_pk_fma_f32 v[96:97], v[94:95], v[64:65], v[96:97] op_sel:[1,1,0] op_sel_hi:[0,1,1] neg_lo:[0,1,0]
  v_pk_fma_f32 v[98:99], v[96:97], v[64:65], v[98:99] op_sel:[0,0,0] op_sel_hi:[1,0,1]
  v_pk_fma_f32 v[98:99], v[96:97], v[64:65], v[98:99] op_sel:[1,1,0] op_sel_hi:[0,1,1] neg_lo:[0,1,0]
  v_pk_fma_f32 v[100:101], v[98:99], v[64:65], v[100:101] op_sel:[0,0,0] op_sel_hi:[1,0,1]
  v_pk_fma_f32 v[100:101], v[98:99], v[64:65], v[100:101] op_sel:[1,1,0] op_sel_hi:[0,1,1] neg_lo:[0,1,0]
  v_pk_fma_f32 v[102:103], v[100:101], v[64:65], v[102:103] op_sel:[0,0,0] op_sel_hi:[1,0,1]
  v_pk_fma_f32 v[102:103], v[100:101], v[64:65], v[102:103] op_sel:[1,1,0] op_sel_hi:[0,1,1] neg_lo:[0,1,0]
  v_pk_fma_f32 v[104:105], v[102:103], v[64:65], v[104:105] op_sel:[0,0,0] op_sel_hi:[1,0,1]
  v_pk_fma_f32 v[104:105], v[102:103], v[64:65], v[104:105] op_sel:[1,1,0] op_sel_hi:[0,1,1] neg_lo:[0,1,0]
  v_pk_fma_f32 v[106:107], v[104:105], v[64:65], v[106:107] op_sel:[0,0,0] op_sel_hi:[1,0,1]
  v_pk_fma_f32 v[106:107], v[104:105], v[64:65], v[106:107] op_sel:[1,1,0] op_sel_hi:[0,1,1] neg_lo:[0,1,0]
  v_pk_fma_f32 v[108:109], v[106:107], v[64:65], v[108:109] op_sel:[0,0,0] op_sel_hi:[1,0,1]
  v_pk_fma_f32 v[108:109], v[106:107], v[64:65], v[108:109] op_sel:[1,1,0] op_sel_hi:[0,1,1] neg_lo:[0,1,0]
  v_pk_fma_f32 v[110:111], v[108:109], v[64:65], v[110:111] op_sel:[0,0,0] op_sel_hi:[1,0,1]
  v_pk_fma_f32 v[110:111], v[108:109], v[64:65], v[110:111] op_sel:[1,1,0] op_sel_hi:[0,1,1] neg_lo:[0,1,0]
  v_mfma_f32_32x32x16_bf16 v[192:207], v[120:123], a[124:127], v[192:207]
  v_mfma_f32_32x32x16_bf16 v[176:191], v[124:127], a[120:123], v[176:191]
  v_mfma_f32_32x32x16_bf16 v[208:223], v[124:127], a[124:127], v[208:223]
  s_add_u32 m0, s44, 0
  s_nop 0
  buffer_load_dwordx4 v52, s[16:19], s70 offen lds
  buffer_load_dwordx4 v13, s[16:19], s70 offen offset:1024 lds
  s_waitcnt lgkmcnt(4)
  s_add_u32 m0, s4, 49152
  s_lshl_b32 s46, s99, 3
  buffer_load_dwordx4 v54, s[32:35], s46 offen offset:0 lds
  buffer_load_dwordx4 v17, s[32:35], s46 offen offset:1024 lds
  s_waitcnt lgkmcnt(0)
  v_mfma_f32_16x16x32_bf16 v[40:43], v[32:35], v[112:115], v[40:43]
  ds_read_b64_tr_b16 v[120:121], v29 offset:16384
  ds_read_b64_tr_b16 v[122:123], v29 offset:17408
  v_mfma_f32_16x16x32_bf16 v[44:47], v[32:35], v[116:119], v[44:47]
  ds_read_b64_tr_b16 v[124:125], v31 offset:16384
  ds_read_b64_tr_b16 v[126:127], v31 offset:17408
  v_mfma_f32_32x32x16_bf16 v[160:175], v[112:115], a[128:131], v[160:175]
  v_cvt_pk_bf16_f32 v144, v80, v82
  v_cvt_pk_bf16_f32 v152, v81, v83
  v_cvt_pk_bf16_f32 v145, v84, v86
  s_add_u32 m0, s4, 51200
  s_lshl_b32 s46, s93, 3
  s_add_u32 s46, s46, 32768
  buffer_load_dwordx4 v54, s[32:35], s46 offen offset:0 lds
  v_mfma_f32_32x32x16_bf16 v[192:207], v[112:115], a[132:135], v[192:207]
  v_cvt_pk_bf16_f32 v153, v85, v87
  v_mfma_f32_32x32x16_bf16 v[176:191], v[116:119], a[128:131], v[176:191]
  v_cvt_pk_bf16_f32 v146, v88, v90
  v_cvt_pk_bf16_f32 v154, v89, v91
  buffer_load_dwordx4 v17, s[32:35], s46 offen offset:1024 lds
  v_mfma_f32_32x32x16_bf16 v[208:223], v[116:119], a[132:135], v[208:223]
  v_cvt_pk_bf16_f32 v147, v92, v94
  v_cvt_pk_bf16_f32 v155, v93, v95
  ds_write_b128 v60, v[144:147]
  v_cvt_pk_bf16_f32 v148, v96, v98
  v_cvt_pk_bf16_f32 v156, v97, v99
  s_waitcnt lgkmcnt(1)
  v_mfma_f32_32x32x16_bf16 v[160:175], v[120:123], a[136:139], v[160:175]
  ds_read_b64_tr_b16 v[112:113], v53 offset:24576
  ds_read_b64_tr_b16 v[114:115], v53 offset:25600
  ds_read_b64_tr_b16 v[116:117], v30 offset:24576
  ds_read_b64_tr_b16 v[118:119], v30 offset:25600
  v_cvt_pk_bf16_f32 v149, v100, v102
  v_cvt_pk_bf16_f32 v157, v101, v103
  v_mfma_f32_32x32x16_bf16 v[192:207], v[120:123], a[140:143], v[192:207]
  s_add_u32 m0, s44, 0
  s_nop 0
  buffer_load_dwordx4 v14, s[16:19], s70 offen offset:2048 lds
  ds_write_b128 v60, v[152:155] offset:2048
  v_mfma_f32_32x32x16_bf16 v[176:191], v[124:127], a[136:139], v[176:191]
  v_cvt_pk_bf16_f32 v150, v104, v106
  buffer_load_dwordx4 v15, s[16:19], s70 offen offset:3072 lds
  s_add_u32 s70, s70, 229376
  s_cmp_eq_u32 s70, 1835008
  s_cselect_b32 s70, 0, s70
  v_mfma_f32_32x32x16_bf16 v[208:223], v[124:127], a[140:143], v[208:223]
  v_cvt_pk_bf16_f32 v158, v105, v107
  v_cvt_pk_bf16_f32 v151, v108, v110
  v_cvt_pk_bf16_f32 v159, v109, v111
  ds_write_b128 v2, v[148:151]
  s_waitcnt lgkmcnt(2)
  v_mfma_f32_16x16x32_bf16 v[40:43], v[32:35], v[112:115], v[40:43]
  ds_read_b64_tr_b16 v[120:121], v29 offset:24576
  v_mfma_f32_16x16x32_bf16 v[44:47], v[32:35], v[116:119], v[44:47]
  ds_read_b64_tr_b16 v[122:123], v29 offset:25600
  v_mfma_f32_32x32x16_bf16 v[160:175], v[112:115], a[144:147], v[160:175]
  ds_read_b64_tr_b16 v[124:125], v31 offset:24576
  ds_read_b64_tr_b16 v[126:127], v31 offset:25600
  v_mfma_f32_32x32x16_bf16 v[192:207], v[112:115], a[148:151], v[192:207]
  ds_write_b128 v2, v[156:159] offset:2048
  ds_read_b64_tr_b16 v[128:129], v61 offset:0
  v_mfma_f32_32x32x16_bf16 v[176:191], v[116:119], a[144:147], v[176:191]
  ds_read_b64_tr_b16 v[130:131], v61 offset:576
  ds_read_b64_tr_b16 v[132:133], v61 offset:64
  v_mfma_f32_32x32x16_bf16 v[208:223], v[116:119], a[148:151], v[208:223]
  ds_read_b64_tr_b16 v[134:135], v61 offset:512
  ds_read_b64_tr_b16 v[136:137], v61 offset:2048
  s_waitcnt lgkmcnt(6)
  v_mfma_f32_32x32x16_bf16 v[160:175], v[120:123], a[152:155], v[160:175]
  s_barrier
  ds_read_b64_tr_b16 v[112:113], v53 offset:32768
  ds_read_b64_tr_b16 v[114:115], v53 offset:33792
  ds_read_b64_tr_b16 v[116:117], v30 offset:32768
  v_mfma_f32_32x32x16_bf16 v[192:207], v[120:123], a[156:159], v[192:207]
  ds_read_b64_tr_b16 v[118:119], v30 offset:33792
  ds_read_b64_tr_b16 v[138:139], v61 offset:2624
  v_mfma_f32_32x32x16_bf16 v[176:191], v[124:127], a[152:155], v[176:191]
  ds_read_b64_tr_b16 a[64:65], v55 offset:0
  ds_read_b64_tr_b16 v[140:141], v61 offset:2112
  ds_read_b64_tr_b16 a[66:67], v55 offset:1024
  v_mfma_f32_32x32x16_bf16 v[208:223], v[124:127], a[156:159], v[208:223]
  ds_read_b64_tr_b16 v[142:143], v61 offset:2560
  ds_read_b64_tr_b16 a[68:69], v12 offset:0
  s_waitcnt lgkmcnt(6)
  v_mfma_f32_16x16x32_bf16 v[40:43], v[32:35], v[112:115], v[40:43]
  ds_read_b64_tr_b16 v[120:121], v29 offset:32768
  v_mfma_f32_16x16x32_bf16 v[44:47], v[32:35], v[116:119], v[44:47]
  ds_read_b64_tr_b16 v[122:123], v29 offset:33792
  v_mfma_f32_32x32x16_bf16 v[160:175], v[112:115], a[160:163], v[160:175]
  ds_read_b64_tr_b16 v[124:125], v31 offset:32768
  ds_read_b64_tr_b16 v[126:127], v31 offset:33792
  v_mfma_f32_32x32x16_bf16 v[192:207], v[112:115], a[164:167], v[192:207]
  buffer_store_dwordx4 v[128:131], v63, s[20:23], s76 offen offset:0 sc1
  ds_read_b64_tr_b16 a[70:71], v12 offset:1024
  v_mfma_f32_32x32x16_bf16 v[176:191], v[116:119], a[160:163], v[176:191]
  buffer_store_dwordx4 v[132:135], v63, s[20:23], s76 offen offset:1024 sc1
  ds_read_b64_tr_b16 a[72:73], v55 offset:2048
  v_mfma_f32_32x32x16_bf16 v[208:223], v[116:119], a[164:167], v[208:223]
  ds_read_b64_tr_b16 a[74:75], v55 offset:3072
  s_waitcnt lgkmcnt(3)
  v_mfma_f32_32x32x16_bf16 v[160:175], v[120:123], a[168:171], v[160:175]
  ds_read_b64_tr_b16 v[112:113], v53 offset:40960
  ds_read_b64_tr_b16 v[114:115], v53 offset:41984
  v_mfma_f32_32x32x16_bf16 v[192:207], v[120:123], a[172:175], v[192:207]
  ds_read_b64_tr_b16 v[116:117], v30 offset:40960
  ds_read_b64_tr_b16 v[118:119], v30 offset:41984
  v_mfma_f32_32x32x16_bf16 v[176:191], v[124:127], a[168:171], v[176:191]
  buffer_store_dwordx4 v[136:139], v63, s[20:23], s76 offen offset:2048 sc1
  ds_read_b64_tr_b16 a[76:77], v12 offset:2048
  v_mfma_f32_32x32x16_bf16 v[208:223], v[124:127], a[172:175], v[208:223]
  buffer_store_dwordx4 v[140:143], v63, s[20:23], s76 offen offset:3072 sc1
  ds_read_b64_tr_b16 a[78:79], v12 offset:3072
  s_waitcnt lgkmcnt(2)
  v_mfma_f32_16x16x32_bf16 v[40:43], v[32:35], v[112:115], v[40:43]
  ds_read_b64_tr_b16 v[120:121], v29 offset:40960
  v_mfma_f32_16x16x32_bf16 v[44:47], v[32:35], v[116:119], v[44:47]
  ds_read_b64_tr_b16 v[122:123], v29 offset:41984
  v_mfma_f32_32x32x16_bf16 v[160:175], v[112:115], a[176:179], v[160:175]
  ds_read_b64_tr_b16 v[124:125], v31 offset:40960
  ds_read_b64_tr_b16 v[126:127], v31 offset:41984
  s_waitcnt lgkmcnt(4)
  s_add_u32 m0, s4, 0
  s_lshl_b32 s46, s94, 3
  s_add_u32 s46, s46, 32768
  buffer_load_dwordx4 v54, s[32:35], s46 offen offset:0 lds
  v_mfma_f32_32x32x16_bf16 v[192:207], v[112:115], a[180:183], v[192:207]
  v_mfma_f32_32x32x16_bf16 v[176:191], v[116:119], a[176:179], v[176:191]
  buffer_load_dwordx4 v17, s[32:35], s46 offen offset:1024 lds
  v_mfma_f32_32x32x16_bf16 v[208:223], v[116:119], a[180:183], v[208:223]
  s_waitcnt lgkmcnt(0)
  v_mfma_f32_32x32x16_bf16 v[160:175], v[120:123], a[184:187], v[160:175]
  s_waitcnt vmcnt(18)
  s_barrier
  ds_read_b64_tr_b16 v[112:113], v53 offset:49152
  ds_read_b64_tr_b16 v[114:115], v53 offset:50176
  ds_read_b64_tr_b16 v[116:117], v30 offset:49152
  ds_read_b64_tr_b16 v[118:119], v30 offset:50176
  v_mfma_f32_32x32x16_bf16 v[192:207], v[120:123], a[188:191], v[192:207]
  s_add_u32 m0, s4, 2048
  s_lshl_b32 s46, s95, 3
  s_add_u32 s46, s46, 32768
  buffer_load_dwordx4 v54, s[32:35], s46 offen offset:0 lds
  v_mfma_f32_32x32x16_bf16 v[176:191], v[124:127], a[184:187], v[176:191]
  v_mfma_f32_32x32x16_bf16 v[208:223], v[124:127], a[188:191], v[208:223]
  buffer_load_dwordx4 v17, s[32:35], s46 offen offset:1024 lds
  s_waitcnt lgkmcnt(0)
  v_mfma_f32_16x16x32_bf16 v[40:43], v[32:35], v[112:115], v[40:43]
  ds_read_b64_tr_b16 v[120:121], v29 offset:49152
  v_mfma_f32_16x16x32_bf16 v[44:47], v[32:35], v[116:119], v[44:47]
  v_mfma_f32_32x32x16_bf16 v[160:175], v[112:115], a[192:195], v[160:175]
  ds_read_b64_tr_b16 v[122:123], v29 offset:50176
  ds_read_b64_tr_b16 v[124:125], v31 offset:49152
  v_mfma_f32_32x32x16_bf16 v[192:207], v[112:115], a[196:199], v[192:207]
  ds_read_b64_tr_b16 v[126:127], v31 offset:50176
  v_mfma_f32_32x32x16_bf16 v[176:191], v[116:119], a[192:195], v[176:191]
  ds_read_b64_tr_b16 a[80:81], v55 offset:16384
  ds_read_b64_tr_b16 a[82:83], v55 offset:17408
  v_mfma_f32_32x32x16_bf16 v[208:223], v[116:119], a[196:199], v[208:223]
  ds_read_b64_tr_b16 a[84:85], v12 offset:16384
  s_waitcnt lgkmcnt(3)
  v_mfma_f32_32x32x16_bf16 v[160:175], v[120:123], a[200:203], v[160:175]
  ds_read_b64_tr_b16 v[112:113], v53 offset:57344
  ds_read_b64_tr_b16 v[114:115], v53 offset:58368
  v_mfma_f32_32x32x16_bf16 v[192:207], v[120:123], a[204:207], v[192:207]
  ds_read_b64_tr_b16 v[116:117], v30 offset:57344
  ds_read_b64_tr_b16 v[118:119], v30 offset:58368
  v_mfma_f32_32x32x16_bf16 v[176:191], v[124:127], a[200:203], v[176:191]
  ds_read_b64_tr_b16 a[86:87], v12 offset:17408
  ds_read_b64_tr_b16 a[88:89], v55 offset:18432
  v_mfma_f32_32x32x16_bf16 v[208:223], v[124:127], a[204:207], v[208:223]
  ds_read_b64_tr_b16 a[90:91], v55 offset:19456
  s_waitcnt lgkmcnt(3)
  v_mfma_f32_16x16x32_bf16 v[40:43], v[32:35], v[112:115], v[40:43]
  ds_read_b64_tr_b16 v[120:121], v29 offset:57344
  v_mfma_f32_16x16x32_bf16 v[44:47], v[32:35], v[116:119], v[44:47]
  ds_read_b64_tr_b16 v[122:123], v29 offset:58368
  v_mfma_f32_32x32x16_bf16 v[160:175], v[112:115], a[208:211], v[160:175]
  ds_read_b64_tr_b16 v[124:125], v31 offset:57344
  ds_read_b64_tr_b16 v[126:127], v31 offset:58368
  v_mfma_f32_32x32x16_bf16 v[192:207], v[112:115], a[212:215], v[192:207]
  s_waitcnt vmcnt(4)
  buffer_store_dword v5, v76, s[20:23], s79 offen sc1
  ds_read_b64_tr_b16 a[92:93], v12 offset:18432
  v_mfma_f32_32x32x16_bf16 v[176:191], v[116:119], a[208:211], v[176:191]
  ds_read_b64_tr_b16 a[94:95], v12 offset:19456
  ds_write_b32 v240, v40 offset:0
  v_mfma_f32_32x32x16_bf16 v[208:223], v[116:119], a[212:215], v[208:223]
  ds_write_b32 v240, v44 offset:256
  s_waitcnt lgkmcnt(4)
  v_mfma_f32_32x32x16_bf16 v[160:175], v[120:123], a[216:219], v[160:175]
  s_waitcnt lgkmcnt(0)
  s_barrier
  ds_read_b64_tr_b16 v[112:113], v53 offset:0
  ds_read_b64_tr_b16 v[114:115], v53 offset:1024
  ds_read_b64_tr_b16 v[116:117], v30 offset:0
  ds_read_b64_tr_b16 v[118:119], v30 offset:1024
  ds_read_b64_tr_b16 a[96:97], v55 offset:32768
  v_mfma_f32_32x32x16_bf16 v[192:207], v[120:123], a[220:223], v[192:207]
  ds_read_b64_tr_b16 a[98:99], v55 offset:33792
  ds_read_b64_tr_b16 a[100:101], v12 offset:32768
  s_add_u32 m0, s4, 16384
  s_lshl_b32 s46, s96, 3
  s_add_u32 s46, s46, 32768
  buffer_load_dwordx4 v54, s[32:35], s46 offen offset:0 lds
  v_mfma_f32_32x32x16_bf16 v[176:191], v[124:127], a[216:219], v[176:191]
  buffer_load_dwordx4 v17, s[32:35], s46 offen offset:1024 lds
  v_mfma_f32_32x32x16_bf16 v[208:223], v[124:127], a[220:223], v[208:223]
  ds_read_b32 v254, v50 offset:0
  ds_read_b32 v255, v50 offset:256
  s_waitcnt lgkmcnt(5)
  v_mfma_f32_16x16x32_bf16 v[40:43], v[32:35], v[112:115], v[40:43]
  ds_read_b64_tr_b16 v[120:121], v29 offset:0
  ds_read_b64_tr_b16 v[122:123], v29 offset:1024
  v_mfma_f32_16x16x32_bf16 v[44:47], v[32:35], v[116:119], v[44:47]
  ds_read_b64_tr_b16 v[124:125], v31 offset:0
  v_mfma_f32_32x32x16_bf16 v[160:175], v[112:115], a[224:227], v[160:175]
  ds_read_b64_tr_b16 v[126:127], v31 offset:1024
  ds_read_b64_tr_b16 a[102:103], v12 offset:33792
  ds_read_b64_tr_b16 a[104:105], v55 offset:34816
  v_mfma_f32_32x32x16_bf16 v[192:207], v[112:115], a[228:231], v[192:207]
  ds_read_b64_tr_b16 a[106:107], v55 offset:35840
  s_add_u32 m0, s4, 18432
  s_lshl_b32 s46, s97, 3
  s_add_u32 s46, s46, 32768
  buffer_load_dwordx4 v54, s[32:35], s46 offen offset:0 lds
  v_mfma_f32_32x32x16_bf16 v[176:191], v[116:119], a[224:227], v[176:191]
  v_mfma_f32_32x32x16_bf16 v[208:223], v[116:119], a[228:231], v[208:223]
  buffer_load_dwordx4 v17, s[32:35], s46 offen offset:1024 lds
  s_waitcnt lgkmcnt(3)
  v_mfma_f32_16x16x32_bf16 v[40:43], v[32:35], v[120:123], v[40:43]
  ds_read_b64_tr_b16 v[112:113], v53 offset:8192
  v_mfma_f32_16x16x32_bf16 v[44:47], v[32:35], v[124:127], v[44:47]
  v_mfma_f32_32x32x16_bf16 v[160:175], v[120:123], a[232:235], v[160:175]
  ds_read_b64_tr_b16 v[114:115], v53 offset:9216
  ds_read_b64_tr_b16 v[116:117], v30 offset:8192
  v_mfma_f32_32x32x16_bf16 v[192:207], v[120:123], a[236:239], v[192:207]
  ds_read_b64_tr_b16 v[118:119], v30 offset:9216
  v_mfma_f32_32x32x16_bf16 v[176:191], v[124:127], a[232:235], v[176:191]
  ds_read_b64_tr_b16 a[108:109], v12 offset:34816
  v_mfma_f32_32x32x16_bf16 v[208:223], v[124:127], a[236:239], v[208:223]
  ds_read_b64_tr_b16 a[110:111], v12 offset:35840
  s_waitcnt lgkmcnt(2)
  v_mfma_f32_16x16x32_bf16 v[40:43], v[32:35], v[112:115], v[40:43]
  ds_read_b64_tr_b16 v[120:121], v29 offset:8192
  v_mfma_f32_16x16x32_bf16 v[44:47], v[32:35], v[116:119], v[44:47]
  ds_read_b64_tr_b16 v[122:123], v29 offset:9216
  v_mfma_f32_32x32x16_bf16 v[160:175], v[112:115], a[240:243], v[160:175]
  ds_read_b64_tr_b16 v[124:125], v31 offset:8192
  ds_read_b64_tr_b16 v[126:127], v31 offset:9216
  s_waitcnt lgkmcnt(4)
  s_add_u32 m0, s4, 32768
  s_lshl_b32 s46, s98, 3
  s_add_u32 s46, s46, 32768
  buffer_load_dwordx4 v54, s[32:35], s46 offen offset:0 lds
  v_mfma_f32_32x32x16_bf16 v[192:207], v[112:115], a[244:247], v[192:207]
  v_mfma_f32_32x32x16_bf16 v[176:191], v[116:119], a[240:243], v[176:191]
  buffer_load_dwordx4 v17, s[32:35], s46 offen offset:1024 lds
  v_mfma_f32_32x32x16_bf16 v[208:223], v[116:119], a[244:247], v[208:223]
  s_waitcnt lgkmcnt(0)
  v_mfma_f32_16x16x32_bf16 v[40:43], v[32:35], v[120:123], v[40:43]
  s_add_u32 m0, s4, 34816
  s_lshl_b32 s46, s99, 3
  s_add_u32 s46, s46, 32768
  buffer_load_dwordx4 v54, s[32:35], s46 offen offset:0 lds
  v_mfma_f32_16x16x32_bf16 v[44:47], v[32:35], v[124:127], v[44:47]
  v_mfma_f32_32x32x16_bf16 v[160:175], v[120:123], a[248:251], v[160:175]
  buffer_load_dwordx4 v17, s[32:35], s46 offen offset:1024 lds
  v_mfma_f32_32x32x16_bf16 v[192:207], v[120:123], a[252:255], v[192:207]
  s_nop 2
  s_nop 2
  v_add_f32 v37, v40, v254
  v_mfma_f32_32x32x16_bf16 v[176:191], v[124:127], a[248:251], v[176:191]
  v_and_b32 v36, s42, v37
  v_sub_f32 v36, v37, v36
  v_perm_b32 v112, v36, v37, s43
  v_add_f32 v37, v44, v255
  v_mfma_f32_32x32x16_bf16 v[208:223], v[124:127], a[252:255], v[208:223]
  v_and_b32 v36, s42, v37
  v_sub_f32 v36, v37, v36
  v_perm_b32 v116, v36, v37, s43
  s_load_dwordx8 s[8:15], s[50:51], 32 glc
  v_mfma_f32_32x32x16_bf16 v[160:175], v[112:115], v[20:23], v[160:175]
  v_mfma_f32_32x32x16_bf16 v[192:207], v[112:115], v[24:27], v[192:207]
  v_mfma_f32_32x32x16_bf16 v[176:191], v[116:119], v[20:23], v[176:191]
  v_mfma_f32_32x32x16_bf16 v[208:223], v[116:119], v[24:27], v[208:223]
  s_add_u32 s49, s77, 4096
  s_min_u32 s49, s49, 268435456
  s_nop 6
  v_pk_mul_f32 v[160:161], v[160:161], v[244:245] op_sel:[0,1] op_sel_hi:[1,1]
  v_pk_mul_f32 v[162:163], v[162:163], v[244:245] op_sel:[0,1] op_sel_hi:[1,1]
  v_pk_mul_f32 v[164:165], v[164:165], v[244:245] op_sel:[0,1] op_sel_hi:[1,1]
  v_pk_mul_f32 v[166:167], v[166:167], v[244:245] op_sel:[0,1] op_sel_hi:[1,1]
  v_cvt_pk_bf16_f32 v160, v160, v161
  v_cvt_pk_bf16_f32 v161, v162, v163
  v_cvt_pk_bf16_f32 v162, v164, v165
  v_cvt_pk_bf16_f32 v163, v166, v167
  v_pk_max_i16 v160, v160, 0
  v_pk_max_i16 v161, v161, 0
  v_pk_max_i16 v162, v162, 0
  v_pk_max_i16 v163, v163, 0
  buffer_store_dwordx4 v[160:163], v63, s[20:23], s77 offen offset:0 sc1
  v_pk_mul_f32 v[168:169], v[168:169], v[244:245] op_sel:[0,1] op_sel_hi:[1,1]
  v_pk_mul_f32 v[170:171], v[170:171], v[244:245] op_sel:[0,1] op_sel_hi:[1,1]
  v_pk_mul_f32 v[172:173], v[172:173], v[244:245] op_sel:[0,1] op_sel_hi:[1,1]
  v_pk_mul_f32 v[174:175], v[174:175], v[244:245] op_sel:[0,1] op_sel_hi:[1,1]
  v_cvt_pk_bf16_f32 v168, v168, v169
  v_cvt_pk_bf16_f32 v169, v170, v171
  v_cvt_pk_bf16_f32 v170, v172, v173
  v_cvt_pk_bf16_f32 v171, v174, v175
  v_pk_max_i16 v168, v168, 0
  v_pk_max_i16 v169, v169, 0
  v_pk_max_i16 v170, v170, 0
  v_pk_max_i16 v171, v171, 0
  buffer_store_dwordx4 v[168:171], v63, s[20:23], s77 offen offset:2048 sc1
  v_pk_mul_f32 v[192:193], v[192:193], v[246:247] op_sel:[0,1] op_sel_hi:[1,1]
  v_pk_mul_f32 v[194:195], v[194:195], v[246:247] op_sel:[0,1] op_sel_hi:[1,1]
  v_pk_mul_f32 v[196:197], v[196:197], v[246:247] op_sel:[0,1] op_sel_hi:[1,1]
  v_pk_mul_f32 v[198:199], v[198:199], v[246:247] op_sel:[0,1] op_sel_hi:[1,1]
  v_cvt_pk_bf16_f32 v192, v192, v193
  v_cvt_pk_bf16_f32 v193, v194, v195
  v_cvt_pk_bf16_f32 v194, v196, v197
  v_cvt_pk_bf16_f32 v195, v198, v199
  v_pk_max_i16 v192, v192, 0
  v_pk_max_i16 v193, v193, 0
  v_pk_max_i16 v194, v194, 0
  v_pk_max_i16 v195, v195, 0
  buffer_store_dwordx4 v[192:195], v63, s[20:23], s77 offen offset:1024 sc1
  v_pk_mul_f32 v[200:201], v[200:201], v[246:247] op_sel:[0,1] op_sel_hi:[1,1]
  v_pk_mul_f32 v[202:203], v[202:203], v[246:247] op_sel:[0,1] op_sel_hi:[1,1]
  v_pk_mul_f32 v[204:205], v[204:205], v[246:247] op_sel:[0,1] op_sel_hi:[1,1]
  v_pk_mul_f32 v[206:207], v[206:207], v[246:247] op_sel:[0,1] op_sel_hi:[1,1]
  v_cvt_pk_bf16_f32 v200, v200, v201
  v_cvt_pk_bf16_f32 v201, v202, v203
  v_cvt_pk_bf16_f32 v202, v204, v205
  v_cvt_pk_bf16_f32 v203, v206, v207
  v_pk_max_i16 v200, v200, 0
  v_pk_max_i16 v201, v201, 0
  v_pk_max_i16 v202, v202, 0
  v_pk_max_i16 v203, v203, 0
  buffer_store_dwordx4 v[200:203], v63, s[20:23], s77 offen offset:3072 sc1
  s_mov_b32 s48, 0
  s_branch L_ps_in
L_ps:
  s_load_dwordx8 s[8:15], s[50:51], 32 glc
L_ps_in:
  s_add_u32 s48, s48, 1
  s_cmp_lt_u32 s48, 0x20000
  s_waitcnt lgkmcnt(0)
  s_cbranch_scc0 L_ps_ok
  s_cmp_eq_u64 s[8:9], s[58:59]
  s_cbranch_scc0 L_ps
  s_cmp_eq_u64 s[10:11], s[58:59]
  s_cbranch_scc0 L_ps
  s_cmp_eq_u64 s[12:13], s[58:59]
  s_cbranch_scc0 L_ps
  s_cmp_eq_u64 s[14:15], s[58:59]
  s_cbranch_scc0 L_ps
L_ps_ok:
  s_xor_b32 s47, s84, 0
  s_add_u32 s47, s47, s85
  buffer_load_dwordx4 v[80:83], v241, s[20:23], s47 offen sc1
  buffer_load_dwordx4 v[84:87], v77, s[20:23], s47 offen sc1
  s_xor_b32 s47, s84, 2048
  s_add_u32 s47, s47, s85
  buffer_load_dwordx4 v[88:91], v241, s[20:23], s47 offen sc1
  buffer_load_dwordx4 v[92:95], v77, s[20:23], s47 offen sc1
  s_xor_b32 s47, s84, 4096
  s_add_u32 s47, s47, s85
  buffer_load_dwordx4 v[96:99], v241, s[20:23], s47 offen sc1
  buffer_load_dwordx4 v[100:103], v77, s[20:23], s47 offen sc1
  s_xor_b32 s47, s84, 6144
  s_add_u32 s47, s47, s85
  buffer_load_dwordx4 v[104:107], v241, s[20:23], s47 offen sc1
  buffer_load_dwordx4 v[108:111], v77, s[20:23], s47 offen sc1
  s_xor_b32 s47, s84, 8192
  s_add_u32 s47, s47, s85
  buffer_load_dwordx4 v[224:227], v241, s[20:23], s47 offen sc1
  buffer_load_dwordx4 v[228:231], v77, s[20:23], s47 offen sc1
  s_xor_b32 s47, s84, 10240
  s_add_u32 s47, s47, s85
  buffer_load_dwordx4 v[232:235], v241, s[20:23], s47 offen sc1
  buffer_load_dwordx4 v[236:239], v77, s[20:23], s47 offen sc1
  v_pk_mul_f32 v[176:177], v[176:177], v[244:245] op_sel:[0,1] op_sel_hi:[1,1]
  v_pk_mul_f32 v[178:179], v[178:179], v[244:245] op_sel:[0,1] op_sel_hi:[1,1]
  v_pk_mul_f32 v[180:181], v[180:181], v[244:245] op_sel:[0,1] op_sel_hi:[1,1]
  v_pk_mul_f32 v[182:183], v[182:183], v[244:245] op_sel:[0,1] op_sel_hi:[1,1]
  v_cvt_pk_bf16_f32 v176, v176, v177
  v_cvt_pk_bf16_f32 v177, v178, v179
  v_cvt_pk_bf16_f32 v178, v180, v181
  v_cvt_pk_bf16_f32 v179, v182, v183
  v_pk_max_i16 v176, v176, 0
  v_pk_max_i16 v177, v177, 0
  v_pk_max_i16 v178, v178, 0
  v_pk_max_i16 v179, v179, 0
  buffer_store_dwordx4 v[176:179], v63, s[20:23], s49 offen offset:0 sc1
  v_pk_mul_f32 v[184:185], v[184:185], v[244:245] op_sel:[0,1] op_sel_hi:[1,1]
  v_pk_mul_f32 v[186:187], v[186:187], v[244:245] op_sel:[0,1] op_sel_hi:[1,1]
  v_pk_mul_f32 v[188:189], v[188:189], v[244:245] op_sel:[0,1] op_sel_hi:[1,1]
  v_pk_mul_f32 v[190:191], v[190:191], v[244:245] op_sel:[0,1] op_sel_hi:[1,1]
  v_cvt_pk_bf16_f32 v184, v184, v185
  v_cvt_pk_bf16_f32 v185, v186, v187
  v_cvt_pk_bf16_f32 v186, v188, v189
  v_cvt_pk_bf16_f32 v187, v190, v191
  v_pk_max_i16 v184, v184, 0
  v_pk_max_i16 v185, v185, 0
  v_pk_max_i16 v186, v186, 0
  v_pk_max_i16 v187, v187, 0
  buffer_store_dwordx4 v[184:187], v63, s[20:23], s49 offen offset:2048 sc1
  s_waitcnt vmcnt(12)
  v_mfma_f32_32x32x16_bf16 v[112:127], v[80:83], a[0:3], 0
  buffer_store_dword v5, v78, s[20:23], s78 offen offset:0 sc1
  v_mul_f32 v208, v208, v247
  v_mul_f32 v209, v209, v247
  v_mul_f32 v210, v210, v247
  v_mul_f32 v211, v211, v247
  v_mfma_f32_32x32x16_bf16 a[176:191], v[80:83], a[16:19], 0
  v_mul_f32 v212, v212, v247
  v_mul_f32 v213, v213, v247
  v_mul_f32 v214, v214, v247
  v_mul_f32 v215, v215, v247
  v_cvt_pk_bf16_f32 v208, v208, v209
  v_mfma_f32_32x32x16_bf16 a[192:207], v[84:87], a[0:3], 0
  v_cvt_pk_bf16_f32 v209, v210, v211
  v_cvt_pk_bf16_f32 v210, v212, v213
  v_cvt_pk_bf16_f32 v211, v214, v215
  v_pk_max_i16 v208, v208, 0
  v_pk_max_i16 v209, v209, 0
  v_mfma_f32_32x32x16_bf16 a[208:223], v[84:87], a[16:19], 0
  v_pk_max_i16 v210, v210, 0
  v_pk_max_i16 v211, v211, 0
  buffer_store_dwordx4 v[208:211], v63, s[20:23], s49 offen offset:1024 sc1
  v_mul_f32 v216, v216, v247
  s_waitcnt vmcnt(12)
  v_mfma_f32_32x32x16_bf16 v[112:127], v[88:91], a[32:35], v[112:127]
  s_xor_b32 s47, s84, 12288
  s_add_u32 s47, s47, s85
  buffer_load_dwordx4 v[144:147], v241, s[20:23], s47 offen sc1
  v_mul_f32 v217, v217, v247
  v_mul_f32 v218, v218, v247
  v_mul_f32 v219, v219, v247
  v_mfma_f32_32x32x16_bf16 a[176:191], v[88:91], a[48:51], a[176:191]
  buffer_load_dwordx4 v[148:151], v77, s[20:23], s47 offen sc1
  v_mul_f32 v220, v220, v247
  v_mul_f32 v221, v221, v247
  v_mul_f32 v222, v222, v247
  v_mul_f32 v223, v223, v247
  v_cvt_pk_bf16_f32 v216, v216, v217
  v_cvt_pk_bf16_f32 v217, v218, v219
  v_mfma_f32_32x32x16_bf16 a[192:207], v[92:95], a[32:35], a[192:207]
  s_xor_b32 s47, s84, 14336
  s_add_u32 s47, s47, s85
  buffer_load_dwordx4 v[152:155], v241, s[20:23], s47 offen sc1
  v_cvt_pk_bf16_f32 v218, v220, v221
  v_cvt_pk_bf16_f32 v219, v222, v223
  v_pk_max_i16 v216, v216, 0
  v_mfma_f32_32x32x16_bf16 a[208:223], v[92:95], a[48:51], a[208:223]
  buffer_load_dwordx4 v[156:159], v77, s[20:23], s47 offen sc1
  v_pk_max_i16 v217, v217, 0
  v_pk_max_i16 v218, v218, 0
  v_pk_max_i16 v219, v219, 0
  buffer_store_dwordx4 v[216:219], v63, s[20:23], s49 offen offset:3072 sc1
  s_xor_b32 s54, s3, 1
  s_mul_i32 s54, s54, 12288
  s_waitcnt vmcnt(15)
  v_mfma_f32_32x32x16_bf16 v[112:127], v[96:99], a[4:7], v[112:127]
  s_xor_b32 s47, s84, 0
  s_add_u32 s47, s47, s83
  buffer_load_dwordx4 v[128:131], v241, s[20:23], s47 offen sc1
  s_add_u32 s54, s54, 49152
  v_lshl_add_u32 v56, v0, 4, s54
  s_xor_b32 s54, s3, 2
  v_mfma_f32_32x32x16_bf16 a[176:191], v[96:99], a[20:23], a[176:191]
  buffer_load_dwordx4 v[132:135], v77, s[20:23], s47 offen sc1
  s_mul_i32 s54, s54, 12288
  s_add_u32 s54, s54, 53248
  v_lshl_add_u32 v57, v0, 4, s54
  s_xor_b32 s54, s3, 3
  s_mul_i32 s54, s54, 12288
  s_add_u32 s54, s54, 57344
  v_mfma_f32_32x32x16_bf16 a[192:207], v[100:103], a[4:7], a[192:207]
  s_xor_b32 s47, s84, 2048
  s_add_u32 s47, s47, s83
  buffer_load_dwordx4 v[136:139], v241, s[20:23], s47 offen sc1
  v_lshl_add_u32 v58, v0, 4, s54
  s_mul_i32 s54, s3, 12288
  s_add_u32 s54, s54, 49152
  v_mfma_f32_32x32x16_bf16 a[208:223], v[100:103], a[20:23], a[208:223]
  buffer_load_dwordx4 v[140:143], v77, s[20:23], s47 offen sc1
  v_lshl_add_u32 v59, v0, 4, s54
  s_add_u32 s36, s64, s87
  s_addc_u32 s37, s65, 0
  s_mov_b32 s38, 63616
  s_mov_b32 s39, 0x20000
  v_lshlrev_b32 v242, 1, v62
  s_waitcnt vmcnt(17)
  v_mfma_f32_32x32x16_bf16 v[112:127], v[104:107], a[36:39], v[112:127]
  s_xor_b32 s47, s84, 4096
  s_add_u32 s47, s47, s83
  buffer_load_dwordx4 v[64:67], v241, s[20:23], s47 offen sc1
  v_mfma_f32_32x32x16_bf16 a[176:191], v[104:107], a[52:55], a[176:191]
  buffer_load_dwordx4 v[68:71], v77, s[20:23], s47 offen sc1
  v_mfma_f32_32x32x16_bf16 a[192:207], v[108:111], a[36:39], a[192:207]
  s_xor_b32 s47, s84, 6144
  s_add_u32 s47, s47, s83
  buffer_load_dwordx4 v[80:83], v241, s[20:23], s47 offen sc1
  v_mfma_f32_32x32x16_bf16 a[208:223], v[108:111], a[52:55], a[208:223]
  buffer_load_dwordx4 v[84:87], v77, s[20:23], s47 offen sc1
  s_waitcnt vmcnt(19)
  v_mfma_f32_32x32x16_bf16 v[112:127], v[224:227], a[8:11], v[112:127]
  s_xor_b32 s47, s84, 8192
  s_add_u32 s47, s47, s83
  buffer_load_dwordx4 v[88:91], v241, s[20:23], s47 offen sc1
  v_mfma_f32_32x32x16_bf16 a[176:191], v[224:227], a[24:27], a[176:191]
  buffer_load_dwordx4 v[92:95], v77, s[20:23], s47 offen sc1
  s_load_dwordx8 s[8:15], s[50:51], 0 glc
  v_mfma_f32_32x32x16_bf16 a[192:207], v[228:231], a[8:11], a[192:207]
  s_xor_b32 s47, s84, 10240
  s_add_u32 s47, s47, s83
  buffer_load_dwordx4 v[96:99], v241, s[20:23], s47 offen sc1
  v_mfma_f32_32x32x16_bf16 a[208:223], v[228:231], a[24:27], a[208:223]
  buffer_load_dwordx4 v[100:103], v77, s[20:23], s47 offen sc1
  s_waitcnt vmcnt(21)
  v_mfma_f32_32x32x16_bf16 v[112:127], v[232:235], a[40:43], v[112:127]
  s_xor_b32 s47, s84, 12288
  s_add_u32 s47, s47, s83
  buffer_load_dwordx4 v[104:107], v241, s[20:23], s47 offen sc1
  v_mfma_f32_32x32x16_bf16 a[176:191], v[232:235], a[56:59], a[176:191]
  buffer_load_dwordx4 v[108:111], v77, s[20:23], s47 offen sc1
  v_mfma_f32_32x32x16_bf16 a[192:207], v[236:239], a[40:43], a[192:207]
  s_xor_b32 s47, s84, 14336
  s_add_u32 s47, s47, s83
  buffer_load_dwordx4 v[224:227], v241, s[20:23], s47 offen sc1
  v_mfma_f32_32x32x16_bf16 a[208:223], v[236:239], a[56:59], a[208:223]
  buffer_load_dwordx4 v[228:231], v77, s[20:23], s47 offen sc1
  s_waitcnt vmcnt(19)
  v_mfma_f32_32x32x16_bf16 v[112:127], v[144:147], a[12:15], v[112:127]
  s_waitcnt vmcnt(16)
  buffer_store_dword v5, v78, s[20:23], s78 offen offset:64 sc1
  v_mfma_f32_32x32x16_bf16 a[176:191], v[144:147], a[28:31], a[176:191]
  v_mfma_f32_32x32x16_bf16 a[192:207], v[148:151], a[12:15], a[192:207]
  v_mfma_f32_32x32x16_bf16 a[208:223], v[148:151], a[28:31], a[208:223]
  s_mov_b32 s48, 0
  s_branch L_pf_in
L_pf:
  s_load_dwordx8 s[8:15], s[50:51], 0 glc
L_pf_in:
  s_add_u32 s48, s48, 1
  s_cmp_lt_u32 s48, 0x20000
  s_waitcnt lgkmcnt(0)
  s_cbranch_scc0 L_pf_ok
  s_cmp_eq_u64 s[8:9], s[58:59]
  s_cbranch_scc0 L_pf
  s_cmp_eq_u64 s[10:11], s[58:59]
  s_cbranch_scc0 L_pf
  s_cmp_eq_u64 s[12:13], s[58:59]
  s_cbranch_scc0 L_pf
  s_cmp_eq_u64 s[14:15], s[58:59]
  s_cbranch_scc0 L_pf
L_pf_ok:
  v_mfma_f32_32x32x16_bf16 v[112:127], v[152:155], a[44:47], v[112:127]
  s_add_u32 s47, s83, s93
  buffer_load_dwordx4 v[232:235], v241, s[20:23], s47 offen sc1
  v_mfma_f32_32x32x16_bf16 a[176:191], v[152:155], a[60:63], a[176:191]
  buffer_load_dwordx4 v[236:239], v77, s[20:23], s47 offen sc1
  v_mfma_f32_32x32x16_bf16 a[192:207], v[156:159], a[44:47], a[192:207]
  s_add_u32 s47, s83, s94
  buffer_load_dwordx4 v[144:147], v241, s[20:23], s47 offen sc1
  v_mfma_f32_32x32x16_bf16 a[208:223], v[156:159], a[60:63], a[208:223]
  buffer_load_dwordx4 v[148:151], v77, s[20:23], s47 offen sc1
  s_waitcnt vmcnt(19)
  v_mfma_f32_32x32x16_bf16 v[160:175], v[128:131], a[0:3], 0
  s_add_u32 s47, s83, s95
  buffer_load_dwordx4 v[152:155], v241, s[20:23], s47 offen sc1
  v_mfma_f32_32x32x16_bf16 v[176:191], v[128:131], a[16:19], 0
  ds_read_b64_tr_b16 a[112:113], v55 offset:49152
  ds_read_b64_tr_b16 a[114:115], v55 offset:50176
  ds_read_b64_tr_b16 a[116:117], v12 offset:49152
  v_mfma_f32_32x32x16_bf16 v[192:207], v[132:135], a[0:3], 0
  buffer_load_dwordx4 v[156:159], v77, s[20:23], s47 offen sc1
  ds_read_b64_tr_b16 a[118:119], v12 offset:50176
  ds_read_b64_tr_b16 a[120:121], v55 offset:51200
  v_mfma_f32_32x32x16_bf16 v[208:223], v[132:135], a[16:19], 0
  ds_read_b64_tr_b16 a[122:123], v55 offset:52224
  ds_read_b64_tr_b16 a[124:125], v12 offset:51200
  ds_read_b64_tr_b16 a[126:127], v12 offset:52224
  s_waitcnt vmcnt(19)
  v_mfma_f32_32x32x16_bf16 v[160:175], v[136:139], a[32:35], v[160:175]
  s_add_u32 s47, s83, s96
  buffer_load_dwordx4 v[128:131], v241, s[20:23], s47 offen sc1
  v_mfma_f32_32x32x16_bf16 v[176:191], v[136:139], a[48:51], v[176:191]
  ds_read_b64_tr_b16 a[128:129], v55 offset:0
  ds_read_b64_tr_b16 a[130:131], v55 offset:1024
  ds_read_b64_tr_b16 a[132:133], v12 offset:0
  v_mfma_f32_32x32x16_bf16 v[192:207], v[140:143], a[32:35], v[192:207]
  buffer_load_dwordx4 v[132:135], v77, s[20:23], s47 offen sc1
  ds_read_b64_tr_b16 a[134:135], v12 offset:1024
  ds_read_b64_tr_b16 a[136:137], v55 offset:2048
  v_mfma_f32_32x32x16_bf16 v[208:223], v[140:143], a[48:51], v[208:223]
  ds_read_b64_tr_b16 a[138:139], v55 offset:3072
  ds_read_b64_tr_b16 a[140:141], v12 offset:2048
  ds_read_b64_tr_b16 a[142:143], v12 offset:3072
  s_waitcnt vmcnt(19)
  v_mfma_f32_32x32x16_bf16 v[160:175], v[64:67], a[4:7], v[160:175]
  s_add_u32 s47, s83, s97
  buffer_load_dwordx4 v[136:139], v241, s[20:23], s47 offen sc1
  v_mfma_f32_32x32x16_bf16 v[176:191], v[64:67], a[20:23], v[176:191]
  ds_read_b64_tr_b16 a[144:145], v55 offset:16384
  ds_read_b64_tr_b16 a[146:147], v55 offset:17408
  ds_read_b64_tr_b16 a[148:149], v12 offset:16384
  v_mfma_f32_32x32x16_bf16 v[192:207], v[68:71], a[4:7], v[192:207]
  buffer_load_dwordx4 v[140:143], v77, s[20:23], s47 offen sc1
  ds_read_b64_tr_b16 a[150:151], v12 offset:17408
  ds_read_b64_tr_b16 a[152:153], v55 offset:18432
  v_mfma_f32_32x32x16_bf16 v[208:223], v[68:71], a[20:23], v[208:223]
  ds_read_b64_tr_b16 a[154:155], v55 offset:19456
  ds_read_b64_tr_b16 a[156:157], v12 offset:18432
  ds_read_b64_tr_b16 a[158:159], v12 offset:19456
  s_waitcnt vmcnt(19)
  v_mfma_f32_32x32x16_bf16 v[160:175], v[80:83], a[36:39], v[160:175]
  s_add_u32 s47, s83, s98
  buffer_load_dwordx4 v[64:67], v241, s[20:23], s47 offen sc1
  v_mfma_f32_32x32x16_bf16 v[176:191], v[80:83], a[52:55], v[176:191]
  ds_read_b64_tr_b16 a[160:161], v55 offset:32768
  ds_read_b64_tr_b16 a[162:163], v55 offset:33792
  ds_read_b64_tr_b16 a[164:165], v12 offset:32768
  v_mfma_f32_32x32x16_bf16 v[192:207], v[84:87], a[36:39], v[192:207]
  buffer_load_dwordx4 v[68:71], v77, s[20:23], s47 offen sc1
  ds_read_b64_tr_b16 a[166:167], v12 offset:33792
  ds_read_b64_tr_b16 a[168:169], v55 offset:34816
  v_mfma_f32_32x32x16_bf16 v[208:223], v[84:87], a[52:55], v[208:223]
  ds_read_b64_tr_b16 a[170:171], v55 offset:35840
  ds_read_b64_tr_b16 a[172:173], v12 offset:34816
  ds_read_b64_tr_b16 a[174:175], v12 offset:35840
  s_waitcnt vmcnt(19)
  v_mfma_f32_32x32x16_bf16 v[160:175], v[88:91], a[8:11], v[160:175]
  s_add_u32 s47, s83, s99
  buffer_load_dwordx4 v[80:83], v241, s[20:23], s47 offen sc1
  s_add_u32 s16, s40, s86
  s_addc_u32 s17, s41, 0
  s_mov_b32 s18, 31808
  v_mfma_f32_32x32x16_bf16 v[176:191], v[88:91], a[24:27], v[176:191]
  s_mov_b32 s19, 0x20000
  v_lshrrev_b32 v1, 2, v0
  v_and_b32 v2, 3, v0
  v_lshlrev_b32 v2, 4, v2
  v_lshl_add_u32 v1, v1, 10, v2
  s_movk_i32 s54, 15360
  s_add_u32 m0, s4, 65536
  s_nop 0
  buffer_load_dwordx4 v1, s[16:19], 0 offen lds
  buffer_load_dwordx4 v1, s[16:19], s54 offen offset:1024 lds
  v_mfma_f32_32x32x16_bf16 v[192:207], v[92:95], a[8:11], v[192:207]
  buffer_load_dwordx4 v[84:87], v77, s[20:23], s47 offen sc1
  v_lshl_add_u32 v1, v6, 6, s91
  ds_read_b128 v[24:27], v1 offset:0
  ds_read_b128 v[40:43], v1 offset:512
  v_mfma_f32_32x32x16_bf16 v[208:223], v[92:95], a[24:27], v[208:223]
  ds_read_b128 v[28:31], v1 offset:16
  ds_read_b128 v[44:47], v1 offset:528
  ds_read_b128 v[32:35], v1 offset:32
  ds_read_b128 v[48:51], v1 offset:544
  ds_read_b128 v[36:39], v1 offset:48
  ds_read_b128 v[52:55], v1 offset:560
  s_load_dwordx8 s[8:15], s[50:51], 64 glc
  s_waitcnt vmcnt(21)
  v_mfma_f32_32x32x16_bf16 v[160:175], v[96:99], a[40:43], v[160:175]
  v_mfma_f32_32x32x16_bf16 v[176:191], v[96:99], a[56:59], v[176:191]
  v_mfma_f32_32x32x16_bf16 v[192:207], v[100:103], a[40:43], v[192:207]
  v_mfma_f32_32x32x16_bf16 v[208:223], v[100:103], a[56:59], v[208:223]
  s_waitcnt vmcnt(19)
  v_mfma_f32_32x32x16_bf16 v[160:175], v[104:107], a[12:15], v[160:175]
  v_mfma_f32_32x32x16_bf16 v[176:191], v[104:107], a[28:31], v[176:191]
  v_mfma_f32_32x32x16_bf16 v[192:207], v[108:111], a[12:15], v[192:207]
  v_mfma_f32_32x32x16_bf16 v[208:223], v[108:111], a[28:31], v[208:223]
  s_mov_b32 s48, 0
  s_branch L_pg_in
L_pg:
  s_load_dwordx8 s[8:15], s[50:51], 64 glc
L_pg_in:
  s_add_u32 s48, s48, 1
  s_cmp_lt_u32 s48, 0x20000
  s_waitcnt lgkmcnt(0)
  s_cbranch_scc0 L_pg_ok
  s_cmp_eq_u64 s[8:9], s[58:59]
  s_cbranch_scc0 L_pg
  s_cmp_eq_u64 s[10:11], s[58:59]
  s_cbranch_scc0 L_pg
  s_cmp_eq_u64 s[12:13], s[58:59]
  s_cbranch_scc0 L_pg
  s_cmp_eq_u64 s[14:15], s[58:59]
  s_cbranch_scc0 L_pg
L_pg_ok:
  s_waitcnt vmcnt(17)
  v_mfma_f32_32x32x16_bf16 v[160:175], v[224:227], a[44:47], v[160:175]
  s_add_u32 s47, s83, s93
  s_add_u32 s47, s47, 4096
  buffer_load_dwordx4 v[88:91], v241, s[20:23], s47 offen sc1
  v_mfma_f32_32x32x16_bf16 v[176:191], v[224:227], a[60:63], v[176:191]
  buffer_load_dwordx4 v[92:95], v77, s[20:23], s47 offen sc1
  v_mfma_f32_32x32x16_bf16 v[192:207], v[228:231], a[44:47], v[192:207]
  s_add_u32 s47, s83, s94
  s_add_u32 s47, s47, 4096
  buffer_load_dwordx4 v[96:99], v241, s[20:23], s47 offen sc1
  v_mfma_f32_32x32x16_bf16 v[208:223], v[228:231], a[60:63], v[208:223]
  buffer_load_dwordx4 v[100:103], v77, s[20:23], s47 offen sc1
  s_waitcnt vmcnt(18)
  v_mfma_f32_32x32x16_bf16 v[160:175], v[232:235], a[64:67], v[160:175]
  s_add_u32 s47, s83, s95
  s_add_u32 s47, s47, 4096
  buffer_load_dwordx4 v[104:107], v241, s[20:23], s47 offen sc1
  v_mfma_f32_32x32x16_bf16 v[176:191], v[232:235], a[68:71], v[176:191]
  buffer_load_dwordx4 v[108:111], v77, s[20:23], s47 offen sc1
  v_mfma_f32_32x32x16_bf16 v[192:207], v[236:239], a[64:67], v[192:207]
  s_add_u32 s47, s83, s96
  s_add_u32 s47, s47, 4096
  buffer_load_dwordx4 v[224:227], v241, s[20:23], s47 offen sc1
  v_mfma_f32_32x32x16_bf16 v[208:223], v[236:239], a[68:71], v[208:223]
  buffer_load_dwordx4 v[228:231], v77, s[20:23], s47 offen sc1
  s_waitcnt vmcnt(20)
  v_mfma_f32_32x32x16_bf16 v[160:175], v[144:147], a[72:75], v[160:175]
  s_add_u32 s47, s83, s97
  s_add_u32 s47, s47, 4096
  buffer_load_dwordx4 v[232:235], v241, s[20:23], s47 offen sc1
  v_bfe_u32 v1, v0, 2, 2
  v_mfma_f32_32x32x16_bf16 v[176:191], v[144:147], a[76:79], v[176:191]
  v_lshl_add_u32 v1, v6, 4, v1
  v_bfe_u32 v2, v0, 4, 1
  v_lshl_add_u32 v1, v1, 1, v2
  v_and_b32 v2, 3, v0
  v_lshl_add_u32 v1, v1, 2, v2
  s_add_u32 s54, s4, 65536
  v_mfma_f32_32x32x16_bf16 v[192:207], v[148:151], a[72:75], v[192:207]
  buffer_load_dwordx4 v[236:239], v77, s[20:23], s47 offen sc1
  v_lshl_add_u32 v1, v1, 3, s54
  s_waitcnt vmcnt(11)
  ds_read_b64_tr_b16 v[16:17], v1 offset:0
  ds_read_b64_tr_b16 v[18:19], v1 offset:256
  ds_read_b64_tr_b16 v[20:21], v1 offset:512
  ds_read_b64_tr_b16 v[22:23], v1 offset:768
  v_mfma_f32_32x32x16_bf16 v[208:223], v[148:151], a[76:79], v[208:223]
  v_lshlrev_b32 v243, 16, v243
  s_waitcnt lgkmcnt(0)
  v_lshlrev_b32 v8, 16, v16
  v_and_b32 v9, s42, v16
  v_lshlrev_b32 v10, 16, v17
  v_and_b32 v11, s42, v17
  v_lshlrev_b32 v12, 16, v18
  v_mfma_f32_32x32x16_bf16 v[160:175], v[152:155], a[80:83], v[160:175]
  s_add_u32 s47, s83, s98
  s_add_u32 s47, s47, 4096
  buffer_load_dwordx4 v[144:147], v241, s[20:23], s47 offen sc1
  v_and_b32 v13, s42, v18
  v_mfma_f32_32x32x16_bf16 v[176:191], v[152:155], a[84:87], v[176:191]
  v_lshlrev_b32 v14, 16, v19
  v_and_b32 v15, s42, v19
  v_lshlrev_b32 v16, 16, v20
  v_and_b32 v17, s42, v20
  v_lshlrev_b32 v18, 16, v21
  v_and_b32 v19, s42, v21
  v_mfma_f32_32x32x16_bf16 v[192:207], v[156:159], a[80:83], v[192:207]
  buffer_load_dwordx4 v[148:151], v77, s[20:23], s47 offen sc1
  v_lshlrev_b32 v20, 16, v22
  v_and_b32 v21, s42, v22
  v_lshlrev_b32 v22, 16, v23
  v_and_b32 v23, s42, v23
  v_sub_f32 v24, v8, v24
  v_mfma_f32_32x32x16_bf16 v[208:223], v[156:159], a[84:87], v[208:223]
  v_sub_f32 v25, v9, v25
  v_cvt_pk_bf16_f32 v1, v24, v25
  v_lshlrev_b32 v24, 16, v1
  v_and_b32 v25, s42, v1
  v_mul_f32 v24, v24, v40
  v_mul_f32 v25, v25, v41
  v_mfma_f32_32x32x16_bf16 v[160:175], v[128:131], a[88:91], v[160:175]
  s_add_u32 s47, s83, s99
  s_add_u32 s47, s47, 4096
  buffer_load_dwordx4 v[152:155], v241, s[20:23], s47 offen sc1
  v_cvt_pk_bf16_f32 v1, v24, v25
  v_mfma_f32_32x32x16_bf16 v[176:191], v[128:131], a[92:95], v[176:191]
  v_lshlrev_b32 v24, 16, v1
  v_and_b32 v25, s42, v1
  v_mul_f32 v24, v24, v243
  v_mul_f32 v25, v25, v243
  v_cvt_pk_bf16_f32 v1, v24, v25
  v_lshlrev_b32 v24, 16, v1
  v_mfma_f32_32x32x16_bf16 v[192:207], v[132:135], a[88:91], v[192:207]
  buffer_load_dwordx4 v[156:159], v77, s[20:23], s47 offen sc1
  v_and_b32 v25, s42, v1
  v_add_f32 v8, v8, v24
  v_add_f32 v9, v9, v25
  v_sub_f32 v26, v10, v26
  v_sub_f32 v27, v11, v27
  v_mfma_f32_32x32x16_bf16 v[208:223], v[132:135], a[92:95], v[208:223]
  v_cvt_pk_bf16_f32 v1, v26, v27
  v_lshlrev_b32 v26, 16, v1
  v_and_b32 v27, s42, v1
  v_mul_f32 v26, v26, v42
  v_mul_f32 v27, v27, v43
  v_cvt_pk_bf16_f32 v1, v26, v27
  v_mfma_f32_32x32x16_bf16 v[160:175], v[136:139], a[96:99], v[160:175]
  s_add_u32 s47, s85, s93
  buffer_load_dwordx4 v[128:131], v241, s[20:23], s47 offen sc1
  v_lshlrev_b32 v26, 16, v1
  v_and_b32 v27, s42, v1
  v_mfma_f32_32x32x16_bf16 v[176:191], v[136:139], a[100:103], v[176:191]
  v_mul_f32 v26, v26, v243
  v_mul_f32 v27, v27, v243
  v_cvt_pk_bf16_f32 v1, v26, v27
  v_lshlrev_b32 v26, 16, v1
  v_and_b32 v27, s42, v1
  v_add_f32 v10, v10, v26
  v_mfma_f32_32x32x16_bf16 v[192:207], v[140:143], a[96:99], v[192:207]
  buffer_load_dwordx4 v[132:135], v77, s[20:23], s47 offen sc1
  v_add_f32 v11, v11, v27
  v_sub_f32 v28, v12, v28
  v_sub_f32 v29, v13, v29
  v_cvt_pk_bf16_f32 v1, v28, v29
  v_mfma_f32_32x32x16_bf16 v[208:223], v[140:143], a[100:103], v[208:223]
  v_lshlrev_b32 v28, 16, v1
  v_and_b32 v29, s42, v1
  v_mul_f32 v28, v28, v44
  v_mul_f32 v29, v29, v45
  v_cvt_pk_bf16_f32 v1, v28, v29
  v_lshlrev_b32 v28, 16, v1
  v_mfma_f32_32x32x16_bf16 v[160:175], v[64:67], a[104:107], v[160:175]
  s_add_u32 s47, s85, s94
  buffer_load_dwordx4 v[136:139], v241, s[20:23], s47 offen sc1
  v_and_b32 v29, s42, v1
  v_mul_f32 v28, v28, v243
  v_mfma_f32_32x32x16_bf16 v[176:191], v[64:67], a[108:111], v[176:191]
  v_mul_f32 v29, v29, v243
  v_cvt_pk_bf16_f32 v1, v28, v29
  v_lshlrev_b32 v28, 16, v1
  v_and_b32 v29, s42, v1
  v_add_f32 v12, v12, v28
  v_add_f32 v13, v13, v29
  v_mfma_f32_32x32x16_bf16 v[192:207], v[68:71], a[104:107], v[192:207]
  buffer_load_dwordx4 v[140:143], v77, s[20:23], s47 offen sc1
  v_sub_f32 v30, v14, v30
  v_sub_f32 v31, v15, v31
  v_cvt_pk_bf16_f32 v1, v30, v31
  v_lshlrev_b32 v30, 16, v1
  v_mfma_f32_32x32x16_bf16 v[208:223], v[68:71], a[108:111], v[208:223]
  v_and_b32 v31, s42, v1
  v_mul_f32 v30, v30, v46
  v_mul_f32 v31, v31, v47
  v_cvt_pk_bf16_f32 v1, v30, v31
  v_lshlrev_b32 v30, 16, v1
  v_and_b32 v31, s42, v1
  s_waitcnt vmcnt(18)
  v_mfma_f32_32x32x16_bf16 v[160:175], v[80:83], a[112:115], v[160:175]
  s_add_u32 s47, s85, s95
  buffer_load_dwordx4 v[64:67], v241, s[20:23], s47 offen sc1
  v_mul_f32 v30, v30, v243
  v_mul_f32 v31, v31, v243
  v_mfma_f32_32x32x16_bf16 v[176:191], v[80:83], a[116:119], v[176:191]
  v_cvt_pk_bf16_f32 v1, v30, v31
  v_lshlrev_b32 v30, 16, v1
  v_and_b32 v31, s42, v1
  v_add_f32 v14, v14, v30
  v_add_f32 v15, v15, v31
  v_sub_f32 v32, v16, v32
  v_mfma_f32_32x32x16_bf16 v[192:207], v[84:87], a[112:115], v[192:207]
  buffer_load_dwordx4 v[68:71], v77, s[20:23], s47 offen sc1
  v_sub_f32 v33, v17, v33
  v_cvt_pk_bf16_f32 v1, v32, v33
  v_lshlrev_b32 v32, 16, v1
  v_and_b32 v33, s42, v1
  v_mfma_f32_32x32x16_bf16 v[208:223], v[84:87], a[116:119], v[208:223]
  v_mul_f32 v32, v32, v48
  v_mul_f32 v33, v33, v49
  v_cvt_pk_bf16_f32 v1, v32, v33
  v_lshlrev_b32 v32, 16, v1
  v_and_b32 v33, s42, v1
  v_mul_f32 v32, v32, v243
  s_waitcnt vmcnt(18)
  v_mfma_f32_32x32x16_bf16 v[160:175], v[88:91], a[120:123], v[160:175]
  s_add_u32 s47, s85, s96
  buffer_load_dwordx4 v[80:83], v241, s[20:23], s47 offen sc1
  v_mul_f32 v33, v33, v243
  v_cvt_pk_bf16_f32 v1, v32, v33
  v_mfma_f32_32x32x16_bf16 v[176:191], v[88:91], a[124:127], v[176:191]
  v_lshlrev_b32 v32, 16, v1
  v_and_b32 v33, s42, v1
  v_add_f32 v16, v16, v32
  v_add_f32 v17, v17, v33
  v_sub_f32 v34, v18, v34
  v_sub_f32 v35, v19, v35
  v_mfma_f32_32x32x16_bf16 v[192:207], v[92:95], a[120:123], v[192:207]
  buffer_load_dwordx4 v[84:87], v77, s[20:23], s47 offen sc1
  v_cvt_pk_bf16_f32 v1, v34, v35
  v_lshlrev_b32 v34, 16, v1
  v_and_b32 v35, s42, v1
  v_mul_f32 v34, v34, v50
  v_mfma_f32_32x32x16_bf16 v[208:223], v[92:95], a[124:127], v[208:223]
  v_mul_f32 v35, v35, v51
  v_cvt_pk_bf16_f32 v1, v34, v35
  v_lshlrev_b32 v34, 16, v1
  v_and_b32 v35, s42, v1
  v_mul_f32 v34, v34, v243
  v_mul_f32 v35, v35, v243
  s_waitcnt vmcnt(18)
  v_mfma_f32_32x32x16_bf16 v[160:175], v[96:99], a[128:131], v[160:175]
  s_add_u32 s47, s85, s97
  buffer_load_dwordx4 v[88:91], v241, s[20:23], s47 offen sc1
  v_cvt_pk_bf16_f32 v1, v34, v35
  v_lshlrev_b32 v34, 16, v1
  v_mfma_f32_32x32x16_bf16 v[176:191], v[96:99], a[132:135], v[176:191]
  v_and_b32 v35, s42, v1
  v_add_f32 v18, v18, v34
  v_add_f32 v19, v19, v35
  v_sub_f32 v36, v20, v36
  v_sub_f32 v37, v21, v37
  v_cvt_pk_bf16_f32 v1, v36, v37
  v_mfma_f32_32x32x16_bf16 v[192:207], v[100:103], a[128:131], v[192:207]
  buffer_load_dwordx4 v[92:95], v77, s[20:23], s47 offen sc1
  v_lshlrev_b32 v36, 16, v1
  v_and_b32 v37, s42, v1
  v_mul_f32 v36, v36, v52
  v_mul_f32 v37, v37, v53
  v_mfma_f32_32x32x16_bf16 v[208:223], v[100:103], a[132:135], v[208:223]
  v_cvt_pk_bf16_f32 v1, v36, v37
  v_lshlrev_b32 v36, 16, v1
  v_and_b32 v37, s42, v1
  v_mul_f32 v36, v36, v243
  v_mul_f32 v37, v37, v243
  v_cvt_pk_bf16_f32 v1, v36, v37
  s_waitcnt vmcnt(18)
  v_mfma_f32_32x32x16_bf16 v[160:175], v[104:107], a[136:139], v[160:175]
  s_add_u32 s47, s85, s98
  buffer_load_dwordx4 v[96:99], v241, s[20:23], s47 offen sc1
  v_lshlrev_b32 v36, 16, v1
  v_and_b32 v37, s42, v1
  v_mfma_f32_32x32x16_bf16 v[176:191], v[104:107], a[140:143], v[176:191]
  v_add_f32 v20, v20, v36
  v_add_f32 v21, v21, v37
  v_sub_f32 v38, v22, v38
  v_sub_f32 v39, v23, v39
  v_cvt_pk_bf16_f32 v1, v38, v39
  v_lshlrev_b32 v38, 16, v1
  v_mfma_f32_32x32x16_bf16 v[192:207], v[108:111], a[136:139], v[192:207]
  buffer_load_dwordx4 v[100:103], v77, s[20:23], s47 offen sc1
  v_and_b32 v39, s42, v1
  v_mul_f32 v38, v38, v54
  v_mul_f32 v39, v39, v55
  v_cvt_pk_bf16_f32 v1, v38, v39
  v_mfma_f32_32x32x16_bf16 v[208:223], v[108:111], a[140:143], v[208:223]
  v_lshlrev_b32 v38, 16, v1
  v_and_b32 v39, s42, v1
  v_mul_f32 v38, v38, v243
  v_mul_f32 v39, v39, v243
  v_cvt_pk_bf16_f32 v1, v38, v39
  v_lshlrev_b32 v38, 16, v1
  s_waitcnt vmcnt(18)
  v_mfma_f32_32x32x16_bf16 v[160:175], v[224:227], a[144:147], v[160:175]
  s_add_u32 s47, s85, s99
  buffer_load_dwordx4 v[104:107], v241, s[20:23], s47 offen sc1
  v_mfma_f32_32x32x16_bf16 v[176:191], v[224:227], a[148:151], v[176:191]
  v_and_b32 v39, s42, v1
  v_mfma_f32_32x32x16_bf16 v[192:207], v[228:231], a[144:147], v[192:207]
  buffer_load_dwordx4 v[108:111], v77, s[20:23], s47 offen sc1
  v_mfma_f32_32x32x16_bf16 v[208:223], v[228:231], a[148:151], v[208:223]
  v_add_f32 v22, v22, v38
  v_add_f32 v23, v23, v39
  s_waitcnt vmcnt(18)
  v_mfma_f32_32x32x16_bf16 v[160:175], v[232:235], a[152:155], v[160:175]
  s_add_u32 s47, s85, s93
  s_add_u32 s47, s47, 4096
  buffer_load_dwordx4 v[224:227], v241, s[20:23], s47 offen sc1
  v_mfma_f32_32x32x16_bf16 v[176:191], v[232:235], a[156:159], v[176:191]
  v_mfma_f32_32x32x16_bf16 v[192:207], v[236:239], a[152:155], v[192:207]
  buffer_load_dwordx4 v[228:231], v77, s[20:23], s47 offen sc1
  v_mfma_f32_32x32x16_bf16 v[208:223], v[236:239], a[156:159], v[208:223]
  s_waitcnt vmcnt(18)
  v_mfma_f32_32x32x16_bf16 v[160:175], v[144:147], a[160:163], v[160:175]
  s_add_u32 s47, s85, s94
  s_add_u32 s47, s47, 4096
  buffer_load_dwordx4 v[232:235], v241, s[20:23], s47 offen sc1
  v_mfma_f32_32x32x16_bf16 v[176:191], v[144:147], a[164:167], v[176:191]
  v_mfma_f32_32x32x16_bf16 v[192:207], v[148:151], a[160:163], v[192:207]
  buffer_load_dwordx4 v[236:239], v77, s[20:23], s47 offen sc1
  v_mfma_f32_32x32x16_bf16 v[208:223], v[148:151], a[164:167], v[208:223]
  s_waitcnt vmcnt(18)
  v_mfma_f32_32x32x16_bf16 v[160:175], v[152:155], a[168:171], v[160:175]
  s_add_u32 s47, s85, s95
  s_add_u32 s47, s47, 4096
  buffer_load_dwordx4 v[144:147], v241, s[20:23], s47 offen sc1
  v_mfma_f32_32x32x16_bf16 v[176:191], v[152:155], a[172:175], v[176:191]
  v_mfma_f32_32x32x16_bf16 v[192:207], v[156:159], a[168:171], v[192:207]
  buffer_load_dwordx4 v[148:151], v77, s[20:23], s47 offen sc1
  v_mfma_f32_32x32x16_bf16 v[208:223], v[156:159], a[172:175], v[208:223]
  s_waitcnt vmcnt(18)
  v_mfma_f32_32x32x16_bf16 v[112:127], v[128:131], a[64:67], v[112:127]
  s_add_u32 s47, s85, s96
  s_add_u32 s47, s47, 4096
  buffer_load_dwordx4 v[152:155], v241, s[20:23], s47 offen sc1
  v_mfma_f32_32x32x16_bf16 a[176:191], v[128:131], a[68:71], a[176:191]
  v_mfma_f32_32x32x16_bf16 a[192:207], v[132:135], a[64:67], a[192:207]
  buffer_load_dwordx4 v[156:159], v77, s[20:23], s47 offen sc1
  v_mfma_f32_32x32x16_bf16 a[208:223], v[132:135], a[68:71], a[208:223]
  s_waitcnt vmcnt(18)
  v_mfma_f32_32x32x16_bf16 v[112:127], v[136:139], a[72:75], v[112:127]
  s_add_u32 s47, s85, s97
  s_add_u32 s47, s47, 4096
  buffer_load_dwordx4 v[128:131], v241, s[20:23], s47 offen sc1
  v_mfma_f32_32x32x16_bf16 a[176:191], v[136:139], a[76:79], a[176:191]
  ds_write_b128 v56, v[176:179] offset:49152
  v_mfma_f32_32x32x16_bf16 a[192:207], v[140:143], a[72:75], a[192:207]
  buffer_load_dwordx4 v[132:135], v77, s[20:23], s47 offen sc1
  ds_write_b128 v56, v[180:183] offset:50176
  ds_write_b128 v56, v[184:187] offset:51200
  v_mfma_f32_32x32x16_bf16 a[208:223], v[140:143], a[76:79], a[208:223]
  ds_write_b128 v56, v[188:191] offset:52224
  ds_write_b128 v57, v[192:195] offset:49152
  ds_write_b128 v57, v[196:199] offset:50176
  s_waitcnt vmcnt(18)
  v_mfma_f32_32x32x16_bf16 v[112:127], v[64:67], a[80:83], v[112:127]
  s_add_u32 s47, s85, s98
  s_add_u32 s47, s47, 4096
  buffer_load_dwordx4 v[136:139], v241, s[20:23], s47 offen sc1
  v_mfma_f32_32x32x16_bf16 a[176:191], v[64:67], a[84:87], a[176:191]
  ds_write_b128 v57, v[200:203] offset:51200
  v_mfma_f32_32x32x16_bf16 a[192:207], v[68:71], a[80:83], a[192:207]
  buffer_load_dwordx4 v[140:143], v77, s[20:23], s47 offen sc1
  ds_write_b128 v57, v[204:207] offset:52224
  ds_write_b128 v58, v[208:211] offset:49152
  v_mfma_f32_32x32x16_bf16 a[208:223], v[68:71], a[84:87], a[208:223]
  ds_write_b128 v58, v[212:215] offset:50176
  ds_write_b128 v58, v[216:219] offset:51200
  ds_write_b128 v58, v[220:223] offset:52224
  s_waitcnt vmcnt(18)
  v_mfma_f32_32x32x16_bf16 v[112:127], v[80:83], a[88:91], v[112:127]
  s_add_u32 s47, s85, s99
  s_add_u32 s47, s47, 4096
  buffer_load_dwordx4 v[64:67], v241, s[20:23], s47 offen sc1
  s_waitcnt lgkmcnt(0)
  s_barrier
  v_mfma_f32_32x32x16_bf16 a[176:191], v[80:83], a[92:95], a[176:191]
  ds_read_b128 v[176:179], v59 offset:49152
  ds_read_b128 v[192:195], v59 offset:53248
  ds_read_b128 v[208:211], v59 offset:57344
  ds_read_b128 v[180:183], v59 offset:50176
  ds_read_b128 v[196:199], v59 offset:54272
  ds_read_b128 v[212:215], v59 offset:58368
  v_mfma_f32_32x32x16_bf16 a[192:207], v[84:87], a[88:91], a[192:207]
  buffer_load_dwordx4 v[68:71], v77, s[20:23], s47 offen sc1
  ds_read_b128 v[184:187], v59 offset:51200
  ds_read_b128 v[200:203], v59 offset:55296
  ds_read_b128 v[216:219], v59 offset:59392
  ds_read_b128 v[188:191], v59 offset:52224
  ds_read_b128 v[204:207], v59 offset:56320
  v_mfma_f32_32x32x16_bf16 a[208:223], v[84:87], a[92:95], a[208:223]
  ds_read_b128 v[220:223], v59 offset:60416
  s_xor_b32 s54, s89, 131072
  s_add_u32 s55, s54, 4096
  s_mov_b32 s8, 0x07060501
  s_mov_b32 s9, 0x07060502
  s_mov_b32 s10, 0x07060503
  s_waitcnt vmcnt(18)
  v_mfma_f32_32x32x16_bf16 v[112:127], v[88:91], a[96:99], v[112:127]
  v_mov_b32 v27, v5
  v_mov_b32 v31, v5
  v_mov_b32 v35, v5
  v_mov_b32 v39, v5
  s_waitcnt lgkmcnt(9)
  v_add_f32 v176, v176, v192
  v_mfma_f32_32x32x16_bf16 a[176:191], v[88:91], a[100:103], a[176:191]
  v_add_f32 v160, v160, v208
  v_add_f32 v177, v177, v193
  v_add_f32 v161, v161, v209
  v_add_f32 v178, v178, v194
  v_mfma_f32_32x32x16_bf16 a[192:207], v[92:95], a[96:99], a[192:207]
  v_add_f32 v162, v162, v210
  v_add_f32 v179, v179, v195
  v_add_f32 v163, v163, v211
  v_add_f32 v160, v160, v176
  v_add_f32 v161, v161, v177
  v_mfma_f32_32x32x16_bf16 a[208:223], v[92:95], a[100:103], a[208:223]
  v_add_f32 v162, v162, v178
  v_add_f32 v163, v163, v179
  v_perm_b32 v24, v160, v163, s8
  v_perm_b32 v25, v161, v163, s9
  s_waitcnt vmcnt(16)
  v_mfma_f32_32x32x16_bf16 v[112:127], v[96:99], a[104:107], v[112:127]
  v_perm_b32 v26, v162, v163, s10
  buffer_store_dwordx4 v[24:27], v63, s[20:23], s54 offen offset:0 sc1
  s_waitcnt lgkmcnt(6)
  v_add_f32 v180, v180, v196
  v_add_f32 v164, v164, v212
  v_add_f32 v181, v181, v197
  v_mfma_f32_32x32x16_bf16 a[176:191], v[96:99], a[108:111], a[176:191]
  v_add_f32 v165, v165, v213
  v_add_f32 v182, v182, v198
  v_add_f32 v166, v166, v214
  v_add_f32 v183, v183, v199
  v_mfma_f32_32x32x16_bf16 a[192:207], v[100:103], a[104:107], a[192:207]
  v_add_f32 v167, v167, v215
  v_add_f32 v164, v164, v180
  v_add_f32 v165, v165, v181
  v_add_f32 v166, v166, v182
  v_add_f32 v167, v167, v183
  v_mfma_f32_32x32x16_bf16 a[208:223], v[100:103], a[108:111], a[208:223]
  v_perm_b32 v28, v164, v167, s8
  v_perm_b32 v29, v165, v167, s9
  v_perm_b32 v30, v166, v167, s10
  buffer_store_dwordx4 v[28:31], v63, s[20:23], s54 offen offset:1024 sc1
  s_waitcnt vmcnt(16)
  v_mfma_f32_32x32x16_bf16 v[112:127], v[104:107], a[112:115], v[112:127]
  s_waitcnt lgkmcnt(3)
  v_add_f32 v184, v184, v200
  v_add_f32 v168, v168, v216
  v_add_f32 v185, v185, v201
  v_add_f32 v169, v169, v217
  v_add_f32 v186, v186, v202
  v_mfma_f32_32x32x16_bf16 a[176:191], v[104:107], a[116:119], a[176:191]
  v_add_f32 v170, v170, v218
  v_add_f32 v187, v187, v203
  v_add_f32 v171, v171, v219
  v_add_f32 v168, v168, v184
  v_mfma_f32_32x32x16_bf16 a[192:207], v[108:111], a[112:115], a[192:207]
  v_add_f32 v169, v169, v185
  v_add_f32 v170, v170, v186
  v_add_f32 v171, v171, v187
  v_perm_b32 v32, v168, v171, s8
  v_perm_b32 v33, v169, v171, s9
  v_mfma_f32_32x32x16_bf16 a[208:223], v[108:111], a[116:119], a[208:223]
  v_perm_b32 v34, v170, v171, s10
  buffer_store_dwordx4 v[32:35], v63, s[20:23], s54 offen offset:2048 sc1
  s_waitcnt lgkmcnt(0)
  v_add_f32 v188, v188, v204
  v_add_f32 v172, v172, v220
  s_waitcnt vmcnt(15)
  v_mfma_f32_32x32x16_bf16 v[112:127], v[224:227], a[120:123], v[112:127]
  v_add_f32 v189, v189, v205
  v_add_f32 v173, v173, v221
  v_add_f32 v190, v190, v206
  v_add_f32 v174, v174, v222
  v_mfma_f32_32x32x16_bf16 a[176:191], v[224:227], a[124:127], a[176:191]
  v_add_f32 v191, v191, v207
  v_add_f32 v175, v175, v223
  v_add_f32 v172, v172, v188
  v_mfma_f32_32x32x16_bf16 a[192:207], v[228:231], a[120:123], a[192:207]
  v_add_f32 v173, v173, v189
  v_add_f32 v174, v174, v190
  v_add_f32 v175, v175, v191
  v_perm_b32 v36, v172, v175, s8
  v_mfma_f32_32x32x16_bf16 a[208:223], v[228:231], a[124:127], a[208:223]
  v_perm_b32 v37, v173, v175, s9
  v_perm_b32 v38, v174, v175, s10
  buffer_store_dwordx4 v[36:39], v63, s[20:23], s54 offen offset:3072 sc1
  s_waitcnt vmcnt(14)
  v_mfma_f32_32x32x16_bf16 v[112:127], v[232:235], a[128:131], v[112:127]
  v_mfma_f32_32x32x16_bf16 a[176:191], v[232:235], a[132:135], a[176:191]
  v_mfma_f32_32x32x16_bf16 a[192:207], v[236:239], a[128:131], a[192:207]
  v_mfma_f32_32x32x16_bf16 a[208:223], v[236:239], a[132:135], a[208:223]
  s_waitcnt vmcnt(12)
  v_mfma_f32_32x32x16_bf16 v[112:127], v[144:147], a[136:139], v[112:127]
  v_mfma_f32_32x32x16_bf16 a[176:191], v[144:147], a[140:143], a[176:191]
  v_mfma_f32_32x32x16_bf16 a[192:207], v[148:151], a[136:139], a[192:207]
  v_mfma_f32_32x32x16_bf16 a[208:223], v[148:151], a[140:143], a[208:223]
  s_waitcnt vmcnt(10)
  v_mfma_f32_32x32x16_bf16 a[208:223], v[156:159], a[148:151], a[208:223]
  s_waitcnt vmcnt(8)
  v_mfma_f32_32x32x16_bf16 a[208:223], v[132:135], a[156:159], a[208:223]
  s_waitcnt vmcnt(6)
  v_mfma_f32_32x32x16_bf16 a[208:223], v[140:143], a[164:167], a[208:223]
  s_waitcnt vmcnt(4)
  v_mfma_f32_32x32x16_bf16 a[208:223], v[68:71], a[172:175], a[208:223]
  v_mfma_f32_32x32x16_bf16 a[192:207], v[156:159], a[144:147], a[192:207]
  s_nop 4
  s_nop 4
  v_mfma_f32_32x32x16_bf16 a[192:207], v[132:135], a[152:155], a[192:207]
  ds_write_b128 v58, a[208:211] offset:0
  v_mfma_f32_32x32x16_bf16 a[192:207], v[140:143], a[160:163], a[192:207]
  ds_write_b128 v58, a[212:215] offset:1024
  ds_write_b128 v58, a[216:219] offset:2048
  v_mfma_f32_32x32x16_bf16 a[192:207], v[68:71], a[168:171], a[192:207]
  ds_write_b128 v58, a[220:223] offset:3072
  v_mfma_f32_32x32x16_bf16 a[176:191], v[152:155], a[148:151], a[176:191]
  s_nop 4
  s_nop 4
  v_mfma_f32_32x32x16_bf16 a[176:191], v[128:131], a[156:159], a[176:191]
  ds_write_b128 v57, a[192:195] offset:0
  v_mfma_f32_32x32x16_bf16 a[176:191], v[136:139], a[164:167], a[176:191]
  ds_write_b128 v57, a[196:199] offset:1024
  ds_write_b128 v57, a[200:203] offset:2048
  v_mfma_f32_32x32x16_bf16 a[176:191], v[64:67], a[172:175], a[176:191]
  ds_write_b128 v57, a[204:207] offset:3072
  v_mfma_f32_32x32x16_bf16 v[112:127], v[152:155], a[144:147], v[112:127]
  s_nop 4
  s_nop 4
  ds_write_b128 v56, a[176:179] offset:0
  v_mfma_f32_32x32x16_bf16 v[112:127], v[128:131], a[152:155], v[112:127]
  ds_write_b128 v56, a[180:183] offset:1024
  ds_write_b128 v56, a[184:187] offset:2048
  v_mfma_f32_32x32x16_bf16 v[112:127], v[136:139], a[160:163], v[112:127]
  ds_write_b128 v56, a[188:191] offset:3072
  buffer_load_dwordx4 v[176:179], v63, s[20:23], s89 offen offset:0 sc1
  buffer_load_dwordx4 v[180:183], v63, s[20:23], s89 offen offset:1024 sc1
  v_mfma_f32_32x32x16_bf16 v[112:127], v[64:67], a[168:171], v[112:127]
  buffer_load_dwordx4 v[184:187], v63, s[20:23], s89 offen offset:2048 sc1
  buffer_load_dwordx4 v[188:191], v63, s[20:23], s89 offen offset:3072 sc1
  s_waitcnt lgkmcnt(0)
  s_barrier
  ds_read_b128 v[128:131], v59 offset:0
  ds_read_b128 v[144:147], v59 offset:4096
  ds_read_b128 v[160:163], v59 offset:8192
  ds_read_b128 v[132:135], v59 offset:1024
  ds_read_b128 v[148:151], v59 offset:5120
  ds_read_b128 v[164:167], v59 offset:9216
  ds_read_b128 v[136:139], v59 offset:2048
  ds_read_b128 v[152:155], v59 offset:6144
  ds_read_b128 v[168:171], v59 offset:10240
  ds_read_b128 v[140:143], v59 offset:3072
  ds_read_b128 v[156:159], v59 offset:7168
  ds_read_b128 v[172:175], v59 offset:11264
  v_pk_add_f32 v[112:113], v[112:113], v[8:9]
  v_pk_add_f32 v[114:115], v[114:115], v[10:11]
  v_pk_add_f32 v[116:117], v[116:117], v[12:13]
  v_pk_add_f32 v[118:119], v[118:119], v[14:15]
  v_pk_add_f32 v[120:121], v[120:121], v[16:17]
  v_pk_add_f32 v[122:123], v[122:123], v[18:19]
  v_pk_add_f32 v[124:125], v[124:125], v[20:21]
  v_pk_add_f32 v[126:127], v[126:127], v[22:23]
  s_waitcnt lgkmcnt(9)
  v_pk_add_f32 v[128:129], v[128:129], v[144:145]
  v_pk_add_f32 v[112:113], v[112:113], v[160:161]
  v_pk_add_f32 v[112:113], v[112:113], v[128:129]
  v_pk_add_f32 v[130:131], v[130:131], v[146:147]
  v_pk_add_f32 v[114:115], v[114:115], v[162:163]
  v_pk_add_f32 v[114:115], v[114:115], v[130:131]
  s_waitcnt lgkmcnt(6)
  v_pk_add_f32 v[132:133], v[132:133], v[148:149]
  v_pk_add_f32 v[116:117], v[116:117], v[164:165]
  v_pk_add_f32 v[116:117], v[116:117], v[132:133]
  v_pk_add_f32 v[134:135], v[134:135], v[150:151]
  v_pk_add_f32 v[118:119], v[118:119], v[166:167]
  v_pk_add_f32 v[118:119], v[118:119], v[134:135]
  s_waitcnt lgkmcnt(3)
  v_pk_add_f32 v[136:137], v[136:137], v[152:153]
  v_pk_add_f32 v[120:121], v[120:121], v[168:169]
  v_pk_add_f32 v[120:121], v[120:121], v[136:137]
  v_pk_add_f32 v[138:139], v[138:139], v[154:155]
  v_pk_add_f32 v[122:123], v[122:123], v[170:171]
  v_pk_add_f32 v[122:123], v[122:123], v[138:139]
  s_waitcnt lgkmcnt(0)
  v_pk_add_f32 v[140:141], v[140:141], v[156:157]
  v_pk_add_f32 v[124:125], v[124:125], v[172:173]
  v_pk_add_f32 v[124:125], v[124:125], v[140:141]
  v_pk_add_f32 v[142:143], v[142:143], v[158:159]
  v_pk_add_f32 v[126:127], v[126:127], v[174:175]
  v_pk_add_f32 v[126:127], v[126:127], v[142:143]
  s_mov_b32 s48, 0
  s_waitcnt vmcnt(0)
L_px:
  v_cmp_ne_u32 vcc, v179, v5
  v_cmp_ne_u32 s[8:9], v183, v5
  s_nop 0
  s_or_b64 vcc, vcc, s[8:9]
  v_cmp_ne_u32 s[8:9], v187, v5
  s_nop 0
  s_or_b64 vcc, vcc, s[8:9]
  v_cmp_ne_u32 s[8:9], v191, v5
  s_nop 0
  s_or_b64 vcc, vcc, s[8:9]
  s_cbranch_scc0 L_px_ok
  buffer_load_dwordx4 v[176:179], v63, s[20:23], s89 offen offset:0 sc1
  buffer_load_dwordx4 v[180:183], v63, s[20:23], s89 offen offset:1024 sc1
  buffer_load_dwordx4 v[184:187], v63, s[20:23], s89 offen offset:2048 sc1
  buffer_load_dwordx4 v[188:191], v63, s[20:23], s89 offen offset:3072 sc1
  s_add_u32 s48, s48, 1
  s_waitcnt vmcnt(0)
  s_cmp_lt_u32 s48, 0x20000
  s_cbranch_scc1 L_px
L_px_ok:
  s_mov_b32 s10, 0x0c04000c
  s_movk_i32 s54, 0
  v_pk_add_f32 v[112:113], v[112:113], v[176:177]
  buffer_store_dword v112, v242, s[36:39], s54 offen nt
  buffer_store_dword v113, v242, s[36:39], s54 offen offset:2048 nt
  s_movk_i32 s54, 4096
  v_perm_b32 v2, v177, v176, s10
  v_lshl_or_b32 v179, v178, 24, v2
  v_pk_add_f32 v[114:115], v[114:115], v[178:179]
  buffer_store_dword v114, v242, s[36:39], s54 offen nt
  buffer_store_dword v115, v242, s[36:39], s54 offen offset:2048 nt
  s_movk_i32 s54, 8192
  v_pk_add_f32 v[116:117], v[116:117], v[180:181]
  buffer_store_dword v116, v242, s[36:39], s54 offen nt
  buffer_store_dword v117, v242, s[36:39], s54 offen offset:2048 nt
  s_movk_i32 s54, 12288
  v_perm_b32 v2, v181, v180, s10
  v_lshl_or_b32 v183, v182, 24, v2
  v_pk_add_f32 v[118:119], v[118:119], v[182:183]
  buffer_store_dword v118, v242, s[36:39], s54 offen nt
  buffer_store_dword v119, v242, s[36:39], s54 offen offset:2048 nt
  s_movk_i32 s54, 16384
  v_pk_add_f32 v[120:121], v[120:121], v[184:185]
  buffer_store_dword v120, v242, s[36:39], s54 offen nt
  buffer_store_dword v121, v242, s[36:39], s54 offen offset:2048 nt
  s_movk_i32 s54, 20480
  v_perm_b32 v2, v185, v184, s10
  v_lshl_or_b32 v187, v186, 24, v2
  v_pk_add_f32 v[122:123], v[122:123], v[186:187]
  buffer_store_dword v122, v242, s[36:39], s54 offen nt
  buffer_store_dword v123, v242, s[36:39], s54 offen offset:2048 nt
  s_movk_i32 s54, 24576
  v_pk_add_f32 v[124:125], v[124:125], v[188:189]
  buffer_store_dword v124, v242, s[36:39], s54 offen nt
  buffer_store_dword v125, v242, s[36:39], s54 offen offset:2048 nt
  s_movk_i32 s54, 28672
  v_perm_b32 v2, v189, v188, s10
  v_lshl_or_b32 v191, v190, 24, v2
  v_pk_add_f32 v[126:127], v[126:127], v[190:191]
  buffer_store_dword v126, v242, s[36:39], s54 offen nt
  buffer_store_dword v127, v242, s[36:39], s54 offen offset:2048 nt
  buffer_store_dword v5, v76, s[20:23], s90 offen sc1
L_end:
  s_endpgm

.section .rodata,"a"
.p2align 6
.amdhsa_kernel parallel_sum__ssm_conv_s5__dense_activation_relu__prompt_kernel
  .amdhsa_next_free_vgpr 512
  .amdhsa_next_free_sgpr 102
  .amdhsa_accum_offset 256
  .amdhsa_group_segment_fixed_size 0
  .amdhsa_kernarg_size 120
  .amdhsa_user_sgpr_count 2
  .amdhsa_user_sgpr_kernarg_segment_ptr 1
  .amdhsa_system_sgpr_workgroup_id_x 1
.end_amdhsa_kernel

.p2align 8
.type tbl_v,@object
tbl_v:
.long 0,1835008,0,11862016,0,0,11665408,0,229376,0,11796480,11796512,0,0,11796480,360448
.long 229376,0,0,0,0,12582912,268435456,147456,11862016,0,2048,8192,10240,16384,18432,24576
.long 57344,1777664,0,11862272,0,128,11665408,256,233472,8192,11796480,11796516,4,4,11796608,360448
.long 245760,0,64,128,64,12587008,268435456,147456,11862032,26624,32768,34816,40960,43008,49152,51200
.long 114688,1720320,0,11862528,0,256,11665408,0,589824,360448,11796496,11796528,0,0,11796736,360448
.long 262144,0,32768,65536,0,12591104,268435456,147584,11862048,57344,59392,65536,67584,73728,75776,81920
.long 172032,1662976,0,11862784,0,384,11665408,256,593920,368640,11796496,11796532,4,4,11796864,360448
.long 278528,0,32832,65664,64,12595200,268435456,147584,11862064,83968,90112,92160,98304,100352,106496,108544
.long 1792,1833216,229376,11862016,0,512,11730944,0,294912,114688,11796480,11797024,512,512,11796992,0
.long 294912,360448,65536,131072,0,12713984,268435456,147712,11862528,114688,116736,122880,124928,131072,133120,139264
.long 59136,1775872,229376,11862272,0,640,11730944,256,299008,122880,11796480,11797028,516,516,11797120,0
.long 311296,360448,65600,131200,64,12718080,268435456,147712,11862544,141312,147456,149504,155648,157696,163840,165888
.long 116480,1718528,229376,11862528,0,768,11730944,0,655360,475136,11796496,11797040,512,512,11797248,0
.long 327680,360448,98304,196608,0,12722176,268435456,147840,11862560,172032,174080,180224,182272,188416,190464,196608
.long 173824,1661184,229376,11862784,0,896,11730944,256,659456,483328,11796496,11797044,516,516,11797376,0
.long 344064,360448,98368,196736,64,12726272,268435456,147840,11862576,198656,204800,206848,212992,215040,221184,223232
.long 0,1835008,458752,11866112,0,0,11665408,2048,3112960,2883584,11800576,11800608,0,0,11800576,3244032
.long 229376,2883584,524288,1048576,0,13631488,268435456,147456,11866112,0,2048,8192,10240,16384,18432,24576
.long 57344,1777664,458752,11866368,0,128,11665408,2304,3117056,2891776,11800576,11800612,4,4,11800704,3244032
.long 245760,2883584,524352,1048704,64,13635584,268435456,147456,11866128,26624,32768,34816,40960,43008,49152,51200
.long 114688,1720320,458752,11866624,0,256,11665408,2048,3473408,3244032,11800592,11800624,0,0,11800832,3244032
.long 262144,2883584,557056,1114112,0,13639680,268435456,147584,11866144,57344,59392,65536,67584,73728,75776,81920
.long 172032,1662976,458752,11866880,0,384,11665408,2304,3477504,3252224,11800592,11800628,4,4,11800960,3244032
.long 278528,2883584,557120,1114240,64,13643776,268435456,147584,11866160,83968,90112,92160,98304,100352,106496,108544
.long 1792,1833216,688128,11866112,0,512,11730944,2048,3178496,2998272,11800576,11801120,512,512,11801088,2883584
.long 294912,3244032,589824,1179648,0,13762560,268435456,147712,11866624,114688,116736,122880,124928,131072,133120,139264
.long 59136,1775872,688128,11866368,0,640,11730944,2304,3182592,3006464,11800576,11801124,516,516,11801216,2883584
.long 311296,3244032,589888,1179776,64,13766656,268435456,147712,11866640,141312,147456,149504,155648,157696,163840,165888
.long 116480,1718528,688128,11866624,0,768,11730944,2048,3538944,3358720,11800592,11801136,512,512,11801344,2883584
.long 327680,3244032,622592,1245184,0,13770752,268435456,147840,11866656,172032,174080,180224,182272,188416,190464,196608
.long 173824,1661184,688128,11866880,0,896,11730944,2304,3543040,3366912,11800592,11801140,516,516,11801472,2883584
.long 344064,3244032,622656,1245312,64,13774848,268435456,147840,11866672,198656,204800,206848,212992,215040,221184,223232
.long 0,1835008,917504,11870208,0,0,11665408,4096,5996544,5767168,11804672,11804704,0,0,11804672,6127616
.long 229376,5767168,1048576,2097152,0,14680064,268435456,147456,11870208,0,2048,8192,10240,16384,18432,24576
.long 57344,1777664,917504,11870464,0,128,11665408,4352,6000640,5775360,11804672,11804708,4,4,11804800,6127616
.long 245760,5767168,1048640,2097280,64,14684160,268435456,147456,11870224,26624,32768,34816,40960,43008,49152,51200
.long 114688,1720320,917504,11870720,0,256,11665408,4096,6356992,6127616,11804688,11804720,0,0,11804928,6127616
.long 262144,5767168,1081344,2162688,0,14688256,268435456,147584,11870240,57344,59392,65536,67584,73728,75776,81920
.long 172032,1662976,917504,11870976,0,384,11665408,4352,6361088,6135808,11804688,11804724,4,4,11805056,6127616
.long 278528,5767168,1081408,2162816,64,14692352,268435456,147584,11870256,83968,90112,92160,98304,100352,106496,108544
.long 1792,1833216,1146880,11870208,0,512,11730944,4096,6062080,5881856,11804672,11805216,512,512,11805184,5767168
.long 294912,6127616,1114112,2228224,0,14811136,268435456,147712,11870720,114688,116736,122880,124928,131072,133120,139264
.long 59136,1775872,1146880,11870464,0,640,11730944,4352,6066176,5890048,11804672,11805220,516,516,11805312,5767168
.long 311296,6127616,1114176,2228352,64,14815232,268435456,147712,11870736,141312,147456,149504,155648,157696,163840,165888
.long 116480,1718528,1146880,11870720,0,768,11730944,4096,6422528,6242304,11804688,11805232,512,512,11805440,5767168
.long 327680,6127616,1146880,2293760,0,14819328,268435456,147840,11870752,172032,174080,180224,182272,188416,190464,196608
.long 173824,1661184,1146880,11870976,0,896,11730944,4352,6426624,6250496,11804688,11805236,516,516,11805568,5767168
.long 344064,6127616,1146944,2293888,64,14823424,268435456,147840,11870768,198656,204800,206848,212992,215040,221184,223232
.long 0,1835008,1376256,11874304,0,0,11665408,6144,8880128,8650752,11808768,11808800,0,0,11808768,9011200
.long 229376,8650752,1572864,3145728,0,15728640,268435456,147456,11874304,0,2048,8192,10240,16384,18432,24576
.long 57344,1777664,1376256,11874560,0,128,11665408,6400,8884224,8658944,11808768,11808804,4,4,11808896,9011200
.long 245760,8650752,1572928,3145856,64,15732736,268435456,147456,11874320,26624,32768,34816,40960,43008,49152,51200
.long 114688,1720320,1376256,11874816,0,256,11665408,6144,9240576,9011200,11808784,11808816,0,0,11809024,9011200
.long 262144,8650752,1605632,3211264,0,15736832,268435456,147584,11874336,57344,59392,65536,67584,73728,75776,81920
.long 172032,1662976,1376256,11875072,0,384,11665408,6400,9244672,9019392,11808784,11808820,4,4,11809152,9011200
.long 278528,8650752,1605696,3211392,64,15740928,268435456,147584,11874352,83968,90112,92160,98304,100352,106496,108544
.long 1792,1833216,1605632,11874304,0,512,11730944,6144,8945664,8765440,11808768,11809312,512,512,11809280,8650752
.long 294912,9011200,1638400,3276800,0,15859712,268435456,147712,11874816,114688,116736,122880,124928,131072,133120,139264
.long 59136,1775872,1605632,11874560,0,640,11730944,6400,8949760,8773632,11808768,11809316,516,516,11809408,8650752
.long 311296,9011200,1638464,3276928,64,15863808,268435456,147712,11874832,141312,147456,149504,155648,157696,163840,165888
.long 116480,1718528,1605632,11874816,0,768,11730944,6144,9306112,9125888,11808784,11809328,512,512,11809536,8650752
.long 327680,9011200,1671168,3342336,0,15867904,268435456,147840,11874848,172032,174080,180224,182272,188416,190464,196608
.long 173824,1661184,1605632,11875072,0,896,11730944,6400,9310208,9134080,11808784,11809332,516,516,11809664,8650752
.long 344064,9011200,1671232,3342464,64,15872000,268435456,147840,11874864,198656,204800,206848,212992,215040,221184,223232
.long 0,1835008,0,11863040,0,0,11665408,512,950272,720896,11797504,11797536,0,0,11797504,1081344
.long 231424,720896,131072,262144,0,12845056,268435456,147456,11863040,2048,8192,10240,16384,18432,24576,0
.long 57344,1777664,0,11863296,0,128,11665408,768,954368,729088,11797504,11797540,4,4,11797632,1081344
.long 247808,720896,131136,262272,64,12849152,268435456,147456,11863056,32768,34816,40960,43008,49152,51200,26624
.long 114688,1720320,0,11863552,0,256,11665408,512,1310720,1081344,11797520,11797552,0,0,11797760,1081344
.long 264192,720896,163840,327680,0,12853248,268435456,147584,11863072,59392,65536,67584,73728,75776,81920,57344
.long 172032,1662976,0,11863808,0,384,11665408,768,1314816,1089536,11797520,11797556,4,4,11797888,1081344
.long 280576,720896,163904,327808,64,12857344,268435456,147584,11863088,90112,92160,98304,100352,106496,108544,83968
.long 1792,1833216,229376,11863040,0,512,11730944,512,1015808,835584,11797504,11798048,512,512,11798016,720896
.long 296960,1081344,196608,393216,0,12976128,268435456,147712,11863552,116736,122880,124928,131072,133120,139264,114688
.long 59136,1775872,229376,11863296,0,640,11730944,768,1019904,843776,11797504,11798052,516,516,11798144,720896
.long 313344,1081344,196672,393344,64,12980224,268435456,147712,11863568,147456,149504,155648,157696,163840,165888,141312
.long 116480,1718528,229376,11863552,0,768,11730944,512,1376256,1196032,11797520,11798064,512,512,11798272,720896
.long 329728,1081344,229376,458752,0,12984320,268435456,147840,11863584,174080,180224,182272,188416,190464,196608,172032
.long 173824,1661184,229376,11863808,0,896,11730944,768,1380352,1204224,11797520,11798068,516,516,11798400,720896
.long 346112,1081344,229440,458880,64,12988416,268435456,147840,11863600,204800,206848,212992,215040,221184,223232,198656
.long 0,1835008,458752,11867136,0,0,11665408,2560,3833856,3604480,11801600,11801632,0,0,11801600,3964928
.long 231424,3604480,655360,1310720,0,13893632,268435456,147456,11867136,2048,8192,10240,16384,18432,24576,0
.long 57344,1777664,458752,11867392,0,128,11665408,2816,3837952,3612672,11801600,11801636,4,4,11801728,3964928
.long 247808,3604480,655424,1310848,64,13897728,268435456,147456,11867152,32768,34816,40960,43008,49152,51200,26624
.long 114688,1720320,458752,11867648,0,256,11665408,2560,4194304,3964928,11801616,11801648,0,0,11801856,3964928
.long 264192,3604480,688128,1376256,0,13901824,268435456,147584,11867168,59392,65536,67584,73728,75776,81920,57344
.long 172032,1662976,458752,11867904,0,384,11665408,2816,4198400,3973120,11801616,11801652,4,4,11801984,3964928
.long 280576,3604480,688192,1376384,64,13905920,268435456,147584,11867184,90112,92160,98304,100352,106496,108544,83968
.long 1792,1833216,688128,11867136,0,512,11730944,2560,3899392,3719168,11801600,11802144,512,512,11802112,3604480
.long 296960,3964928,720896,1441792,0,14024704,268435456,147712,11867648,116736,122880,124928,131072,133120,139264,114688
.long 59136,1775872,688128,11867392,0,640,11730944,2816,3903488,3727360,11801600,11802148,516,516,11802240,3604480
.long 313344,3964928,720960,1441920,64,14028800,268435456,147712,11867664,147456,149504,155648,157696,163840,165888,141312
.long 116480,1718528,688128,11867648,0,768,11730944,2560,4259840,4079616,11801616,11802160,512,512,11802368,3604480
.long 329728,3964928,753664,1507328,0,14032896,268435456,147840,11867680,174080,180224,182272,188416,190464,196608,172032
.long 173824,1661184,688128,11867904,0,896,11730944,2816,4263936,4087808,11801616,11802164,516,516,11802496,3604480
.long 346112,3964928,753728,1507456,64,14036992,268435456,147840,11867696,204800,206848,212992,215040,221184,223232,198656
.long 0,1835008,917504,11871232,0,0,11665408,4608,6717440,6488064,11805696,11805728,0,0,11805696,6848512
.long 231424,6488064,1179648,2359296,0,14942208,268435456,147456,11871232,2048,8192,10240,16384,18432,24576,0
.long 57344,1777664,917504,11871488,0,128,11665408,4864,6721536,6496256,11805696,11805732,4,4,11805824,6848512
.long 247808,6488064,1179712,2359424,64,14946304,268435456,147456,11871248,32768,34816,40960,43008,49152,51200,26624
.long 114688,1720320,917504,11871744,0,256,11665408,4608,7077888,6848512,11805712,11805744,0,0,11805952,6848512
.long 264192,6488064,1212416,2424832,0,14950400,268435456,147584,11871264,59392,65536,67584,73728,75776,81920,57344
.long 172032,1662976,917504,11872000,0,384,11665408,4864,7081984,6856704,11805712,11805748,4,4,11806080,6848512
.long 280576,6488064,1212480,2424960,64,14954496,268435456,147584,11871280,90112,92160,98304,100352,106496,108544,83968
.long 1792,1833216,1146880,11871232,0,512,11730944,4608,6782976,6602752,11805696,11806240,512,512,11806208,6488064
.long 296960,6848512,1245184,2490368,0,15073280,268435456,147712,11871744,116736,122880,124928,131072,133120,139264,114688
.long 59136,1775872,1146880,11871488,0,640,11730944,4864,6787072,6610944,11805696,11806244,516,516,11806336,6488064
.long 313344,6848512,1245248,2490496,64,15077376,268435456,147712,11871760,147456,149504,155648,157696,163840,165888,141312
.long 116480,1718528,1146880,11871744,0,768,11730944,4608,7143424,6963200,11805712,11806256,512,512,11806464,6488064
.long 329728,6848512,1277952,2555904,0,15081472,268435456,147840,11871776,174080,180224,182272,188416,190464,196608,172032
.long 173824,1661184,1146880,11872000,0,896,11730944,4864,7147520,6971392,11805712,11806260,516,516,11806592,6488064
.long 346112,6848512,1278016,2556032,64,15085568,268435456,147840,11871792,204800,206848,212992,215040,221184,223232,198656
.long 0,1835008,1376256,11875328,0,0,11665408,6656,9601024,9371648,11809792,11809824,0,0,11809792,9732096
.long 231424,9371648,1703936,3407872,0,15990784,268435456,147456,11875328,2048,8192,10240,16384,18432,24576,0
.long 57344,1777664,1376256,11875584,0,128,11665408,6912,9605120,9379840,11809792,11809828,4,4,11809920,9732096
.long 247808,9371648,1704000,3408000,64,15994880,268435456,147456,11875344,32768,34816,40960,43008,49152,51200,26624
.long 114688,1720320,1376256,11875840,0,256,11665408,6656,9961472,9732096,11809808,11809840,0,0,11810048,9732096
.long 264192,9371648,1736704,3473408,0,15998976,268435456,147584,11875360,59392,65536,67584,73728,75776,81920,57344
.long 172032,1662976,1376256,11876096,0,384,11665408,6912,9965568,9740288,11809808,11809844,4,4,11810176,9732096
.long 280576,9371648,1736768,3473536,64,16003072,268435456,147584,11875376,90112,92160,98304,100352,106496,108544,83968
.long 1792,1833216,1605632,11875328,0,512,11730944,6656,9666560,9486336,11809792,11810336,512,512,11810304,9371648
.long 296960,9732096,1769472,3538944,0,16121856,268435456,147712,11875840,116736,122880,124928,131072,133120,139264,114688
.long 59136,1775872,1605632,11875584,0,640,11730944,6912,9670656,9494528,11809792,11810340,516,516,11810432,9371648
.long 313344,9732096,1769536,3539072,64,16125952,268435456,147712,11875856,147456,149504,155648,157696,163840,165888,141312
.long 116480,1718528,1605632,11875840,0,768,11730944,6656,10027008,9846784,11809808,11810352,512,512,11810560,9371648
.long 329728,9732096,1802240,3604480,0,16130048,268435456,147840,11875872,174080,180224,182272,188416,190464,196608,172032
.long 173824,1661184,1605632,11876096,0,896,11730944,6912,10031104,9854976,11809808,11810356,516,516,11810688,9371648
.long 346112,9732096,1802304,3604608,64,16134144,268435456,147840,11875888,204800,206848,212992,215040,221184,223232,198656
.long 0,1835008,0,11864064,0,0,11665408,1024,1671168,1441792,11798528,11798560,0,0,11798528,1802240
.long 229376,1441792,262144,524288,0,13107200,268435456,147456,11864064,10240,16384,18432,24576,0,2048,8192
.long 57344,1777664,0,11864320,0,128,11665408,1280,1675264,1449984,11798528,11798564,4,4,11798656,1802240
.long 245760,1441792,262208,524416,64,13111296,268435456,147456,11864080,40960,43008,49152,51200,26624,32768,34816
.long 114688,1720320,0,11864576,0,256,11665408,1024,2031616,1802240,11798544,11798576,0,0,11798784,1802240
.long 262144,1441792,294912,589824,0,13115392,268435456,147584,11864096,67584,73728,75776,81920,57344,59392,65536
.long 172032,1662976,0,11864832,0,384,11665408,1280,2035712,1810432,11798544,11798580,4,4,11798912,1802240
.long 278528,1441792,294976,589952,64,13119488,268435456,147584,11864112,98304,100352,106496,108544,83968,90112,92160
.long 1792,1833216,229376,11864064,0,512,11730944,1024,1736704,1556480,11798528,11799072,512,512,11799040,1441792
.long 294912,1802240,327680,655360,0,13238272,268435456,147712,11864576,124928,131072,133120,139264,114688,116736,122880
.long 59136,1775872,229376,11864320,0,640,11730944,1280,1740800,1564672,11798528,11799076,516,516,11799168,1441792
.long 311296,1802240,327744,655488,64,13242368,268435456,147712,11864592,155648,157696,163840,165888,141312,147456,149504
.long 116480,1718528,229376,11864576,0,768,11730944,1024,2097152,1916928,11798544,11799088,512,512,11799296,1441792
.long 327680,1802240,360448,720896,0,13246464,268435456,147840,11864608,182272,188416,190464,196608,172032,174080,180224
.long 173824,1661184,229376,11864832,0,896,11730944,1280,2101248,1925120,11798544,11799092,516,516,11799424,1441792
.long 344064,1802240,360512,721024,64,13250560,268435456,147840,11864624,212992,215040,221184,223232,198656,204800,206848
.long 0,1835008,458752,11868160,0,0,11665408,3072,4554752,4325376,11802624,11802656,0,0,11802624,4685824
.long 229376,4325376,786432,1572864,0,14155776,268435456,147456,11868160,10240,16384,18432,24576,0,2048,8192
.long 57344,1777664,458752,11868416,0,128,11665408,3328,4558848,4333568,11802624,11802660,4,4,11802752,4685824
.long 245760,4325376,786496,1572992,64,14159872,268435456,147456,11868176,40960,43008,49152,51200,26624,32768,34816
.long 114688,1720320,458752,11868672,0,256,11665408,3072,4915200,4685824,11802640,11802672,0,0,11802880,4685824
.long 262144,4325376,819200,1638400,0,14163968,268435456,147584,11868192,67584,73728,75776,81920,57344,59392,65536
.long 172032,1662976,458752,11868928,0,384,11665408,3328,4919296,4694016,11802640,11802676,4,4,11803008,4685824
.long 278528,4325376,819264,1638528,64,14168064,268435456,147584,11868208,98304,100352,106496,108544,83968,90112,92160
.long 1792,1833216,688128,11868160,0,512,11730944,3072,4620288,4440064,11802624,11803168,512,512,11803136,4325376
.long 294912,4685824,851968,1703936,0,14286848,268435456,147712,11868672,124928,131072,133120,139264,114688,116736,122880
.long 59136,1775872,688128,11868416,0,640,11730944,3328,4624384,4448256,11802624,11803172,516,516,11803264,4325376
.long 311296,4685824,852032,1704064,64,14290944,268435456,147712,11868688,155648,157696,163840,165888,141312,147456,149504
.long 116480,1718528,688128,11868672,0,768,11730944,3072,4980736,4800512,11802640,11803184,512,512,11803392,4325376
.long 327680,4685824,884736,1769472,0,14295040,268435456,147840,11868704,182272,188416,190464,196608,172032,174080,180224
.long 173824,1661184,688128,11868928,0,896,11730944,3328,4984832,4808704,11802640,11803188,516,516,11803520,4325376
.long 344064,4685824,884800,1769600,64,14299136,268435456,147840,11868720,212992,215040,221184,223232,198656,204800,206848
.long 0,1835008,917504,11872256,0,0,11665408,5120,7438336,7208960,11806720,11806752,0,0,11806720,7569408
.long 229376,7208960,1310720,2621440,0,15204352,268435456,147456,11872256,10240,16384,18432,24576,0,2048,8192
.long 57344,1777664,917504,11872512,0,128,11665408,5376,7442432,7217152,11806720,11806756,4,4,11806848,7569408
.long 245760,7208960,1310784,2621568,64,15208448,268435456,147456,11872272,40960,43008,49152,51200,26624,32768,34816
.long 114688,1720320,917504,11872768,0,256,11665408,5120,7798784,7569408,11806736,11806768,0,0,11806976,7569408
.long 262144,7208960,1343488,2686976,0,15212544,268435456,147584,11872288,67584,73728,75776,81920,57344,59392,65536
.long 172032,1662976,917504,11873024,0,384,11665408,5376,7802880,7577600,11806736,11806772,4,4,11807104,7569408
.long 278528,7208960,1343552,2687104,64,15216640,268435456,147584,11872304,98304,100352,106496,108544,83968,90112,92160
.long 1792,1833216,1146880,11872256,0,512,11730944,5120,7503872,7323648,11806720,11807264,512,512,11807232,7208960
.long 294912,7569408,1376256,2752512,0,15335424,268435456,147712,11872768,124928,131072,133120,139264,114688,116736,122880
.long 59136,1775872,1146880,11872512,0,640,11730944,5376,7507968,7331840,11806720,11807268,516,516,11807360,7208960
.long 311296,7569408,1376320,2752640,64,15339520,268435456,147712,11872784,155648,157696,163840,165888,141312,147456,149504
.long 116480,1718528,1146880,11872768,0,768,11730944,5120,7864320,7684096,11806736,11807280,512,512,11807488,7208960
.long 327680,7569408,1409024,2818048,0,15343616,268435456,147840,11872800,182272,188416,190464,196608,172032,174080,180224
.long 173824,1661184,1146880,11873024,0,896,11730944,5376,7868416,7692288,11806736,11807284,516,516,11807616,7208960
.long 344064,7569408,1409088,2818176,64,15347712,268435456,147840,11872816,212992,215040,221184,223232,198656,204800,206848
.long 0,1835008,1376256,11876352,0,0,11665408,7168,10321920,10092544,11810816,11810848,0,0,11810816,10452992
.long 229376,10092544,1835008,3670016,0,16252928,268435456,147456,11876352,10240,16384,18432,24576,0,2048,8192
.long 57344,1777664,1376256,11876608,0,128,11665408,7424,10326016,10100736,11810816,11810852,4,4,11810944,10452992
.long 245760,10092544,1835072,3670144,64,16257024,268435456,147456,11876368,40960,43008,49152,51200,26624,32768,34816
.long 114688,1720320,1376256,11876864,0,256,11665408,7168,10682368,10452992,11810832,11810864,0,0,11811072,10452992
.long 262144,10092544,1867776,3735552,0,16261120,268435456,147584,11876384,67584,73728,75776,81920,57344,59392,65536
.long 172032,1662976,1376256,11877120,0,384,11665408,7424,10686464,10461184,11810832,11810868,4,4,11811200,10452992
.long 278528,10092544,1867840,3735680,64,16265216,268435456,147584,11876400,98304,100352,106496,108544,83968,90112,92160
.long 1792,1833216,1605632,11876352,0,512,11730944,7168,10387456,10207232,11810816,11811360,512,512,11811328,10092544
.long 294912,10452992,1900544,3801088,0,16384000,268435456,147712,11876864,124928,131072,133120,139264,114688,116736,122880
.long 59136,1775872,1605632,11876608,0,640,11730944,7424,10391552,10215424,11810816,11811364,516,516,11811456,10092544
.long 311296,10452992,1900608,3801216,64,16388096,268435456,147712,11876880,155648,157696,163840,165888,141312,147456,149504
.long 116480,1718528,1605632,11876864,0,768,11730944,7168,10747904,10567680,11810832,11811376,512,512,11811584,10092544
.long 327680,10452992,1933312,3866624,0,16392192,268435456,147840,11876896,182272,188416,190464,196608,172032,174080,180224
.long 173824,1661184,1605632,11877120,0,896,11730944,7424,10752000,10575872,11810832,11811380,516,516,11811712,10092544
.long 344064,10452992,1933376,3866752,64,16396288,268435456,147840,11876912,212992,215040,221184,223232,198656,204800,206848
.long 0,1835008,0,11865088,0,0,11665408,1536,2392064,2162688,11799552,11799584,0,0,11799552,2523136
.long 231424,2162688,393216,786432,0,13369344,268435456,147456,11865088,18432,24576,0,2048,8192,10240,16384
.long 57344,1777664,0,11865344,0,128,11665408,1792,2396160,2170880,11799552,11799588,4,4,11799680,2523136
.long 247808,2162688,393280,786560,64,13373440,268435456,147456,11865104,49152,51200,26624,32768,34816,40960,43008
.long 114688,1720320,0,11865600,0,256,11665408,1536,2752512,2523136,11799568,11799600,0,0,11799808,2523136
.long 264192,2162688,425984,851968,0,13377536,268435456,147584,11865120,75776,81920,57344,59392,65536,67584,73728
.long 172032,1662976,0,11865856,0,384,11665408,1792,2756608,2531328,11799568,11799604,4,4,11799936,2523136
.long 280576,2162688,426048,852096,64,13381632,268435456,147584,11865136,106496,108544,83968,90112,92160,98304,100352
.long 1792,1833216,229376,11865088,0,512,11730944,1536,2457600,2277376,11799552,11800096,512,512,11800064,2162688
.long 296960,2523136,458752,917504,0,13500416,268435456,147712,11865600,133120,139264,114688,116736,122880,124928,131072
.long 59136,1775872,229376,11865344,0,640,11730944,1792,2461696,2285568,11799552,11800100,516,516,11800192,2162688
.long 313344,2523136,458816,917632,64,13504512,268435456,147712,11865616,163840,165888,141312,147456,149504,155648,157696
.long 116480,1718528,229376,11865600,0,768,11730944,1536,2818048,2637824,11799568,11800112,512,512,11800320,2162688
.long 329728,2523136,491520,983040,0,13508608,268435456,147840,11865632,190464,196608,172032,174080,180224,182272,188416
.long 173824,1661184,229376,11865856,0,896,11730944,1792,2822144,2646016,11799568,11800116,516,516,11800448,2162688
.long 346112,2523136,491584,983168,64,13512704,268435456,147840,11865648,221184,223232,198656,204800,206848,212992,215040
.long 0,1835008,458752,11869184,0,0,11665408,3584,5275648,5046272,11803648,11803680,0,0,11803648,5406720
.long 231424,5046272,917504,1835008,0,14417920,268435456,147456,11869184,18432,24576,0,2048,8192,10240,16384
.long 57344,1777664,458752,11869440,0,128,11665408,3840,5279744,5054464,11803648,11803684,4,4,11803776,5406720
.long 247808,5046272,917568,1835136,64,14422016,268435456,147456,11869200,49152,51200,26624,32768,34816,40960,43008
.long 114688,1720320,458752,11869696,0,256,11665408,3584,5636096,5406720,11803664,11803696,0,0,11803904,5406720
.long 264192,5046272,950272,1900544,0,14426112,268435456,147584,11869216,75776,81920,57344,59392,65536,67584,73728
.long 172032,1662976,458752,11869952,0,384,11665408,3840,5640192,5414912,11803664,11803700,4,4,11804032,5406720
.long 280576,5046272,950336,1900672,64,14430208,268435456,147584,11869232,106496,108544,83968,90112,92160,98304,100352
.long 1792,1833216,688128,11869184,0,512,11730944,3584,5341184,5160960,11803648,11804192,512,512,11804160,5046272
.long 296960,5406720,983040,1966080,0,14548992,268435456,147712,11869696,133120,139264,114688,116736,122880,124928,131072
.long 59136,1775872,688128,11869440,0,640,11730944,3840,5345280,5169152,11803648,11804196,516,516,11804288,5046272
.long 313344,5406720,983104,1966208,64,14553088,268435456,147712,11869712,163840,165888,141312,147456,149504,155648,157696
.long 116480,1718528,688128,11869696,0,768,11730944,3584,5701632,5521408,11803664,11804208,512,512,11804416,5046272
.long 329728,5406720,1015808,2031616,0,14557184,268435456,147840,11869728,190464,196608,172032,174080,180224,182272,188416
.long 173824,1661184,688128,11869952,0,896,11730944,3840,5705728,5529600,11803664,11804212,516,516,11804544,5046272
.long 346112,5406720,1015872,2031744,64,14561280,268435456,147840,11869744,221184,223232,198656,204800,206848,212992,215040
.long 0,1835008,917504,11873280,0,0,11665408,5632,8159232,7929856,11807744,11807776,0,0,11807744,8290304
.long 231424,7929856,1441792,2883584,0,15466496,268435456,147456,11873280,18432,24576,0,2048,8192,10240,16384
.long 57344,1777664,917504,11873536,0,128,11665408,5888,8163328,7938048,11807744,11807780,4,4,11807872,8290304
.long 247808,7929856,1441856,2883712,64,15470592,268435456,147456,11873296,49152,51200,26624,32768,34816,40960,43008
.long 114688,1720320,917504,11873792,0,256,11665408,5632,8519680,8290304,11807760,11807792,0,0,11808000,8290304
.long 264192,7929856,1474560,2949120,0,15474688,268435456,147584,11873312,75776,81920,57344,59392,65536,67584,73728
.long 172032,1662976,917504,11874048,0,384,11665408,5888,8523776,8298496,11807760,11807796,4,4,11808128,8290304
.long 280576,7929856,1474624,2949248,64,15478784,268435456,147584,11873328,106496,108544,83968,90112,92160,98304,100352
.long 1792,1833216,1146880,11873280,0,512,11730944,5632,8224768,8044544,11807744,11808288,512,512,11808256,7929856
.long 296960,8290304,1507328,3014656,0,15597568,268435456,147712,11873792,133120,139264,114688,116736,122880,124928,131072
.long 59136,1775872,1146880,11873536,0,640,11730944,5888,8228864,8052736,11807744,11808292,516,516,11808384,7929856
.long 313344,8290304,1507392,3014784,64,15601664,268435456,147712,11873808,163840,165888,141312,147456,149504,155648,157696
.long 116480,1718528,1146880,11873792,0,768,11730944,5632,8585216,8404992,11807760,11808304,512,512,11808512,7929856
.long 329728,8290304,1540096,3080192,0,15605760,268435456,147840,11873824,190464,196608,172032,174080,180224,182272,188416
.long 173824,1661184,1146880,11874048,0,896,11730944,5888,8589312,8413184,11807760,11808308,516,516,11808640,7929856
.long 346112,8290304,1540160,3080320,64,15609856,268435456,147840,11873840,221184,223232,198656,204800,206848,212992,215040
.long 0,1835008,1376256,11877376,0,0,11665408,7680,11042816,10813440,11811840,11811872,0,0,11811840,11173888
.long 231424,10813440,1966080,3932160,0,16515072,11927552,147456,11877376,18432,24576,0,2048,8192,10240,16384
.long 57344,1777664,1376256,11877632,0,128,11665408,7936,11046912,10821632,11811840,11811876,4,4,11811968,11173888
.long 247808,10813440,1966144,3932288,64,16519168,268435456,147456,11877392,49152,51200,26624,32768,34816,40960,43008
.long 114688,1720320,1376256,11877888,0,256,11665408,7680,11403264,11173888,11811856,11811888,0,0,11812096,11173888
.long 264192,10813440,1998848,3997696,0,16523264,268435456,147584,11877408,75776,81920,57344,59392,65536,67584,73728
.long 172032,1662976,1376256,11878144,0,384,11665408,7936,11407360,11182080,11811856,11811892,4,4,11812224,11173888
.long 280576,10813440,1998912,3997824,64,16527360,268435456,147584,11877424,106496,108544,83968,90112,92160,98304,100352
.long 1792,1833216,1605632,11877376,0,512,11730944,7680,11108352,10928128,11811840,11812384,512,512,11812352,10813440
.long 296960,11173888,2031616,4063232,0,16646144,268435456,147712,11877888,133120,139264,114688,116736,122880,124928,131072
.long 59136,1775872,1605632,11877632,0,640,11730944,7936,11112448,10936320,11811840,11812388,516,516,11812480,10813440
.long 313344,11173888,2031680,4063360,64,16650240,268435456,147712,11877904,163840,165888,141312,147456,149504,155648,157696
.long 116480,1718528,1605632,11877888,0,768,11730944,7680,11468800,11288576,11811856,11812400,512,512,11812608,10813440
.long 329728,11173888,2064384,4128768,0,16654336,268435456,147840,11877920,190464,196608,172032,174080,180224,182272,188416
.long 173824,1661184,1605632,11878144,0,896,11730944,7936,11472896,11296768,11811856,11812404,516,516,11812736,10813440
.long 346112,11173888,2064448,4128896,64,16658432,268435456,147840,11877936,221184,223232,198656,204800,206848,212992,215040
.long 256,1834752,0,11862016,128,65536,11673600,0,237568,16384,11796480,11796520,8,8,11796480,360448
.long 231424,0,128,256,128,12599296,268435456,147456,11862080,0,2048,8192,10240,16384,18432,24576
.long 57600,1777408,0,11862272,128,65664,11673600,256,241664,24576,11796480,11796524,12,128,11796608,360448
.long 247808,0,192,384,192,12603392,268435456,147456,11862096,26624,32768,34816,40960,43008,49152,51200
.long 114944,1720064,0,11862528,128,65792,11673600,0,598016,376832,11796496,11796536,8,8,11796736,360448
.long 264192,0,32896,65792,128,12607488,268435456,147584,11862112,57344,59392,65536,67584,73728,75776,81920
.long 172288,1662720,0,11862784,128,65920,11673600,256,602112,385024,11796496,11796540,12,128,11796864,360448
.long 280576,0,32960,65920,192,12611584,268435456,147584,11862128,83968,90112,92160,98304,100352,106496,108544
.long 2048,1832960,229376,11862016,128,66048,11739136,0,303104,131072,11796480,11797032,520,520,11796992,0
.long 296960,360448,65664,131328,128,12730368,268435456,147712,11862592,114688,116736,122880,124928,131072,133120,139264
.long 59392,1775616,229376,11862272,128,66176,11739136,256,307200,139264,11796480,11797036,524,640,11797120,0
.long 313344,360448,65728,131456,192,12734464,268435456,147712,11862608,141312,147456,149504,155648,157696,163840,165888
.long 116736,1718272,229376,11862528,128,66304,11739136,0,663552,491520,11796496,11797048,520,520,11797248,0
.long 329728,360448,98432,196864,128,12738560,268435456,147840,11862624,172032,174080,180224,182272,188416,190464,196608
.long 174080,1660928,229376,11862784,128,66432,11739136,256,667648,499712,11796496,11797052,524,640,11797376,0
.long 346112,360448,98496,196992,192,12742656,268435456,147840,11862640,198656,204800,206848,212992,215040,221184,223232
.long 256,1834752,458752,11866112,128,65536,11673600,2048,3121152,2899968,11800576,11800616,8,8,11800576,3244032
.long 231424,2883584,524416,1048832,128,13647872,268435456,147456,11866176,0,2048,8192,10240,16384,18432,24576
.long 57600,1777408,458752,11866368,128,65664,11673600,2304,3125248,2908160,11800576,11800620,12,128,11800704,3244032
.long 247808,2883584,524480,1048960,192,13651968,268435456,147456,11866192,26624,32768,34816,40960,43008,49152,51200
.long 114944,1720064,458752,11866624,128,65792,11673600,2048,3481600,3260416,11800592,11800632,8,8,11800832,3244032
.long 264192,2883584,557184,1114368,128,13656064,268435456,147584,11866208,57344,59392,65536,67584,73728,75776,81920
.long 172288,1662720,458752,11866880,128,65920,11673600,2304,3485696,3268608,11800592,11800636,12,128,11800960,3244032
.long 280576,2883584,557248,1114496,192,13660160,268435456,147584,11866224,83968,90112,92160,98304,100352,106496,108544
.long 2048,1832960,688128,11866112,128,66048,11739136,2048,3186688,3014656,11800576,11801128,520,520,11801088,2883584
.long 296960,3244032,589952,1179904,128,13778944,268435456,147712,11866688,114688,116736,122880,124928,131072,133120,139264
.long 59392,1775616,688128,11866368,128,66176,11739136,2304,3190784,3022848,11800576,11801132,524,640,11801216,2883584
.long 313344,3244032,590016,1180032,192,13783040,268435456,147712,11866704,141312,147456,149504,155648,157696,163840,165888
.long 116736,1718272,688128,11866624,128,66304,11739136,2048,3547136,3375104,11800592,11801144,520,520,11801344,2883584
.long 329728,3244032,622720,1245440,128,13787136,268435456,147840,11866720,172032,174080,180224,182272,188416,190464,196608
.long 174080,1660928,688128,11866880,128,66432,11739136,2304,3551232,3383296,11800592,11801148,524,640,11801472,2883584
.long 346112,3244032,622784,1245568,192,13791232,268435456,147840,11866736,198656,204800,206848,212992,215040,221184,223232
.long 256,1834752,917504,11870208,128,65536,11673600,4096,6004736,5783552,11804672,11804712,8,8,11804672,6127616
.long 231424,5767168,1048704,2097408,128,14696448,268435456,147456,11870272,0,2048,8192,10240,16384,18432,24576
.long 57600,1777408,917504,11870464,128,65664,11673600,4352,6008832,5791744,11804672,11804716,12,128,11804800,6127616
.long 247808,5767168,1048768,2097536,192,14700544,268435456,147456,11870288,26624,32768,34816,40960,43008,49152,51200
.long 114944,1720064,917504,11870720,128,65792,11673600,4096,6365184,6144000,11804688,11804728,8,8,11804928,6127616
.long 264192,5767168,1081472,2162944,128,14704640,268435456,147584,11870304,57344,59392,65536,67584,73728,75776,81920
.long 172288,1662720,917504,11870976,128,65920,11673600,4352,6369280,6152192,11804688,11804732,12,128,11805056,6127616
.long 280576,5767168,1081536,2163072,192,14708736,268435456,147584,11870320,83968,90112,92160,98304,100352,106496,108544
.long 2048,1832960,1146880,11870208,128,66048,11739136,4096,6070272,5898240,11804672,11805224,520,520,11805184,5767168
.long 296960,6127616,1114240,2228480,128,14827520,268435456,147712,11870784,114688,116736,122880,124928,131072,133120,139264
.long 59392,1775616,1146880,11870464,128,66176,11739136,4352,6074368,5906432,11804672,11805228,524,640,11805312,5767168
.long 313344,6127616,1114304,2228608,192,14831616,268435456,147712,11870800,141312,147456,149504,155648,157696,163840,165888
.long 116736,1718272,1146880,11870720,128,66304,11739136,4096,6430720,6258688,11804688,11805240,520,520,11805440,5767168
.long 329728,6127616,1147008,2294016,128,14835712,268435456,147840,11870816,172032,174080,180224,182272,188416,190464,196608
.long 174080,1660928,1146880,11870976,128,66432,11739136,4352,6434816,6266880,11804688,11805244,524,640,11805568,5767168
.long 346112,6127616,1147072,2294144,192,14839808,268435456,147840,11870832,198656,204800,206848,212992,215040,221184,223232
.long 256,1834752,1376256,11874304,128,65536,11673600,6144,8888320,8667136,11808768,11808808,8,8,11808768,9011200
.long 231424,8650752,1572992,3145984,128,15745024,268435456,147456,11874368,0,2048,8192,10240,16384,18432,24576
.long 57600,1777408,1376256,11874560,128,65664,11673600,6400,8892416,8675328,11808768,11808812,12,128,11808896,9011200
.long 247808,8650752,1573056,3146112,192,15749120,268435456,147456,11874384,26624,32768,34816,40960,43008,49152,51200
.long 114944,1720064,1376256,11874816,128,65792,11673600,6144,9248768,9027584,11808784,11808824,8,8,11809024,9011200
.long 264192,8650752,1605760,3211520,128,15753216,268435456,147584,11874400,57344,59392,65536,67584,73728,75776,81920
.long 172288,1662720,1376256,11875072,128,65920,11673600,6400,9252864,9035776,11808784,11808828,12,128,11809152,9011200
.long 280576,8650752,1605824,3211648,192,15757312,268435456,147584,11874416,83968,90112,92160,98304,100352,106496,108544
.long 2048,1832960,1605632,11874304,128,66048,11739136,6144,8953856,8781824,11808768,11809320,520,520,11809280,8650752
.long 296960,9011200,1638528,3277056,128,15876096,268435456,147712,11874880,114688,116736,122880,124928,131072,133120,139264
.long 59392,1775616,1605632,11874560,128,66176,11739136,6400,8957952,8790016,11808768,11809324,524,640,11809408,8650752
.long 313344,9011200,1638592,3277184,192,15880192,268435456,147712,11874896,141312,147456,149504,155648,157696,163840,165888
.long 116736,1718272,1605632,11874816,128,66304,11739136,6144,9314304,9142272,11808784,11809336,520,520,11809536,8650752
.long 329728,9011200,1671296,3342592,128,15884288,268435456,147840,11874912,172032,174080,180224,182272,188416,190464,196608
.long 174080,1660928,1605632,11875072,128,66432,11739136,6400,9318400,9150464,11808784,11809340,524,640,11809664,8650752
.long 346112,9011200,1671360,3342720,192,15888384,268435456,147840,11874928,198656,204800,206848,212992,215040,221184,223232
.long 256,1834752,0,11863040,128,65536,11673600,512,958464,737280,11797504,11797544,8,8,11797504,1081344
.long 229376,720896,131200,262400,128,12861440,268435456,147456,11863104,8192,10240,16384,18432,24576,0,2048
.long 57600,1777408,0,11863296,128,65664,11673600,768,962560,745472,11797504,11797548,12,128,11797632,1081344
.long 245760,720896,131264,262528,192,12865536,268435456,147456,11863120,34816,40960,43008,49152,51200,26624,32768
.long 114944,1720064,0,11863552,128,65792,11673600,512,1318912,1097728,11797520,11797560,8,8,11797760,1081344
.long 262144,720896,163968,327936,128,12869632,268435456,147584,11863136,65536,67584,73728,75776,81920,57344,59392
.long 172288,1662720,0,11863808,128,65920,11673600,768,1323008,1105920,11797520,11797564,12,128,11797888,1081344
.long 278528,720896,164032,328064,192,12873728,268435456,147584,11863152,92160,98304,100352,106496,108544,83968,90112
.long 2048,1832960,229376,11863040,128,66048,11739136,512,1024000,851968,11797504,11798056,520,520,11798016,720896
.long 294912,1081344,196736,393472,128,12992512,268435456,147712,11863616,122880,124928,131072,133120,139264,114688,116736
.long 59392,1775616,229376,11863296,128,66176,11739136,768,1028096,860160,11797504,11798060,524,640,11798144,720896
.long 311296,1081344,196800,393600,192,12996608,268435456,147712,11863632,149504,155648,157696,163840,165888,141312,147456
.long 116736,1718272,229376,11863552,128,66304,11739136,512,1384448,1212416,11797520,11798072,520,520,11798272,720896
.long 327680,1081344,229504,459008,128,13000704,268435456,147840,11863648,180224,182272,188416,190464,196608,172032,174080
.long 174080,1660928,229376,11863808,128,66432,11739136,768,1388544,1220608,11797520,11798076,524,640,11798400,720896
.long 344064,1081344,229568,459136,192,13004800,268435456,147840,11863664,206848,212992,215040,221184,223232,198656,204800
.long 256,1834752,458752,11867136,128,65536,11673600,2560,3842048,3620864,11801600,11801640,8,8,11801600,3964928
.long 229376,3604480,655488,1310976,128,13910016,268435456,147456,11867200,8192,10240,16384,18432,24576,0,2048
.long 57600,1777408,458752,11867392,128,65664,11673600,2816,3846144,3629056,11801600,11801644,12,128,11801728,3964928
.long 245760,3604480,655552,1311104,192,13914112,268435456,147456,11867216,34816,40960,43008,49152,51200,26624,32768
.long 114944,1720064,458752,11867648,128,65792,11673600,2560,4202496,3981312,11801616,11801656,8,8,11801856,3964928
.long 262144,3604480,688256,1376512,128,13918208,268435456,147584,11867232,65536,67584,73728,75776,81920,57344,59392
.long 172288,1662720,458752,11867904,128,65920,11673600,2816,4206592,3989504,11801616,11801660,12,128,11801984,3964928
.long 278528,3604480,688320,1376640,192,13922304,268435456,147584,11867248,92160,98304,100352,106496,108544,83968,90112
.long 2048,1832960,688128,11867136,128,66048,11739136,2560,3907584,3735552,11801600,11802152,520,520,11802112,3604480
.long 294912,3964928,721024,1442048,128,14041088,268435456,147712,11867712,122880,124928,131072,133120,139264,114688,116736
.long 59392,1775616,688128,11867392,128,66176,11739136,2816,3911680,3743744,11801600,11802156,524,640,11802240,3604480
.long 311296,3964928,721088,1442176,192,14045184,268435456,147712,11867728,149504,155648,157696,163840,165888,141312,147456
.long 116736,1718272,688128,11867648,128,66304,11739136,2560,4268032,4096000,11801616,11802168,520,520,11802368,3604480
.long 327680,3964928,753792,1507584,128,14049280,268435456,147840,11867744,180224,182272,188416,190464,196608,172032,174080
.long 174080,1660928,688128,11867904,128,66432,11739136,2816,4272128,4104192,11801616,11802172,524,640,11802496,3604480
.long 344064,3964928,753856,1507712,192,14053376,268435456,147840,11867760,206848,212992,215040,221184,223232,198656,204800
.long 256,1834752,917504,11871232,128,65536,11673600,4608,6725632,6504448,11805696,11805736,8,8,11805696,6848512
.long 229376,6488064,1179776,2359552,128,14958592,268435456,147456,11871296,8192,10240,16384,18432,24576,0,2048
.long 57600,1777408,917504,11871488,128,65664,11673600,4864,6729728,6512640,11805696,11805740,12,128,11805824,6848512
.long 245760,6488064,1179840,2359680,192,14962688,268435456,147456,11871312,34816,40960,43008,49152,51200,26624,32768
.long 114944,1720064,917504,11871744,128,65792,11673600,4608,7086080,6864896,11805712,11805752,8,8,11805952,6848512
.long 262144,6488064,1212544,2425088,128,14966784,268435456,147584,11871328,65536,67584,73728,75776,81920,57344,59392
.long 172288,1662720,917504,11872000,128,65920,11673600,4864,7090176,6873088,11805712,11805756,12,128,11806080,6848512
.long 278528,6488064,1212608,2425216,192,14970880,268435456,147584,11871344,92160,98304,100352,106496,108544,83968,90112
.long 2048,1832960,1146880,11871232,128,66048,11739136,4608,6791168,6619136,11805696,11806248,520,520,11806208,6488064
.long 294912,6848512,1245312,2490624,128,15089664,268435456,147712,11871808,122880,124928,131072,133120,139264,114688,116736
.long 59392,1775616,1146880,11871488,128,66176,11739136,4864,6795264,6627328,11805696,11806252,524,640,11806336,6488064
.long 311296,6848512,1245376,2490752,192,15093760,268435456,147712,11871824,149504,155648,157696,163840,165888,141312,147456
.long 116736,1718272,1146880,11871744,128,66304,11739136,4608,7151616,6979584,11805712,11806264,520,520,11806464,6488064
.long 327680,6848512,1278080,2556160,128,15097856,268435456,147840,11871840,180224,182272,188416,190464,196608,172032,174080
.long 174080,1660928,1146880,11872000,128,66432,11739136,4864,7155712,6987776,11805712,11806268,524,640,11806592,6488064
.long 344064,6848512,1278144,2556288,192,15101952,268435456,147840,11871856,206848,212992,215040,221184,223232,198656,204800
.long 256,1834752,1376256,11875328,128,65536,11673600,6656,9609216,9388032,11809792,11809832,8,8,11809792,9732096
.long 229376,9371648,1704064,3408128,128,16007168,268435456,147456,11875392,8192,10240,16384,18432,24576,0,2048
.long 57600,1777408,1376256,11875584,128,65664,11673600,6912,9613312,9396224,11809792,11809836,12,128,11809920,9732096
.long 245760,9371648,1704128,3408256,192,16011264,268435456,147456,11875408,34816,40960,43008,49152,51200,26624,32768
.long 114944,1720064,1376256,11875840,128,65792,11673600,6656,9969664,9748480,11809808,11809848,8,8,11810048,9732096
.long 262144,9371648,1736832,3473664,128,16015360,268435456,147584,11875424,65536,67584,73728,75776,81920,57344,59392
.long 172288,1662720,1376256,11876096,128,65920,11673600,6912,9973760,9756672,11809808,11809852,12,128,11810176,9732096
.long 278528,9371648,1736896,3473792,192,16019456,268435456,147584,11875440,92160,98304,100352,106496,108544,83968,90112
.long 2048,1832960,1605632,11875328,128,66048,11739136,6656,9674752,9502720,11809792,11810344,520,520,11810304,9371648
.long 294912,9732096,1769600,3539200,128,16138240,268435456,147712,11875904,122880,124928,131072,133120,139264,114688,116736
.long 59392,1775616,1605632,11875584,128,66176,11739136,6912,9678848,9510912,11809792,11810348,524,640,11810432,9371648
.long 311296,9732096,1769664,3539328,192,16142336,268435456,147712,11875920,149504,155648,157696,163840,165888,141312,147456
.long 116736,1718272,1605632,11875840,128,66304,11739136,6656,10035200,9863168,11809808,11810360,520,520,11810560,9371648
.long 327680,9732096,1802368,3604736,128,16146432,268435456,147840,11875936,180224,182272,188416,190464,196608,172032,174080
.long 174080,1660928,1605632,11876096,128,66432,11739136,6912,10039296,9871360,11809808,11810364,524,640,11810688,9371648
.long 344064,9732096,1802432,3604864,192,16150528,268435456,147840,11875952,206848,212992,215040,221184,223232,198656,204800
.long 256,1834752,0,11864064,128,65536,11673600,1024,1679360,1458176,11798528,11798568,8,8,11798528,1802240
.long 231424,1441792,262272,524544,128,13123584,268435456,147456,11864128,16384,18432,24576,0,2048,8192,10240
.long 57600,1777408,0,11864320,128,65664,11673600,1280,1683456,1466368,11798528,11798572,12,128,11798656,1802240
.long 247808,1441792,262336,524672,192,13127680,268435456,147456,11864144,43008,49152,51200,26624,32768,34816,40960
.long 114944,1720064,0,11864576,128,65792,11673600,1024,2039808,1818624,11798544,11798584,8,8,11798784,1802240
.long 264192,1441792,295040,590080,128,13131776,268435456,147584,11864160,73728,75776,81920,57344,59392,65536,67584
.long 172288,1662720,0,11864832,128,65920,11673600,1280,2043904,1826816,11798544,11798588,12,128,11798912,1802240
.long 280576,1441792,295104,590208,192,13135872,268435456,147584,11864176,100352,106496,108544,83968,90112,92160,98304
.long 2048,1832960,229376,11864064,128,66048,11739136,1024,1744896,1572864,11798528,11799080,520,520,11799040,1441792
.long 296960,1802240,327808,655616,128,13254656,268435456,147712,11864640,131072,133120,139264,114688,116736,122880,124928
.long 59392,1775616,229376,11864320,128,66176,11739136,1280,1748992,1581056,11798528,11799084,524,640,11799168,1441792
.long 313344,1802240,327872,655744,192,13258752,268435456,147712,11864656,157696,163840,165888,141312,147456,149504,155648
.long 116736,1718272,229376,11864576,128,66304,11739136,1024,2105344,1933312,11798544,11799096,520,520,11799296,1441792
.long 329728,1802240,360576,721152,128,13262848,268435456,147840,11864672,188416,190464,196608,172032,174080,180224,182272
.long 174080,1660928,229376,11864832,128,66432,11739136,1280,2109440,1941504,11798544,11799100,524,640,11799424,1441792
.long 346112,1802240,360640,721280,192,13266944,268435456,147840,11864688,215040,221184,223232,198656,204800,206848,212992
.long 256,1834752,458752,11868160,128,65536,11673600,3072,4562944,4341760,11802624,11802664,8,8,11802624,4685824
.long 231424,4325376,786560,1573120,128,14172160,268435456,147456,11868224,16384,18432,24576,0,2048,8192,10240
.long 57600,1777408,458752,11868416,128,65664,11673600,3328,4567040,4349952,11802624,11802668,12,128,11802752,4685824
.long 247808,4325376,786624,1573248,192,14176256,268435456,147456,11868240,43008,49152,51200,26624,32768,34816,40960
.long 114944,1720064,458752,11868672,128,65792,11673600,3072,4923392,4702208,11802640,11802680,8,8,11802880,4685824
.long 264192,4325376,819328,1638656,128,14180352,268435456,147584,11868256,73728,75776,81920,57344,59392,65536,67584
.long 172288,1662720,458752,11868928,128,65920,11673600,3328,4927488,4710400,11802640,11802684,12,128,11803008,4685824
.long 280576,4325376,819392,1638784,192,14184448,268435456,147584,11868272,100352,106496,108544,83968,90112,92160,98304
.long 2048,1832960,688128,11868160,128,66048,11739136,3072,4628480,4456448,11802624,11803176,520,520,11803136,4325376
.long 296960,4685824,852096,1704192,128,14303232,268435456,147712,11868736,131072,133120,139264,114688,116736,122880,124928
.long 59392,1775616,688128,11868416,128,66176,11739136,3328,4632576,4464640,11802624,11803180,524,640,11803264,4325376
.long 313344,4685824,852160,1704320,192,14307328,268435456,147712,11868752,157696,163840,165888,141312,147456,149504,155648
.long 116736,1718272,688128,11868672,128,66304,11739136,3072,4988928,4816896,11802640,11803192,520,520,11803392,4325376
.long 329728,4685824,884864,1769728,128,14311424,268435456,147840,11868768,188416,190464,196608,172032,174080,180224,182272
.long 174080,1660928,688128,11868928,128,66432,11739136,3328,4993024,4825088,11802640,11803196,524,640,11803520,4325376
.long 346112,4685824,884928,1769856,192,14315520,268435456,147840,11868784,215040,221184,223232,198656,204800,206848,212992
.long 256,1834752,917504,11872256,128,65536,11673600,5120,7446528,7225344,11806720,11806760,8,8,11806720,7569408
.long 231424,7208960,1310848,2621696,128,15220736,268435456,147456,11872320,16384,18432,24576,0,2048,8192,10240
.long 57600,1777408,917504,11872512,128,65664,11673600,5376,7450624,7233536,11806720,11806764,12,128,11806848,7569408
.long 247808,7208960,1310912,2621824,192,15224832,268435456,147456,11872336,43008,49152,51200,26624,32768,34816,40960
.long 114944,1720064,917504,11872768,128,65792,11673600,5120,7806976,7585792,11806736,11806776,8,8,11806976,7569408
.long 264192,7208960,1343616,2687232,128,15228928,268435456,147584,11872352,73728,75776,81920,57344,59392,65536,67584
.long 172288,1662720,917504,11873024,128,65920,11673600,5376,7811072,7593984,11806736,11806780,12,128,11807104,7569408
.long 280576,7208960,1343680,2687360,192,15233024,268435456,147584,11872368,100352,106496,108544,83968,90112,92160,98304
.long 2048,1832960,1146880,11872256,128,66048,11739136,5120,7512064,7340032,11806720,11807272,520,520,11807232,7208960
.long 296960,7569408,1376384,2752768,128,15351808,268435456,147712,11872832,131072,133120,139264,114688,116736,122880,124928
.long 59392,1775616,1146880,11872512,128,66176,11739136,5376,7516160,7348224,11806720,11807276,524,640,11807360,7208960
.long 313344,7569408,1376448,2752896,192,15355904,268435456,147712,11872848,157696,163840,165888,141312,147456,149504,155648
.long 116736,1718272,1146880,11872768,128,66304,11739136,5120,7872512,7700480,11806736,11807288,520,520,11807488,7208960
.long 329728,7569408,1409152,2818304,128,15360000,268435456,147840,11872864,188416,190464,196608,172032,174080,180224,182272
.long 174080,1660928,1146880,11873024,128,66432,11739136,5376,7876608,7708672,11806736,11807292,524,640,11807616,7208960
.long 346112,7569408,1409216,2818432,192,15364096,268435456,147840,11872880,215040,221184,223232,198656,204800,206848,212992
.long 256,1834752,1376256,11876352,128,65536,11673600,7168,10330112,10108928,11810816,11810856,8,8,11810816,10452992
.long 231424,10092544,1835136,3670272,128,16269312,268435456,147456,11876416,16384,18432,24576,0,2048,8192,10240
.long 57600,1777408,1376256,11876608,128,65664,11673600,7424,10334208,10117120,11810816,11810860,12,128,11810944,10452992
.long 247808,10092544,1835200,3670400,192,16273408,268435456,147456,11876432,43008,49152,51200,26624,32768,34816,40960
.long 114944,1720064,1376256,11876864,128,65792,11673600,7168,10690560,10469376,11810832,11810872,8,8,11811072,10452992
.long 264192,10092544,1867904,3735808,128,16277504,268435456,147584,11876448,73728,75776,81920,57344,59392,65536,67584
.long 172288,1662720,1376256,11877120,128,65920,11673600,7424,10694656,10477568,11810832,11810876,12,128,11811200,10452992
.long 280576,10092544,1867968,3735936,192,16281600,268435456,147584,11876464,100352,106496,108544,83968,90112,92160,98304
.long 2048,1832960,1605632,11876352,128,66048,11739136,7168,10395648,10223616,11810816,11811368,520,520,11811328,10092544
.long 296960,10452992,1900672,3801344,128,16400384,268435456,147712,11876928,131072,133120,139264,114688,116736,122880,124928
.long 59392,1775616,1605632,11876608,128,66176,11739136,7424,10399744,10231808,11810816,11811372,524,640,11811456,10092544
.long 313344,10452992,1900736,3801472,192,16404480,268435456,147712,11876944,157696,163840,165888,141312,147456,149504,155648
.long 116736,1718272,1605632,11876864,128,66304,11739136,7168,10756096,10584064,11810832,11811384,520,520,11811584,10092544
.long 329728,10452992,1933440,3866880,128,16408576,268435456,147840,11876960,188416,190464,196608,172032,174080,180224,182272
.long 174080,1660928,1605632,11877120,128,66432,11739136,7424,10760192,10592256,11810832,11811388,524,640,11811712,10092544
.long 346112,10452992,1933504,3867008,192,16412672,268435456,147840,11876976,215040,221184,223232,198656,204800,206848,212992
.long 256,1834752,0,11865088,128,65536,11673600,1536,2400256,2179072,11799552,11799592,8,8,11799552,2523136
.long 229376,2162688,393344,786688,128,13385728,268435456,147456,11865152,24576,0,2048,8192,10240,16384,18432
.long 57600,1777408,0,11865344,128,65664,11673600,1792,2404352,2187264,11799552,11799596,12,128,11799680,2523136
.long 245760,2162688,393408,786816,192,13389824,268435456,147456,11865168,51200,26624,32768,34816,40960,43008,49152
.long 114944,1720064,0,11865600,128,65792,11673600,1536,2760704,2539520,11799568,11799608,8,8,11799808,2523136
.long 262144,2162688,426112,852224,128,13393920,268435456,147584,11865184,81920,57344,59392,65536,67584,73728,75776
.long 172288,1662720,0,11865856,128,65920,11673600,1792,2764800,2547712,11799568,11799612,12,128,11799936,2523136
.long 278528,2162688,426176,852352,192,13398016,268435456,147584,11865200,108544,83968,90112,92160,98304,100352,106496
.long 2048,1832960,229376,11865088,128,66048,11739136,1536,2465792,2293760,11799552,11800104,520,520,11800064,2162688
.long 294912,2523136,458880,917760,128,13516800,268435456,147712,11865664,139264,114688,116736,122880,124928,131072,133120
.long 59392,1775616,229376,11865344,128,66176,11739136,1792,2469888,2301952,11799552,11800108,524,640,11800192,2162688
.long 311296,2523136,458944,917888,192,13520896,268435456,147712,11865680,165888,141312,147456,149504,155648,157696,163840
.long 116736,1718272,229376,11865600,128,66304,11739136,1536,2826240,2654208,11799568,11800120,520,520,11800320,2162688
.long 327680,2523136,491648,983296,128,13524992,268435456,147840,11865696,196608,172032,174080,180224,182272,188416,190464
.long 174080,1660928,229376,11865856,128,66432,11739136,1792,2830336,2662400,11799568,11800124,524,640,11800448,2162688
.long 344064,2523136,491712,983424,192,13529088,268435456,147840,11865712,223232,198656,204800,206848,212992,215040,221184
.long 256,1834752,458752,11869184,128,65536,11673600,3584,5283840,5062656,11803648,11803688,8,8,11803648,5406720
.long 229376,5046272,917632,1835264,128,14434304,268435456,147456,11869248,24576,0,2048,8192,10240,16384,18432
.long 57600,1777408,458752,11869440,128,65664,11673600,3840,5287936,5070848,11803648,11803692,12,128,11803776,5406720
.long 245760,5046272,917696,1835392,192,14438400,268435456,147456,11869264,51200,26624,32768,34816,40960,43008,49152
.long 114944,1720064,458752,11869696,128,65792,11673600,3584,5644288,5423104,11803664,11803704,8,8,11803904,5406720
.long 262144,5046272,950400,1900800,128,14442496,268435456,147584,11869280,81920,57344,59392,65536,67584,73728,75776
.long 172288,1662720,458752,11869952,128,65920,11673600,3840,5648384,5431296,11803664,11803708,12,128,11804032,5406720
.long 278528,5046272,950464,1900928,192,14446592,268435456,147584,11869296,108544,83968,90112,92160,98304,100352,106496
.long 2048,1832960,688128,11869184,128,66048,11739136,3584,5349376,5177344,11803648,11804200,520,520,11804160,5046272
.long 294912,5406720,983168,1966336,128,14565376,268435456,147712,11869760,139264,114688,116736,122880,124928,131072,133120
.long 59392,1775616,688128,11869440,128,66176,11739136,3840,5353472,5185536,11803648,11804204,524,640,11804288,5046272
.long 311296,5406720,983232,1966464,192,14569472,268435456,147712,11869776,165888,141312,147456,149504,155648,157696,163840
.long 116736,1718272,688128,11869696,128,66304,11739136,3584,5709824,5537792,11803664,11804216,520,520,11804416,5046272
.long 327680,5406720,1015936,2031872,128,14573568,268435456,147840,11869792,196608,172032,174080,180224,182272,188416,190464
.long 174080,1660928,688128,11869952,128,66432,11739136,3840,5713920,5545984,11803664,11804220,524,640,11804544,5046272
.long 344064,5406720,1016000,2032000,192,14577664,268435456,147840,11869808,223232,198656,204800,206848,212992,215040,221184
.long 256,1834752,917504,11873280,128,65536,11673600,5632,8167424,7946240,11807744,11807784,8,8,11807744,8290304
.long 229376,7929856,1441920,2883840,128,15482880,268435456,147456,11873344,24576,0,2048,8192,10240,16384,18432
.long 57600,1777408,917504,11873536,128,65664,11673600,5888,8171520,7954432,11807744,11807788,12,128,11807872,8290304
.long 245760,7929856,1441984,2883968,192,15486976,268435456,147456,11873360,51200,26624,32768,34816,40960,43008,49152
.long 114944,1720064,917504,11873792,128,65792,11673600,5632,8527872,8306688,11807760,11807800,8,8,11808000,8290304
.long 262144,7929856,1474688,2949376,128,15491072,268435456,147584,11873376,81920,57344,59392,65536,67584,73728,75776
.long 172288,1662720,917504,11874048,128,65920,11673600,5888,8531968,8314880,11807760,11807804,12,128,11808128,8290304
.long 278528,7929856,1474752,2949504,192,15495168,268435456,147584,11873392,108544,83968,90112,92160,98304,100352,106496
.long 2048,1832960,1146880,11873280,128,66048,11739136,5632,8232960,8060928,11807744,11808296,520,520,11808256,7929856
.long 294912,8290304,1507456,3014912,128,15613952,268435456,147712,11873856,139264,114688,116736,122880,124928,131072,133120
.long 59392,1775616,1146880,11873536,128,66176,11739136,5888,8237056,8069120,11807744,11808300,524,640,11808384,7929856
.long 311296,8290304,1507520,3015040,192,15618048,268435456,147712,11873872,165888,141312,147456,149504,155648,157696,163840
.long 116736,1718272,1146880,11873792,128,66304,11739136,5632,8593408,8421376,11807760,11808312,520,520,11808512,7929856
.long 327680,8290304,1540224,3080448,128,15622144,268435456,147840,11873888,196608,172032,174080,180224,182272,188416,190464
.long 174080,1660928,1146880,11874048,128,66432,11739136,5888,8597504,8429568,11807760,11808316,524,640,11808640,7929856
.long 344064,8290304,1540288,3080576,192,15626240,268435456,147840,11873904,223232,198656,204800,206848,212992,215040,221184
.long 256,1834752,1376256,11877376,128,65536,11673600,7680,11051008,10829824,11811840,11811880,8,8,11811840,11173888
.long 229376,10813440,1966208,3932416,128,16531456,268435456,147456,11877440,24576,0,2048,8192,10240,16384,18432
.long 57600,1777408,1376256,11877632,128,65664,11673600,7936,11055104,10838016,11811840,11811884,12,128,11811968,11173888
.long 245760,10813440,1966272,3932544,192,16535552,268435456,147456,11877456,51200,26624,32768,34816,40960,43008,49152
.long 114944,1720064,1376256,11877888,128,65792,11673600,7680,11411456,11190272,11811856,11811896,8,8,11812096,11173888
.long 262144,10813440,1998976,3997952,128,16539648,268435456,147584,11877472,81920,57344,59392,65536,67584,73728,75776
.long 172288,1662720,1376256,11878144,128,65920,11673600,7936,11415552,11198464,11811856,11811900,12,128,11812224,11173888
.long 278528,10813440,1999040,3998080,192,16543744,268435456,147584,11877488,108544,83968,90112,92160,98304,100352,106496
.long 2048,1832960,1605632,11877376,128,66048,11739136,7680,11116544,10944512,11811840,11812392,520,520,11812352,10813440
.long 294912,11173888,2031744,4063488,128,16662528,268435456,147712,11877952,139264,114688,116736,122880,124928,131072,133120
.long 59392,1775616,1605632,11877632,128,66176,11739136,7936,11120640,10952704,11811840,11812396,524,640,11812480,10813440
.long 311296,11173888,2031808,4063616,192,16666624,268435456,147712,11877968,165888,141312,147456,149504,155648,157696,163840
.long 116736,1718272,1605632,11877888,128,66304,11739136,7680,11476992,11304960,11811856,11812408,520,520,11812608,10813440
.long 327680,11173888,2064512,4129024,128,16670720,268435456,147840,11877984,196608,172032,174080,180224,182272,188416,190464
.long 174080,1660928,1605632,11878144,128,66432,11739136,7936,11481088,11313152,11811856,11812412,524,640,11812736,10813440
.long 344064,11173888,2064576,4129152,192,16674816,268435456,147840,11878000,223232,198656,204800,206848,212992,215040,221184
.long 512,1834496,0,11862016,256,131072,11681792,0,245760,32768,11796480,11796640,132,132,11796480,360448
.long 233472,0,256,512,256,12615680,268435456,147456,11862144,2048,8192,10240,16384,18432,24576,0
.long 57856,1777152,0,11862272,256,131200,11681792,256,249856,40960,11796480,11796644,136,136,11796608,360448
.long 249856,0,320,640,320,12619776,268435456,147456,11862160,32768,34816,40960,43008,49152,51200,26624
.long 115200,1719808,0,11862528,256,131328,11681792,0,606208,393216,11796496,11796656,132,132,11796736,360448
.long 266240,0,33024,66048,256,12623872,268435456,147584,11862176,59392,65536,67584,73728,75776,81920,57344
.long 172544,1662464,0,11862784,256,131456,11681792,256,610304,401408,11796496,11796660,136,136,11796864,360448
.long 282624,0,33088,66176,320,12627968,268435456,147584,11862192,90112,92160,98304,100352,106496,108544,83968
.long 2304,1832704,229376,11862016,256,131584,11747328,0,311296,147456,11796480,11797152,644,644,11796992,0
.long 299008,360448,65792,131584,256,12746752,268435456,147712,11862656,116736,122880,124928,131072,133120,139264,114688
.long 59648,1775360,229376,11862272,256,131712,11747328,256,315392,155648,11796480,11797156,648,648,11797120,0
.long 315392,360448,65856,131712,320,12750848,268435456,147712,11862672,147456,149504,155648,157696,163840,165888,141312
.long 116992,1718016,229376,11862528,256,131840,11747328,0,671744,507904,11796496,11797168,644,644,11797248,0
.long 331776,360448,98560,197120,256,12754944,268435456,147840,11862688,174080,180224,182272,188416,190464,196608,172032
.long 174336,1660672,229376,11862784,256,131968,11747328,256,675840,516096,11796496,11797172,648,648,11797376,0
.long 348160,360448,98624,197248,320,12759040,268435456,147840,11862704,204800,206848,212992,215040,221184,223232,198656
.long 512,1834496,458752,11866112,256,131072,11681792,2048,3129344,2916352,11800576,11800736,132,132,11800576,3244032
.long 233472,2883584,524544,1049088,256,13664256,268435456,147456,11866240,2048,8192,10240,16384,18432,24576,0
.long 57856,1777152,458752,11866368,256,131200,11681792,2304,3133440,2924544,11800576,11800740,136,136,11800704,3244032
.long 249856,2883584,524608,1049216,320,13668352,268435456,147456,11866256,32768,34816,40960,43008,49152,51200,26624
.long 115200,1719808,458752,11866624,256,131328,11681792,2048,3489792,3276800,11800592,11800752,132,132,11800832,3244032
.long 266240,2883584,557312,1114624,256,13672448,268435456,147584,11866272,59392,65536,67584,73728,75776,81920,57344
.long 172544,1662464,458752,11866880,256,131456,11681792,2304,3493888,3284992,11800592,11800756,136,136,11800960,3244032
.long 282624,2883584,557376,1114752,320,13676544,268435456,147584,11866288,90112,92160,98304,100352,106496,108544,83968
.long 2304,1832704,688128,11866112,256,131584,11747328,2048,3194880,3031040,11800576,11801248,644,644,11801088,2883584
.long 299008,3244032,590080,1180160,256,13795328,268435456,147712,11866752,116736,122880,124928,131072,133120,139264,114688
.long 59648,1775360,688128,11866368,256,131712,11747328,2304,3198976,3039232,11800576,11801252,648,648,11801216,2883584
.long 315392,3244032,590144,1180288,320,13799424,268435456,147712,11866768,147456,149504,155648,157696,163840,165888,141312
.long 116992,1718016,688128,11866624,256,131840,11747328,2048,3555328,3391488,11800592,11801264,644,644,11801344,2883584
.long 331776,3244032,622848,1245696,256,13803520,268435456,147840,11866784,174080,180224,182272,188416,190464,196608,172032
.long 174336,1660672,688128,11866880,256,131968,11747328,2304,3559424,3399680,11800592,11801268,648,648,11801472,2883584
.long 348160,3244032,622912,1245824,320,13807616,268435456,147840,11866800,204800,206848,212992,215040,221184,223232,198656
.long 512,1834496,917504,11870208,256,131072,11681792,4096,6012928,5799936,11804672,11804832,132,132,11804672,6127616
.long 233472,5767168,1048832,2097664,256,14712832,268435456,147456,11870336,2048,8192,10240,16384,18432,24576,0
.long 57856,1777152,917504,11870464,256,131200,11681792,4352,6017024,5808128,11804672,11804836,136,136,11804800,6127616
.long 249856,5767168,1048896,2097792,320,14716928,268435456,147456,11870352,32768,34816,40960,43008,49152,51200,26624
.long 115200,1719808,917504,11870720,256,131328,11681792,4096,6373376,6160384,11804688,11804848,132,132,11804928,6127616
.long 266240,5767168,1081600,2163200,256,14721024,268435456,147584,11870368,59392,65536,67584,73728,75776,81920,57344
.long 172544,1662464,917504,11870976,256,131456,11681792,4352,6377472,6168576,11804688,11804852,136,136,11805056,6127616
.long 282624,5767168,1081664,2163328,320,14725120,268435456,147584,11870384,90112,92160,98304,100352,106496,108544,83968
.long 2304,1832704,1146880,11870208,256,131584,11747328,4096,6078464,5914624,11804672,11805344,644,644,11805184,5767168
.long 299008,6127616,1114368,2228736,256,14843904,268435456,147712,11870848,116736,122880,124928,131072,133120,139264,114688
.long 59648,1775360,1146880,11870464,256,131712,11747328,4352,6082560,5922816,11804672,11805348,648,648,11805312,5767168
.long 315392,6127616,1114432,2228864,320,14848000,268435456,147712,11870864,147456,149504,155648,157696,163840,165888,141312
.long 116992,1718016,1146880,11870720,256,131840,11747328,4096,6438912,6275072,11804688,11805360,644,644,11805440,5767168
.long 331776,6127616,1147136,2294272,256,14852096,268435456,147840,11870880,174080,180224,182272,188416,190464,196608,172032
.long 174336,1660672,1146880,11870976,256,131968,11747328,4352,6443008,6283264,11804688,11805364,648,648,11805568,5767168
.long 348160,6127616,1147200,2294400,320,14856192,268435456,147840,11870896,204800,206848,212992,215040,221184,223232,198656
.long 512,1834496,1376256,11874304,256,131072,11681792,6144,8896512,8683520,11808768,11808928,132,132,11808768,9011200
.long 233472,8650752,1573120,3146240,256,15761408,268435456,147456,11874432,2048,8192,10240,16384,18432,24576,0
.long 57856,1777152,1376256,11874560,256,131200,11681792,6400,8900608,8691712,11808768,11808932,136,136,11808896,9011200
.long 249856,8650752,1573184,3146368,320,15765504,268435456,147456,11874448,32768,34816,40960,43008,49152,51200,26624
.long 115200,1719808,1376256,11874816,256,131328,11681792,6144,9256960,9043968,11808784,11808944,132,132,11809024,9011200
.long 266240,8650752,1605888,3211776,256,15769600,268435456,147584,11874464,59392,65536,67584,73728,75776,81920,57344
.long 172544,1662464,1376256,11875072,256,131456,11681792,6400,9261056,9052160,11808784,11808948,136,136,11809152,9011200
.long 282624,8650752,1605952,3211904,320,15773696,268435456,147584,11874480,90112,92160,98304,100352,106496,108544,83968
.long 2304,1832704,1605632,11874304,256,131584,11747328,6144,8962048,8798208,11808768,11809440,644,644,11809280,8650752
.long 299008,9011200,1638656,3277312,256,15892480,268435456,147712,11874944,116736,122880,124928,131072,133120,139264,114688
.long 59648,1775360,1605632,11874560,256,131712,11747328,6400,8966144,8806400,11808768,11809444,648,648,11809408,8650752
.long 315392,9011200,1638720,3277440,320,15896576,268435456,147712,11874960,147456,149504,155648,157696,163840,165888,141312
.long 116992,1718016,1605632,11874816,256,131840,11747328,6144,9322496,9158656,11808784,11809456,644,644,11809536,8650752
.long 331776,9011200,1671424,3342848,256,15900672,268435456,147840,11874976,174080,180224,182272,188416,190464,196608,172032
.long 174336,1660672,1605632,11875072,256,131968,11747328,6400,9326592,9166848,11808784,11809460,648,648,11809664,8650752
.long 348160,9011200,1671488,3342976,320,15904768,268435456,147840,11874992,204800,206848,212992,215040,221184,223232,198656
.long 512,1834496,0,11863040,256,131072,11681792,512,966656,753664,11797504,11797664,132,132,11797504,1081344
.long 235520,720896,131328,262656,256,12877824,268435456,147456,11863168,10240,16384,18432,24576,0,2048,8192
.long 57856,1777152,0,11863296,256,131200,11681792,768,970752,761856,11797504,11797668,136,136,11797632,1081344
.long 251904,720896,131392,262784,320,12881920,268435456,147456,11863184,40960,43008,49152,51200,26624,32768,34816
.long 115200,1719808,0,11863552,256,131328,11681792,512,1327104,1114112,11797520,11797680,132,132,11797760,1081344
.long 268288,720896,164096,328192,256,12886016,268435456,147584,11863200,67584,73728,75776,81920,57344,59392,65536
.long 172544,1662464,0,11863808,256,131456,11681792,768,1331200,1122304,11797520,11797684,136,136,11797888,1081344
.long 284672,720896,164160,328320,320,12890112,268435456,147584,11863216,98304,100352,106496,108544,83968,90112,92160
.long 2304,1832704,229376,11863040,256,131584,11747328,512,1032192,868352,11797504,11798176,644,644,11798016,720896
.long 301056,1081344,196864,393728,256,13008896,268435456,147712,11863680,124928,131072,133120,139264,114688,116736,122880
.long 59648,1775360,229376,11863296,256,131712,11747328,768,1036288,876544,11797504,11798180,648,648,11798144,720896
.long 317440,1081344,196928,393856,320,13012992,268435456,147712,11863696,155648,157696,163840,165888,141312,147456,149504
.long 116992,1718016,229376,11863552,256,131840,11747328,512,1392640,1228800,11797520,11798192,644,644,11798272,720896
.long 333824,1081344,229632,459264,256,13017088,268435456,147840,11863712,182272,188416,190464,196608,172032,174080,180224
.long 174336,1660672,229376,11863808,256,131968,11747328,768,1396736,1236992,11797520,11798196,648,648,11798400,720896
.long 350208,1081344,229696,459392,320,13021184,268435456,147840,11863728,212992,215040,221184,223232,198656,204800,206848
.long 512,1834496,458752,11867136,256,131072,11681792,2560,3850240,3637248,11801600,11801760,132,132,11801600,3964928
.long 235520,3604480,655616,1311232,256,13926400,268435456,147456,11867264,10240,16384,18432,24576,0,2048,8192
.long 57856,1777152,458752,11867392,256,131200,11681792,2816,3854336,3645440,11801600,11801764,136,136,11801728,3964928
.long 251904,3604480,655680,1311360,320,13930496,268435456,147456,11867280,40960,43008,49152,51200,26624,32768,34816
.long 115200,1719808,458752,11867648,256,131328,11681792,2560,4210688,3997696,11801616,11801776,132,132,11801856,3964928
.long 268288,3604480,688384,1376768,256,13934592,268435456,147584,11867296,67584,73728,75776,81920,57344,59392,65536
.long 172544,1662464,458752,11867904,256,131456,11681792,2816,4214784,4005888,11801616,11801780,136,136,11801984,3964928
.long 284672,3604480,688448,1376896,320,13938688,268435456,147584,11867312,98304,100352,106496,108544,83968,90112,92160
.long 2304,1832704,688128,11867136,256,131584,11747328,2560,3915776,3751936,11801600,11802272,644,644,11802112,3604480
.long 301056,3964928,721152,1442304,256,14057472,268435456,147712,11867776,124928,131072,133120,139264,114688,116736,122880
.long 59648,1775360,688128,11867392,256,131712,11747328,2816,3919872,3760128,11801600,11802276,648,648,11802240,3604480
.long 317440,3964928,721216,1442432,320,14061568,268435456,147712,11867792,155648,157696,163840,165888,141312,147456,149504
.long 116992,1718016,688128,11867648,256,131840,11747328,2560,4276224,4112384,11801616,11802288,644,644,11802368,3604480
.long 333824,3964928,753920,1507840,256,14065664,268435456,147840,11867808,182272,188416,190464,196608,172032,174080,180224
.long 174336,1660672,688128,11867904,256,131968,11747328,2816,4280320,4120576,11801616,11802292,648,648,11802496,3604480
.long 350208,3964928,753984,1507968,320,14069760,268435456,147840,11867824,212992,215040,221184,223232,198656,204800,206848
.long 512,1834496,917504,11871232,256,131072,11681792,4608,6733824,6520832,11805696,11805856,132,132,11805696,6848512
.long 235520,6488064,1179904,2359808,256,14974976,268435456,147456,11871360,10240,16384,18432,24576,0,2048,8192
.long 57856,1777152,917504,11871488,256,131200,11681792,4864,6737920,6529024,11805696,11805860,136,136,11805824,6848512
.long 251904,6488064,1179968,2359936,320,14979072,268435456,147456,11871376,40960,43008,49152,51200,26624,32768,34816
.long 115200,1719808,917504,11871744,256,131328,11681792,4608,7094272,6881280,11805712,11805872,132,132,11805952,6848512
.long 268288,6488064,1212672,2425344,256,14983168,268435456,147584,11871392,67584,73728,75776,81920,57344,59392,65536
.long 172544,1662464,917504,11872000,256,131456,11681792,4864,7098368,6889472,11805712,11805876,136,136,11806080,6848512
.long 284672,6488064,1212736,2425472,320,14987264,268435456,147584,11871408,98304,100352,106496,108544,83968,90112,92160
.long 2304,1832704,1146880,11871232,256,131584,11747328,4608,6799360,6635520,11805696,11806368,644,644,11806208,6488064
.long 301056,6848512,1245440,2490880,256,15106048,268435456,147712,11871872,124928,131072,133120,139264,114688,116736,122880
.long 59648,1775360,1146880,11871488,256,131712,11747328,4864,6803456,6643712,11805696,11806372,648,648,11806336,6488064
.long 317440,6848512,1245504,2491008,320,15110144,268435456,147712,11871888,155648,157696,163840,165888,141312,147456,149504
.long 116992,1718016,1146880,11871744,256,131840,11747328,4608,7159808,6995968,11805712,11806384,644,644,11806464,6488064
.long 333824,6848512,1278208,2556416,256,15114240,268435456,147840,11871904,182272,188416,190464,196608,172032,174080,180224
.long 174336,1660672,1146880,11872000,256,131968,11747328,4864,7163904,7004160,11805712,11806388,648,648,11806592,6488064
.long 350208,6848512,1278272,2556544,320,15118336,268435456,147840,11871920,212992,215040,221184,223232,198656,204800,206848
.long 512,1834496,1376256,11875328,256,131072,11681792,6656,9617408,9404416,11809792,11809952,132,132,11809792,9732096
.long 235520,9371648,1704192,3408384,256,16023552,268435456,147456,11875456,10240,16384,18432,24576,0,2048,8192
.long 57856,1777152,1376256,11875584,256,131200,11681792,6912,9621504,9412608,11809792,11809956,136,136,11809920,9732096
.long 251904,9371648,1704256,3408512,320,16027648,268435456,147456,11875472,40960,43008,49152,51200,26624,32768,34816
.long 115200,1719808,1376256,11875840,256,131328,11681792,6656,9977856,9764864,11809808,11809968,132,132,11810048,9732096
.long 268288,9371648,1736960,3473920,256,16031744,268435456,147584,11875488,67584,73728,75776,81920,57344,59392,65536
.long 172544,1662464,1376256,11876096,256,131456,11681792,6912,9981952,9773056,11809808,11809972,136,136,11810176,9732096
.long 284672,9371648,1737024,3474048,320,16035840,268435456,147584,11875504,98304,100352,106496,108544,83968,90112,92160
.long 2304,1832704,1605632,11875328,256,131584,11747328,6656,9682944,9519104,11809792,11810464,644,644,11810304,9371648
.long 301056,9732096,1769728,3539456,256,16154624,268435456,147712,11875968,124928,131072,133120,139264,114688,116736,122880
.long 59648,1775360,1605632,11875584,256,131712,11747328,6912,9687040,9527296,11809792,11810468,648,648,11810432,9371648
.long 317440,9732096,1769792,3539584,320,16158720,268435456,147712,11875984,155648,157696,163840,165888,141312,147456,149504
.long 116992,1718016,1605632,11875840,256,131840,11747328,6656,10043392,9879552,11809808,11810480,644,644,11810560,9371648
.long 333824,9732096,1802496,3604992,256,16162816,268435456,147840,11876000,182272,188416,190464,196608,172032,174080,180224
.long 174336,1660672,1605632,11876096,256,131968,11747328,6912,10047488,9887744,11809808,11810484,648,648,11810688,9371648
.long 350208,9732096,1802560,3605120,320,16166912,268435456,147840,11876016,212992,215040,221184,223232,198656,204800,206848
.long 512,1834496,0,11864064,256,131072,11681792,1024,1687552,1474560,11798528,11798688,132,132,11798528,1802240
.long 233472,1441792,262400,524800,256,13139968,268435456,147456,11864192,18432,24576,0,2048,8192,10240,16384
.long 57856,1777152,0,11864320,256,131200,11681792,1280,1691648,1482752,11798528,11798692,136,136,11798656,1802240
.long 249856,1441792,262464,524928,320,13144064,268435456,147456,11864208,49152,51200,26624,32768,34816,40960,43008
.long 115200,1719808,0,11864576,256,131328,11681792,1024,2048000,1835008,11798544,11798704,132,132,11798784,1802240
.long 266240,1441792,295168,590336,256,13148160,268435456,147584,11864224,75776,81920,57344,59392,65536,67584,73728
.long 172544,1662464,0,11864832,256,131456,11681792,1280,2052096,1843200,11798544,11798708,136,136,11798912,1802240
.long 282624,1441792,295232,590464,320,13152256,268435456,147584,11864240,106496,108544,83968,90112,92160,98304,100352
.long 2304,1832704,229376,11864064,256,131584,11747328,1024,1753088,1589248,11798528,11799200,644,644,11799040,1441792
.long 299008,1802240,327936,655872,256,13271040,268435456,147712,11864704,133120,139264,114688,116736,122880,124928,131072
.long 59648,1775360,229376,11864320,256,131712,11747328,1280,1757184,1597440,11798528,11799204,648,648,11799168,1441792
.long 315392,1802240,328000,656000,320,13275136,268435456,147712,11864720,163840,165888,141312,147456,149504,155648,157696
.long 116992,1718016,229376,11864576,256,131840,11747328,1024,2113536,1949696,11798544,11799216,644,644,11799296,1441792
.long 331776,1802240,360704,721408,256,13279232,268435456,147840,11864736,190464,196608,172032,174080,180224,182272,188416
.long 174336,1660672,229376,11864832,256,131968,11747328,1280,2117632,1957888,11798544,11799220,648,648,11799424,1441792
.long 348160,1802240,360768,721536,320,13283328,268435456,147840,11864752,221184,223232,198656,204800,206848,212992,215040
.long 512,1834496,458752,11868160,256,131072,11681792,3072,4571136,4358144,11802624,11802784,132,132,11802624,4685824
.long 233472,4325376,786688,1573376,256,14188544,268435456,147456,11868288,18432,24576,0,2048,8192,10240,16384
.long 57856,1777152,458752,11868416,256,131200,11681792,3328,4575232,4366336,11802624,11802788,136,136,11802752,4685824
.long 249856,4325376,786752,1573504,320,14192640,268435456,147456,11868304,49152,51200,26624,32768,34816,40960,43008
.long 115200,1719808,458752,11868672,256,131328,11681792,3072,4931584,4718592,11802640,11802800,132,132,11802880,4685824
.long 266240,4325376,819456,1638912,256,14196736,268435456,147584,11868320,75776,81920,57344,59392,65536,67584,73728
.long 172544,1662464,458752,11868928,256,131456,11681792,3328,4935680,4726784,11802640,11802804,136,136,11803008,4685824
.long 282624,4325376,819520,1639040,320,14200832,268435456,147584,11868336,106496,108544,83968,90112,92160,98304,100352
.long 2304,1832704,688128,11868160,256,131584,11747328,3072,4636672,4472832,11802624,11803296,644,644,11803136,4325376
.long 299008,4685824,852224,1704448,256,14319616,268435456,147712,11868800,133120,139264,114688,116736,122880,124928,131072
.long 59648,1775360,688128,11868416,256,131712,11747328,3328,4640768,4481024,11802624,11803300,648,648,11803264,4325376
.long 315392,4685824,852288,1704576,320,14323712,268435456,147712,11868816,163840,165888,141312,147456,149504,155648,157696
.long 116992,1718016,688128,11868672,256,131840,11747328,3072,4997120,4833280,11802640,11803312,644,644,11803392,4325376
.long 331776,4685824,884992,1769984,256,14327808,268435456,147840,11868832,190464,196608,172032,174080,180224,182272,188416
.long 174336,1660672,688128,11868928,256,131968,11747328,3328,5001216,4841472,11802640,11803316,648,648,11803520,4325376
.long 348160,4685824,885056,1770112,320,14331904,268435456,147840,11868848,221184,223232,198656,204800,206848,212992,215040
.long 512,1834496,917504,11872256,256,131072,11681792,5120,7454720,7241728,11806720,11806880,132,132,11806720,7569408
.long 233472,7208960,1310976,2621952,256,15237120,268435456,147456,11872384,18432,24576,0,2048,8192,10240,16384
.long 57856,1777152,917504,11872512,256,131200,11681792,5376,7458816,7249920,11806720,11806884,136,136,11806848,7569408
.long 249856,7208960,1311040,2622080,320,15241216,268435456,147456,11872400,49152,51200,26624,32768,34816,40960,43008
.long 115200,1719808,917504,11872768,256,131328,11681792,5120,7815168,7602176,11806736,11806896,132,132,11806976,7569408
.long 266240,7208960,1343744,2687488,256,15245312,268435456,147584,11872416,75776,81920,57344,59392,65536,67584,73728
.long 172544,1662464,917504,11873024,256,131456,11681792,5376,7819264,7610368,11806736,11806900,136,136,11807104,7569408
.long 282624,7208960,1343808,2687616,320,15249408,268435456,147584,11872432,106496,108544,83968,90112,92160,98304,100352
.long 2304,1832704,1146880,11872256,256,131584,11747328,5120,7520256,7356416,11806720,11807392,644,644,11807232,7208960
.long 299008,7569408,1376512,2753024,256,15368192,268435456,147712,11872896,133120,139264,114688,116736,122880,124928,131072
.long 59648,1775360,1146880,11872512,256,131712,11747328,5376,7524352,7364608,11806720,11807396,648,648,11807360,7208960
.long 315392,7569408,1376576,2753152,320,15372288,268435456,147712,11872912,163840,165888,141312,147456,149504,155648,157696
.long 116992,1718016,1146880,11872768,256,131840,11747328,5120,7880704,7716864,11806736,11807408,644,644,11807488,7208960
.long 331776,7569408,1409280,2818560,256,15376384,268435456,147840,11872928,190464,196608,172032,174080,180224,182272,188416
.long 174336,1660672,1146880,11873024,256,131968,11747328,5376,7884800,7725056,11806736,11807412,648,648,11807616,7208960
.long 348160,7569408,1409344,2818688,320,15380480,268435456,147840,11872944,221184,223232,198656,204800,206848,212992,215040
.long 512,1834496,1376256,11876352,256,131072,11681792,7168,10338304,10125312,11810816,11810976,132,132,11810816,10452992
.long 233472,10092544,1835264,3670528,256,16285696,268435456,147456,11876480,18432,24576,0,2048,8192,10240,16384
.long 57856,1777152,1376256,11876608,256,131200,11681792,7424,10342400,10133504,11810816,11810980,136,136,11810944,10452992
.long 249856,10092544,1835328,3670656,320,16289792,268435456,147456,11876496,49152,51200,26624,32768,34816,40960,43008
.long 115200,1719808,1376256,11876864,256,131328,11681792,7168,10698752,10485760,11810832,11810992,132,132,11811072,10452992
.long 266240,10092544,1868032,3736064,256,16293888,268435456,147584,11876512,75776,81920,57344,59392,65536,67584,73728
.long 172544,1662464,1376256,11877120,256,131456,11681792,7424,10702848,10493952,11810832,11810996,136,136,11811200,10452992
.long 282624,10092544,1868096,3736192,320,16297984,268435456,147584,11876528,106496,108544,83968,90112,92160,98304,100352
.long 2304,1832704,1605632,11876352,256,131584,11747328,7168,10403840,10240000,11810816,11811488,644,644,11811328,10092544
.long 299008,10452992,1900800,3801600,256,16416768,268435456,147712,11876992,133120,139264,114688,116736,122880,124928,131072
.long 59648,1775360,1605632,11876608,256,131712,11747328,7424,10407936,10248192,11810816,11811492,648,648,11811456,10092544
.long 315392,10452992,1900864,3801728,320,16420864,268435456,147712,11877008,163840,165888,141312,147456,149504,155648,157696
.long 116992,1718016,1605632,11876864,256,131840,11747328,7168,10764288,10600448,11810832,11811504,644,644,11811584,10092544
.long 331776,10452992,1933568,3867136,256,16424960,268435456,147840,11877024,190464,196608,172032,174080,180224,182272,188416
.long 174336,1660672,1605632,11877120,256,131968,11747328,7424,10768384,10608640,11810832,11811508,648,648,11811712,10092544
.long 348160,10452992,1933632,3867264,320,16429056,268435456,147840,11877040,221184,223232,198656,204800,206848,212992,215040
.long 512,1834496,0,11865088,256,131072,11681792,1536,2408448,2195456,11799552,11799712,132,132,11799552,2523136
.long 235520,2162688,393472,786944,256,13402112,268435456,147456,11865216,0,2048,8192,10240,16384,18432,24576
.long 57856,1777152,0,11865344,256,131200,11681792,1792,2412544,2203648,11799552,11799716,136,136,11799680,2523136
.long 251904,2162688,393536,787072,320,13406208,268435456,147456,11865232,26624,32768,34816,40960,43008,49152,51200
.long 115200,1719808,0,11865600,256,131328,11681792,1536,2768896,2555904,11799568,11799728,132,132,11799808,2523136
.long 268288,2162688,426240,852480,256,13410304,268435456,147584,11865248,57344,59392,65536,67584,73728,75776,81920
.long 172544,1662464,0,11865856,256,131456,11681792,1792,2772992,2564096,11799568,11799732,136,136,11799936,2523136
.long 284672,2162688,426304,852608,320,13414400,268435456,147584,11865264,83968,90112,92160,98304,100352,106496,108544
.long 2304,1832704,229376,11865088,256,131584,11747328,1536,2473984,2310144,11799552,11800224,644,644,11800064,2162688
.long 301056,2523136,459008,918016,256,13533184,268435456,147712,11865728,114688,116736,122880,124928,131072,133120,139264
.long 59648,1775360,229376,11865344,256,131712,11747328,1792,2478080,2318336,11799552,11800228,648,648,11800192,2162688
.long 317440,2523136,459072,918144,320,13537280,268435456,147712,11865744,141312,147456,149504,155648,157696,163840,165888
.long 116992,1718016,229376,11865600,256,131840,11747328,1536,2834432,2670592,11799568,11800240,644,644,11800320,2162688
.long 333824,2523136,491776,983552,256,13541376,268435456,147840,11865760,172032,174080,180224,182272,188416,190464,196608
.long 174336,1660672,229376,11865856,256,131968,11747328,1792,2838528,2678784,11799568,11800244,648,648,11800448,2162688
.long 350208,2523136,491840,983680,320,13545472,268435456,147840,11865776,198656,204800,206848,212992,215040,221184,223232
.long 512,1834496,458752,11869184,256,131072,11681792,3584,5292032,5079040,11803648,11803808,132,132,11803648,5406720
.long 235520,5046272,917760,1835520,256,14450688,268435456,147456,11869312,0,2048,8192,10240,16384,18432,24576
.long 57856,1777152,458752,11869440,256,131200,11681792,3840,5296128,5087232,11803648,11803812,136,136,11803776,5406720
.long 251904,5046272,917824,1835648,320,14454784,268435456,147456,11869328,26624,32768,34816,40960,43008,49152,51200
.long 115200,1719808,458752,11869696,256,131328,11681792,3584,5652480,5439488,11803664,11803824,132,132,11803904,5406720
.long 268288,5046272,950528,1901056,256,14458880,268435456,147584,11869344,57344,59392,65536,67584,73728,75776,81920
.long 172544,1662464,458752,11869952,256,131456,11681792,3840,5656576,5447680,11803664,11803828,136,136,11804032,5406720
.long 284672,5046272,950592,1901184,320,14462976,268435456,147584,11869360,83968,90112,92160,98304,100352,106496,108544
.long 2304,1832704,688128,11869184,256,131584,11747328,3584,5357568,5193728,11803648,11804320,644,644,11804160,5046272
.long 301056,5406720,983296,1966592,256,14581760,268435456,147712,11869824,114688,116736,122880,124928,131072,133120,139264
.long 59648,1775360,688128,11869440,256,131712,11747328,3840,5361664,5201920,11803648,11804324,648,648,11804288,5046272
.long 317440,5406720,983360,1966720,320,14585856,268435456,147712,11869840,141312,147456,149504,155648,157696,163840,165888
.long 116992,1718016,688128,11869696,256,131840,11747328,3584,5718016,5554176,11803664,11804336,644,644,11804416,5046272
.long 333824,5406720,1016064,2032128,256,14589952,268435456,147840,11869856,172032,174080,180224,182272,188416,190464,196608
.long 174336,1660672,688128,11869952,256,131968,11747328,3840,5722112,5562368,11803664,11804340,648,648,11804544,5046272
.long 350208,5406720,1016128,2032256,320,14594048,268435456,147840,11869872,198656,204800,206848,212992,215040,221184,223232
.long 512,1834496,917504,11873280,256,131072,11681792,5632,8175616,7962624,11807744,11807904,132,132,11807744,8290304
.long 235520,7929856,1442048,2884096,256,15499264,268435456,147456,11873408,0,2048,8192,10240,16384,18432,24576
.long 57856,1777152,917504,11873536,256,131200,11681792,5888,8179712,7970816,11807744,11807908,136,136,11807872,8290304
.long 251904,7929856,1442112,2884224,320,15503360,268435456,147456,11873424,26624,32768,34816,40960,43008,49152,51200
.long 115200,1719808,917504,11873792,256,131328,11681792,5632,8536064,8323072,11807760,11807920,132,132,11808000,8290304
.long 268288,7929856,1474816,2949632,256,15507456,268435456,147584,11873440,57344,59392,65536,67584,73728,75776,81920
.long 172544,1662464,917504,11874048,256,131456,11681792,5888,8540160,8331264,11807760,11807924,136,136,11808128,8290304
.long 284672,7929856,1474880,2949760,320,15511552,268435456,147584,11873456,83968,90112,92160,98304,100352,106496,108544
.long 2304,1832704,1146880,11873280,256,131584,11747328,5632,8241152,8077312,11807744,11808416,644,644,11808256,7929856
.long 301056,8290304,1507584,3015168,256,15630336,268435456,147712,11873920,114688,116736,122880,124928,131072,133120,139264
.long 59648,1775360,1146880,11873536,256,131712,11747328,5888,8245248,8085504,11807744,11808420,648,648,11808384,7929856
.long 317440,8290304,1507648,3015296,320,15634432,268435456,147712,11873936,141312,147456,149504,155648,157696,163840,165888
.long 116992,1718016,1146880,11873792,256,131840,11747328,5632,8601600,8437760,11807760,11808432,644,644,11808512,7929856
.long 333824,8290304,1540352,3080704,256,15638528,268435456,147840,11873952,172032,174080,180224,182272,188416,190464,196608
.long 174336,1660672,1146880,11874048,256,131968,11747328,5888,8605696,8445952,11807760,11808436,648,648,11808640,7929856
.long 350208,8290304,1540416,3080832,320,15642624,268435456,147840,11873968,198656,204800,206848,212992,215040,221184,223232
.long 512,1834496,1376256,11877376,256,131072,11681792,7680,11059200,10846208,11811840,11812000,132,132,11811840,11173888
.long 235520,10813440,1966336,3932672,256,16547840,268435456,147456,11877504,0,2048,8192,10240,16384,18432,24576
.long 57856,1777152,1376256,11877632,256,131200,11681792,7936,11063296,10854400,11811840,11812004,136,136,11811968,11173888
.long 251904,10813440,1966400,3932800,320,16551936,268435456,147456,11877520,26624,32768,34816,40960,43008,49152,51200
.long 115200,1719808,1376256,11877888,256,131328,11681792,7680,11419648,11206656,11811856,11812016,132,132,11812096,11173888
.long 268288,10813440,1999104,3998208,256,16556032,268435456,147584,11877536,57344,59392,65536,67584,73728,75776,81920
.long 172544,1662464,1376256,11878144,256,131456,11681792,7936,11423744,11214848,11811856,11812020,136,136,11812224,11173888
.long 284672,10813440,1999168,3998336,320,16560128,268435456,147584,11877552,83968,90112,92160,98304,100352,106496,108544
.long 2304,1832704,1605632,11877376,256,131584,11747328,7680,11124736,10960896,11811840,11812512,644,644,11812352,10813440
.long 301056,11173888,2031872,4063744,256,16678912,268435456,147712,11878016,114688,116736,122880,124928,131072,133120,139264
.long 59648,1775360,1605632,11877632,256,131712,11747328,7936,11128832,10969088,11811840,11812516,648,648,11812480,10813440
.long 317440,11173888,2031936,4063872,320,16683008,268435456,147712,11878032,141312,147456,149504,155648,157696,163840,165888
.long 116992,1718016,1605632,11877888,256,131840,11747328,7680,11485184,11321344,11811856,11812528,644,644,11812608,10813440
.long 333824,11173888,2064640,4129280,256,16687104,268435456,147840,11878048,172032,174080,180224,182272,188416,190464,196608
.long 174336,1660672,1605632,11878144,256,131968,11747328,7936,11489280,11329536,11811856,11812532,648,648,11812736,10813440
.long 350208,11173888,2064704,4129408,320,16691200,268435456,147840,11878064,198656,204800,206848,212992,215040,221184,223232
.long 0,0,0,11862016,384,196608,11689984,0,253952,268435456,268435456,11796648,1032,1032,11796480,360448
.long 235520,0,384,768,384,12632064,268435456,147456,11862208,8192,10240,16384,18432,24576,0,2048
.long 0,0,0,11862272,384,196736,11689984,256,258048,268435456,268435456,11796652,1036,1152,11796608,360448
.long 251904,0,448,896,448,12636160,268435456,147456,11862224,34816,40960,43008,49152,51200,26624,32768
.long 0,0,0,11862528,384,196864,11689984,0,614400,268435456,268435456,11796664,1032,1032,11796736,360448
.long 268288,0,33152,66304,384,12640256,268435456,147584,11862240,65536,67584,73728,75776,81920,57344,59392
.long 0,0,0,11862784,384,196992,11689984,256,618496,268435456,268435456,11796668,1036,1152,11796864,360448
.long 284672,0,33216,66432,448,12644352,268435456,147584,11862256,92160,98304,100352,106496,108544,83968,90112
.long 0,0,229376,11862016,384,197120,11755520,0,319488,268435456,268435456,11797160,1032,1032,11796992,0
.long 301056,360448,65920,131840,384,12763136,268435456,147712,11862720,122880,124928,131072,133120,139264,114688,116736
.long 0,0,229376,11862272,384,197248,11755520,256,323584,268435456,268435456,11797164,1036,1152,11797120,0
.long 317440,360448,65984,131968,448,12767232,268435456,147712,11862736,149504,155648,157696,163840,165888,141312,147456
.long 0,0,229376,11862528,384,197376,11755520,0,679936,268435456,268435456,11797176,1032,1032,11797248,0
.long 333824,360448,98688,197376,384,12771328,268435456,147840,11862752,180224,182272,188416,190464,196608,172032,174080
.long 0,0,229376,11862784,384,197504,11755520,256,684032,268435456,268435456,11797180,1036,1152,11797376,0
.long 350208,360448,98752,197504,448,12775424,268435456,147840,11862768,206848,212992,215040,221184,223232,198656,204800
.long 0,0,458752,11866112,384,196608,11689984,2048,3137536,268435456,268435456,11800744,1032,1032,11800576,3244032
.long 235520,2883584,524672,1049344,384,13680640,268435456,147456,11866304,8192,10240,16384,18432,24576,0,2048
.long 0,0,458752,11866368,384,196736,11689984,2304,3141632,268435456,268435456,11800748,1036,1152,11800704,3244032
.long 251904,2883584,524736,1049472,448,13684736,268435456,147456,11866320,34816,40960,43008,49152,51200,26624,32768
.long 0,0,458752,11866624,384,196864,11689984,2048,3497984,268435456,268435456,11800760,1032,1032,11800832,3244032
.long 268288,2883584,557440,1114880,384,13688832,268435456,147584,11866336,65536,67584,73728,75776,81920,57344,59392
.long 0,0,458752,11866880,384,196992,11689984,2304,3502080,268435456,268435456,11800764,1036,1152,11800960,3244032
.long 284672,2883584,557504,1115008,448,13692928,268435456,147584,11866352,92160,98304,100352,106496,108544,83968,90112
.long 0,0,688128,11866112,384,197120,11755520,2048,3203072,268435456,268435456,11801256,1032,1032,11801088,2883584
.long 301056,3244032,590208,1180416,384,13811712,268435456,147712,11866816,122880,124928,131072,133120,139264,114688,116736
.long 0,0,688128,11866368,384,197248,11755520,2304,3207168,268435456,268435456,11801260,1036,1152,11801216,2883584
.long 317440,3244032,590272,1180544,448,13815808,268435456,147712,11866832,149504,155648,157696,163840,165888,141312,147456
.long 0,0,688128,11866624,384,197376,11755520,2048,3563520,268435456,268435456,11801272,1032,1032,11801344,2883584
.long 333824,3244032,622976,1245952,384,13819904,268435456,147840,11866848,180224,182272,188416,190464,196608,172032,174080
.long 0,0,688128,11866880,384,197504,11755520,2304,3567616,268435456,268435456,11801276,1036,1152,11801472,2883584
.long 350208,3244032,623040,1246080,448,13824000,268435456,147840,11866864,206848,212992,215040,221184,223232,198656,204800
.long 0,0,917504,11870208,384,196608,11689984,4096,6021120,268435456,268435456,11804840,1032,1032,11804672,6127616
.long 235520,5767168,1048960,2097920,384,14729216,268435456,147456,11870400,8192,10240,16384,18432,24576,0,2048
.long 0,0,917504,11870464,384,196736,11689984,4352,6025216,268435456,268435456,11804844,1036,1152,11804800,6127616
.long 251904,5767168,1049024,2098048,448,14733312,268435456,147456,11870416,34816,40960,43008,49152,51200,26624,32768
.long 0,0,917504,11870720,384,196864,11689984,4096,6381568,268435456,268435456,11804856,1032,1032,11804928,6127616
.long 268288,5767168,1081728,2163456,384,14737408,268435456,147584,11870432,65536,67584,73728,75776,81920,57344,59392
.long 0,0,917504,11870976,384,196992,11689984,4352,6385664,268435456,268435456,11804860,1036,1152,11805056,6127616
.long 284672,5767168,1081792,2163584,448,14741504,268435456,147584,11870448,92160,98304,100352,106496,108544,83968,90112
.long 0,0,1146880,11870208,384,197120,11755520,4096,6086656,268435456,268435456,11805352,1032,1032,11805184,5767168
.long 301056,6127616,1114496,2228992,384,14860288,268435456,147712,11870912,122880,124928,131072,133120,139264,114688,116736
.long 0,0,1146880,11870464,384,197248,11755520,4352,6090752,268435456,268435456,11805356,1036,1152,11805312,5767168
.long 317440,6127616,1114560,2229120,448,14864384,268435456,147712,11870928,149504,155648,157696,163840,165888,141312,147456
.long 0,0,1146880,11870720,384,197376,11755520,4096,6447104,268435456,268435456,11805368,1032,1032,11805440,5767168
.long 333824,6127616,1147264,2294528,384,14868480,268435456,147840,11870944,180224,182272,188416,190464,196608,172032,174080
.long 0,0,1146880,11870976,384,197504,11755520,4352,6451200,268435456,268435456,11805372,1036,1152,11805568,5767168
.long 350208,6127616,1147328,2294656,448,14872576,268435456,147840,11870960,206848,212992,215040,221184,223232,198656,204800
.long 0,0,1376256,11874304,384,196608,11689984,6144,8904704,268435456,268435456,11808936,1032,1032,11808768,9011200
.long 235520,8650752,1573248,3146496,384,15777792,268435456,147456,11874496,8192,10240,16384,18432,24576,0,2048
.long 0,0,1376256,11874560,384,196736,11689984,6400,8908800,268435456,268435456,11808940,1036,1152,11808896,9011200
.long 251904,8650752,1573312,3146624,448,15781888,268435456,147456,11874512,34816,40960,43008,49152,51200,26624,32768
.long 0,0,1376256,11874816,384,196864,11689984,6144,9265152,268435456,268435456,11808952,1032,1032,11809024,9011200
.long 268288,8650752,1606016,3212032,384,15785984,268435456,147584,11874528,65536,67584,73728,75776,81920,57344,59392
.long 0,0,1376256,11875072,384,196992,11689984,6400,9269248,268435456,268435456,11808956,1036,1152,11809152,9011200
.long 284672,8650752,1606080,3212160,448,15790080,268435456,147584,11874544,92160,98304,100352,106496,108544,83968,90112
.long 0,0,1605632,11874304,384,197120,11755520,6144,8970240,268435456,268435456,11809448,1032,1032,11809280,8650752
.long 301056,9011200,1638784,3277568,384,15908864,268435456,147712,11875008,122880,124928,131072,133120,139264,114688,116736
.long 0,0,1605632,11874560,384,197248,11755520,6400,8974336,268435456,268435456,11809452,1036,1152,11809408,8650752
.long 317440,9011200,1638848,3277696,448,15912960,268435456,147712,11875024,149504,155648,157696,163840,165888,141312,147456
.long 0,0,1605632,11874816,384,197376,11755520,6144,9330688,268435456,268435456,11809464,1032,1032,11809536,8650752
.long 333824,9011200,1671552,3343104,384,15917056,268435456,147840,11875040,180224,182272,188416,190464,196608,172032,174080
.long 0,0,1605632,11875072,384,197504,11755520,6400,9334784,268435456,268435456,11809468,1036,1152,11809664,8650752
.long 350208,9011200,1671616,3343232,448,15921152,268435456,147840,11875056,206848,212992,215040,221184,223232,198656,204800
.long 0,0,0,11863040,384,196608,11689984,512,974848,268435456,268435456,11797672,1032,1032,11797504,1081344
.long 233472,720896,131456,262912,384,12894208,268435456,147456,11863232,16384,18432,24576,0,2048,8192,10240
.long 0,0,0,11863296,384,196736,11689984,768,978944,268435456,268435456,11797676,1036,1152,11797632,1081344
.long 249856,720896,131520,263040,448,12898304,268435456,147456,11863248,43008,49152,51200,26624,32768,34816,40960
.long 0,0,0,11863552,384,196864,11689984,512,1335296,268435456,268435456,11797688,1032,1032,11797760,1081344
.long 266240,720896,164224,328448,384,12902400,268435456,147584,11863264,73728,75776,81920,57344,59392,65536,67584
.long 0,0,0,11863808,384,196992,11689984,768,1339392,268435456,268435456,11797692,1036,1152,11797888,1081344
.long 282624,720896,164288,328576,448,12906496,268435456,147584,11863280,100352,106496,108544,83968,90112,92160,98304
.long 0,0,229376,11863040,384,197120,11755520,512,1040384,268435456,268435456,11798184,1032,1032,11798016,720896
.long 299008,1081344,196992,393984,384,13025280,268435456,147712,11863744,131072,133120,139264,114688,116736,122880,124928
.long 0,0,229376,11863296,384,197248,11755520,768,1044480,268435456,268435456,11798188,1036,1152,11798144,720896
.long 315392,1081344,197056,394112,448,13029376,268435456,147712,11863760,157696,163840,165888,141312,147456,149504,155648
.long 0,0,229376,11863552,384,197376,11755520,512,1400832,268435456,268435456,11798200,1032,1032,11798272,720896
.long 331776,1081344,229760,459520,384,13033472,268435456,147840,11863776,188416,190464,196608,172032,174080,180224,182272
.long 0,0,229376,11863808,384,197504,11755520,768,1404928,268435456,268435456,11798204,1036,1152,11798400,720896
.long 348160,1081344,229824,459648,448,13037568,268435456,147840,11863792,215040,221184,223232,198656,204800,206848,212992
.long 0,0,458752,11867136,384,196608,11689984,2560,3858432,268435456,268435456,11801768,1032,1032,11801600,3964928
.long 233472,3604480,655744,1311488,384,13942784,268435456,147456,11867328,16384,18432,24576,0,2048,8192,10240
.long 0,0,458752,11867392,384,196736,11689984,2816,3862528,268435456,268435456,11801772,1036,1152,11801728,3964928
.long 249856,3604480,655808,1311616,448,13946880,268435456,147456,11867344,43008,49152,51200,26624,32768,34816,40960
.long 0,0,458752,11867648,384,196864,11689984,2560,4218880,268435456,268435456,11801784,1032,1032,11801856,3964928
.long 266240,3604480,688512,1377024,384,13950976,268435456,147584,11867360,73728,75776,81920,57344,59392,65536,67584
.long 0,0,458752,11867904,384,196992,11689984,2816,4222976,268435456,268435456,11801788,1036,1152,11801984,3964928
.long 282624,3604480,688576,1377152,448,13955072,268435456,147584,11867376,100352,106496,108544,83968,90112,92160,98304
.long 0,0,688128,11867136,384,197120,11755520,2560,3923968,268435456,268435456,11802280,1032,1032,11802112,3604480
.long 299008,3964928,721280,1442560,384,14073856,268435456,147712,11867840,131072,133120,139264,114688,116736,122880,124928
.long 0,0,688128,11867392,384,197248,11755520,2816,3928064,268435456,268435456,11802284,1036,1152,11802240,3604480
.long 315392,3964928,721344,1442688,448,14077952,268435456,147712,11867856,157696,163840,165888,141312,147456,149504,155648
.long 0,0,688128,11867648,384,197376,11755520,2560,4284416,268435456,268435456,11802296,1032,1032,11802368,3604480
.long 331776,3964928,754048,1508096,384,14082048,268435456,147840,11867872,188416,190464,196608,172032,174080,180224,182272
.long 0,0,688128,11867904,384,197504,11755520,2816,4288512,268435456,268435456,11802300,1036,1152,11802496,3604480
.long 348160,3964928,754112,1508224,448,14086144,268435456,147840,11867888,215040,221184,223232,198656,204800,206848,212992
.long 0,0,917504,11871232,384,196608,11689984,4608,6742016,268435456,268435456,11805864,1032,1032,11805696,6848512
.long 233472,6488064,1180032,2360064,384,14991360,268435456,147456,11871424,16384,18432,24576,0,2048,8192,10240
.long 0,0,917504,11871488,384,196736,11689984,4864,6746112,268435456,268435456,11805868,1036,1152,11805824,6848512
.long 249856,6488064,1180096,2360192,448,14995456,268435456,147456,11871440,43008,49152,51200,26624,32768,34816,40960
.long 0,0,917504,11871744,384,196864,11689984,4608,7102464,268435456,268435456,11805880,1032,1032,11805952,6848512
.long 266240,6488064,1212800,2425600,384,14999552,268435456,147584,11871456,73728,75776,81920,57344,59392,65536,67584
.long 0,0,917504,11872000,384,196992,11689984,4864,7106560,268435456,268435456,11805884,1036,1152,11806080,6848512
.long 282624,6488064,1212864,2425728,448,15003648,268435456,147584,11871472,100352,106496,108544,83968,90112,92160,98304
.long 0,0,1146880,11871232,384,197120,11755520,4608,6807552,268435456,268435456,11806376,1032,1032,11806208,6488064
.long 299008,6848512,1245568,2491136,384,15122432,268435456,147712,11871936,131072,133120,139264,114688,116736,122880,124928
.long 0,0,1146880,11871488,384,197248,11755520,4864,6811648,268435456,268435456,11806380,1036,1152,11806336,6488064
.long 315392,6848512,1245632,2491264,448,15126528,268435456,147712,11871952,157696,163840,165888,141312,147456,149504,155648
.long 0,0,1146880,11871744,384,197376,11755520,4608,7168000,268435456,268435456,11806392,1032,1032,11806464,6488064
.long 331776,6848512,1278336,2556672,384,15130624,268435456,147840,11871968,188416,190464,196608,172032,174080,180224,182272
.long 0,0,1146880,11872000,384,197504,11755520,4864,7172096,268435456,268435456,11806396,1036,1152,11806592,6488064
.long 348160,6848512,1278400,2556800,448,15134720,268435456,147840,11871984,215040,221184,223232,198656,204800,206848,212992
.long 0,0,1376256,11875328,384,196608,11689984,6656,9625600,268435456,268435456,11809960,1032,1032,11809792,9732096
.long 233472,9371648,1704320,3408640,384,16039936,268435456,147456,11875520,16384,18432,24576,0,2048,8192,10240
.long 0,0,1376256,11875584,384,196736,11689984,6912,9629696,268435456,268435456,11809964,1036,1152,11809920,9732096
.long 249856,9371648,1704384,3408768,448,16044032,268435456,147456,11875536,43008,49152,51200,26624,32768,34816,40960
.long 0,0,1376256,11875840,384,196864,11689984,6656,9986048,268435456,268435456,11809976,1032,1032,11810048,9732096
.long 266240,9371648,1737088,3474176,384,16048128,268435456,147584,11875552,73728,75776,81920,57344,59392,65536,67584
.long 0,0,1376256,11876096,384,196992,11689984,6912,9990144,268435456,268435456,11809980,1036,1152,11810176,9732096
.long 282624,9371648,1737152,3474304,448,16052224,268435456,147584,11875568,100352,106496,108544,83968,90112,92160,98304
.long 0,0,1605632,11875328,384,197120,11755520,6656,9691136,268435456,268435456,11810472,1032,1032,11810304,9371648
.long 299008,9732096,1769856,3539712,384,16171008,268435456,147712,11876032,131072,133120,139264,114688,116736,122880,124928
.long 0,0,1605632,11875584,384,197248,11755520,6912,9695232,268435456,268435456,11810476,1036,1152,11810432,9371648
.long 315392,9732096,1769920,3539840,448,16175104,268435456,147712,11876048,157696,163840,165888,141312,147456,149504,155648
.long 0,0,1605632,11875840,384,197376,11755520,6656,10051584,268435456,268435456,11810488,1032,1032,11810560,9371648
.long 331776,9732096,1802624,3605248,384,16179200,268435456,147840,11876064,188416,190464,196608,172032,174080,180224,182272
.long 0,0,1605632,11876096,384,197504,11755520,6912,10055680,268435456,268435456,11810492,1036,1152,11810688,9371648
.long 348160,9732096,1802688,3605376,448,16183296,268435456,147840,11876080,215040,221184,223232,198656,204800,206848,212992
.long 0,0,0,11864064,384,196608,11689984,1024,1695744,268435456,268435456,11798696,1032,1032,11798528,1802240
.long 235520,1441792,262528,525056,384,13156352,268435456,147456,11864256,24576,0,2048,8192,10240,16384,18432
.long 0,0,0,11864320,384,196736,11689984,1280,1699840,268435456,268435456,11798700,1036,1152,11798656,1802240
.long 251904,1441792,262592,525184,448,13160448,268435456,147456,11864272,51200,26624,32768,34816,40960,43008,49152
.long 0,0,0,11864576,384,196864,11689984,1024,2056192,268435456,268435456,11798712,1032,1032,11798784,1802240
.long 268288,1441792,295296,590592,384,13164544,268435456,147584,11864288,81920,57344,59392,65536,67584,73728,75776
.long 0,0,0,11864832,384,196992,11689984,1280,2060288,268435456,268435456,11798716,1036,1152,11798912,1802240
.long 284672,1441792,295360,590720,448,13168640,268435456,147584,11864304,108544,83968,90112,92160,98304,100352,106496
.long 0,0,229376,11864064,384,197120,11755520,1024,1761280,268435456,268435456,11799208,1032,1032,11799040,1441792
.long 301056,1802240,328064,656128,384,13287424,268435456,147712,11864768,139264,114688,116736,122880,124928,131072,133120
.long 0,0,229376,11864320,384,197248,11755520,1280,1765376,268435456,268435456,11799212,1036,1152,11799168,1441792
.long 317440,1802240,328128,656256,448,13291520,268435456,147712,11864784,165888,141312,147456,149504,155648,157696,163840
.long 0,0,229376,11864576,384,197376,11755520,1024,2121728,268435456,268435456,11799224,1032,1032,11799296,1441792
.long 333824,1802240,360832,721664,384,13295616,268435456,147840,11864800,196608,172032,174080,180224,182272,188416,190464
.long 0,0,229376,11864832,384,197504,11755520,1280,2125824,268435456,268435456,11799228,1036,1152,11799424,1441792
.long 350208,1802240,360896,721792,448,13299712,268435456,147840,11864816,223232,198656,204800,206848,212992,215040,221184
.long 0,0,458752,11868160,384,196608,11689984,3072,4579328,268435456,268435456,11802792,1032,1032,11802624,4685824
.long 235520,4325376,786816,1573632,384,14204928,268435456,147456,11868352,24576,0,2048,8192,10240,16384,18432
.long 0,0,458752,11868416,384,196736,11689984,3328,4583424,268435456,268435456,11802796,1036,1152,11802752,4685824
.long 251904,4325376,786880,1573760,448,14209024,268435456,147456,11868368,51200,26624,32768,34816,40960,43008,49152
.long 0,0,458752,11868672,384,196864,11689984,3072,4939776,268435456,268435456,11802808,1032,1032,11802880,4685824
.long 268288,4325376,819584,1639168,384,14213120,268435456,147584,11868384,81920,57344,59392,65536,67584,73728,75776
.long 0,0,458752,11868928,384,196992,11689984,3328,4943872,268435456,268435456,11802812,1036,1152,11803008,4685824
.long 284672,4325376,819648,1639296,448,14217216,268435456,147584,11868400,108544,83968,90112,92160,98304,100352,106496
.long 0,0,688128,11868160,384,197120,11755520,3072,4644864,268435456,268435456,11803304,1032,1032,11803136,4325376
.long 301056,4685824,852352,1704704,384,14336000,268435456,147712,11868864,139264,114688,116736,122880,124928,131072,133120
.long 0,0,688128,11868416,384,197248,11755520,3328,4648960,268435456,268435456,11803308,1036,1152,11803264,4325376
.long 317440,4685824,852416,1704832,448,14340096,268435456,147712,11868880,165888,141312,147456,149504,155648,157696,163840
.long 0,0,688128,11868672,384,197376,11755520,3072,5005312,268435456,268435456,11803320,1032,1032,11803392,4325376
.long 333824,4685824,885120,1770240,384,14344192,268435456,147840,11868896,196608,172032,174080,180224,182272,188416,190464
.long 0,0,688128,11868928,384,197504,11755520,3328,5009408,268435456,268435456,11803324,1036,1152,11803520,4325376
.long 350208,4685824,885184,1770368,448,14348288,268435456,147840,11868912,223232,198656,204800,206848,212992,215040,221184
.long 0,0,917504,11872256,384,196608,11689984,5120,7462912,268435456,268435456,11806888,1032,1032,11806720,7569408
.long 235520,7208960,1311104,2622208,384,15253504,268435456,147456,11872448,24576,0,2048,8192,10240,16384,18432
.long 0,0,917504,11872512,384,196736,11689984,5376,7467008,268435456,268435456,11806892,1036,1152,11806848,7569408
.long 251904,7208960,1311168,2622336,448,15257600,268435456,147456,11872464,51200,26624,32768,34816,40960,43008,49152
.long 0,0,917504,11872768,384,196864,11689984,5120,7823360,268435456,268435456,11806904,1032,1032,11806976,7569408
.long 268288,7208960,1343872,2687744,384,15261696,268435456,147584,11872480,81920,57344,59392,65536,67584,73728,75776
.long 0,0,917504,11873024,384,196992,11689984,5376,7827456,268435456,268435456,11806908,1036,1152,11807104,7569408
.long 284672,7208960,1343936,2687872,448,15265792,268435456,147584,11872496,108544,83968,90112,92160,98304,100352,106496
.long 0,0,1146880,11872256,384,197120,11755520,5120,7528448,268435456,268435456,11807400,1032,1032,11807232,7208960
.long 301056,7569408,1376640,2753280,384,15384576,268435456,147712,11872960,139264,114688,116736,122880,124928,131072,133120
.long 0,0,1146880,11872512,384,197248,11755520,5376,7532544,268435456,268435456,11807404,1036,1152,11807360,7208960
.long 317440,7569408,1376704,2753408,448,15388672,268435456,147712,11872976,165888,141312,147456,149504,155648,157696,163840
.long 0,0,1146880,11872768,384,197376,11755520,5120,7888896,268435456,268435456,11807416,1032,1032,11807488,7208960
.long 333824,7569408,1409408,2818816,384,15392768,268435456,147840,11872992,196608,172032,174080,180224,182272,188416,190464
.long 0,0,1146880,11873024,384,197504,11755520,5376,7892992,268435456,268435456,11807420,1036,1152,11807616,7208960
.long 350208,7569408,1409472,2818944,448,15396864,268435456,147840,11873008,223232,198656,204800,206848,212992,215040,221184
.long 0,0,1376256,11876352,384,196608,11689984,7168,10346496,268435456,268435456,11810984,1032,1032,11810816,10452992
.long 235520,10092544,1835392,3670784,384,16302080,268435456,147456,11876544,24576,0,2048,8192,10240,16384,18432
.long 0,0,1376256,11876608,384,196736,11689984,7424,10350592,268435456,268435456,11810988,1036,1152,11810944,10452992
.long 251904,10092544,1835456,3670912,448,16306176,268435456,147456,11876560,51200,26624,32768,34816,40960,43008,49152
.long 0,0,1376256,11876864,384,196864,11689984,7168,10706944,268435456,268435456,11811000,1032,1032,11811072,10452992
.long 268288,10092544,1868160,3736320,384,16310272,268435456,147584,11876576,81920,57344,59392,65536,67584,73728,75776
.long 0,0,1376256,11877120,384,196992,11689984,7424,10711040,268435456,268435456,11811004,1036,1152,11811200,10452992
.long 284672,10092544,1868224,3736448,448,16314368,268435456,147584,11876592,108544,83968,90112,92160,98304,100352,106496
.long 0,0,1605632,11876352,384,197120,11755520,7168,10412032,268435456,268435456,11811496,1032,1032,11811328,10092544
.long 301056,10452992,1900928,3801856,384,16433152,268435456,147712,11877056,139264,114688,116736,122880,124928,131072,133120
.long 0,0,1605632,11876608,384,197248,11755520,7424,10416128,268435456,268435456,11811500,1036,1152,11811456,10092544
.long 317440,10452992,1900992,3801984,448,16437248,268435456,147712,11877072,165888,141312,147456,149504,155648,157696,163840
.long 0,0,1605632,11876864,384,197376,11755520,7168,10772480,268435456,268435456,11811512,1032,1032,11811584,10092544
.long 333824,10452992,1933696,3867392,384,16441344,268435456,147840,11877088,196608,172032,174080,180224,182272,188416,190464
.long 0,0,1605632,11877120,384,197504,11755520,7424,10776576,268435456,268435456,11811516,1036,1152,11811712,10092544
.long 350208,10452992,1933760,3867520,448,16445440,268435456,147840,11877104,223232,198656,204800,206848,212992,215040,221184
.long 0,0,0,11865088,384,196608,11689984,1536,2416640,268435456,268435456,11799720,1032,1032,11799552,2523136
.long 233472,2162688,393600,787200,384,13418496,268435456,147456,11865280,0,2048,8192,10240,16384,18432,24576
.long 0,0,0,11865344,384,196736,11689984,1792,2420736,268435456,268435456,11799724,1036,1152,11799680,2523136
.long 249856,2162688,393664,787328,448,13422592,268435456,147456,11865296,26624,32768,34816,40960,43008,49152,51200
.long 0,0,0,11865600,384,196864,11689984,1536,2777088,268435456,268435456,11799736,1032,1032,11799808,2523136
.long 266240,2162688,426368,852736,384,13426688,268435456,147584,11865312,57344,59392,65536,67584,73728,75776,81920
.long 0,0,0,11865856,384,196992,11689984,1792,2781184,268435456,268435456,11799740,1036,1152,11799936,2523136
.long 282624,2162688,426432,852864,448,13430784,268435456,147584,11865328,83968,90112,92160,98304,100352,106496,108544
.long 0,0,229376,11865088,384,197120,11755520,1536,2482176,268435456,268435456,11800232,1032,1032,11800064,2162688
.long 299008,2523136,459136,918272,384,13549568,268435456,147712,11865792,114688,116736,122880,124928,131072,133120,139264
.long 0,0,229376,11865344,384,197248,11755520,1792,2486272,268435456,268435456,11800236,1036,1152,11800192,2162688
.long 315392,2523136,459200,918400,448,13553664,268435456,147712,11865808,141312,147456,149504,155648,157696,163840,165888
.long 0,0,229376,11865600,384,197376,11755520,1536,2842624,268435456,268435456,11800248,1032,1032,11800320,2162688
.long 331776,2523136,491904,983808,384,13557760,268435456,147840,11865824,172032,174080,180224,182272,188416,190464,196608
.long 0,0,229376,11865856,384,197504,11755520,1792,2846720,268435456,268435456,11800252,1036,1152,11800448,2162688
.long 348160,2523136,491968,983936,448,13561856,268435456,147840,11865840,198656,204800,206848,212992,215040,221184,223232
.long 0,0,458752,11869184,384,196608,11689984,3584,5300224,268435456,268435456,11803816,1032,1032,11803648,5406720
.long 233472,5046272,917888,1835776,384,14467072,268435456,147456,11869376,0,2048,8192,10240,16384,18432,24576
.long 0,0,458752,11869440,384,196736,11689984,3840,5304320,268435456,268435456,11803820,1036,1152,11803776,5406720
.long 249856,5046272,917952,1835904,448,14471168,268435456,147456,11869392,26624,32768,34816,40960,43008,49152,51200
.long 0,0,458752,11869696,384,196864,11689984,3584,5660672,268435456,268435456,11803832,1032,1032,11803904,5406720
.long 266240,5046272,950656,1901312,384,14475264,268435456,147584,11869408,57344,59392,65536,67584,73728,75776,81920
.long 0,0,458752,11869952,384,196992,11689984,3840,5664768,268435456,268435456,11803836,1036,1152,11804032,5406720
.long 282624,5046272,950720,1901440,448,14479360,268435456,147584,11869424,83968,90112,92160,98304,100352,106496,108544
.long 0,0,688128,11869184,384,197120,11755520,3584,5365760,268435456,268435456,11804328,1032,1032,11804160,5046272
.long 299008,5406720,983424,1966848,384,14598144,268435456,147712,11869888,114688,116736,122880,124928,131072,133120,139264
.long 0,0,688128,11869440,384,197248,11755520,3840,5369856,268435456,268435456,11804332,1036,1152,11804288,5046272
.long 315392,5406720,983488,1966976,448,14602240,268435456,147712,11869904,141312,147456,149504,155648,157696,163840,165888
.long 0,0,688128,11869696,384,197376,11755520,3584,5726208,268435456,268435456,11804344,1032,1032,11804416,5046272
.long 331776,5406720,1016192,2032384,384,14606336,268435456,147840,11869920,172032,174080,180224,182272,188416,190464,196608
.long 0,0,688128,11869952,384,197504,11755520,3840,5730304,268435456,268435456,11804348,1036,1152,11804544,5046272
.long 348160,5406720,1016256,2032512,448,14610432,268435456,147840,11869936,198656,204800,206848,212992,215040,221184,223232
.long 0,0,917504,11873280,384,196608,11689984,5632,8183808,268435456,268435456,11807912,1032,1032,11807744,8290304
.long 233472,7929856,1442176,2884352,384,15515648,268435456,147456,11873472,0,2048,8192,10240,16384,18432,24576
.long 0,0,917504,11873536,384,196736,11689984,5888,8187904,268435456,268435456,11807916,1036,1152,11807872,8290304
.long 249856,7929856,1442240,2884480,448,15519744,268435456,147456,11873488,26624,32768,34816,40960,43008,49152,51200
.long 0,0,917504,11873792,384,196864,11689984,5632,8544256,268435456,268435456,11807928,1032,1032,11808000,8290304
.long 266240,7929856,1474944,2949888,384,15523840,268435456,147584,11873504,57344,59392,65536,67584,73728,75776,81920
.long 0,0,917504,11874048,384,196992,11689984,5888,8548352,268435456,268435456,11807932,1036,1152,11808128,8290304
.long 282624,7929856,1475008,2950016,448,15527936,268435456,147584,11873520,83968,90112,92160,98304,100352,106496,108544
.long 0,0,1146880,11873280,384,197120,11755520,5632,8249344,268435456,268435456,11808424,1032,1032,11808256,7929856
.long 299008,8290304,1507712,3015424,384,15646720,268435456,147712,11873984,114688,116736,122880,124928,131072,133120,139264
.long 0,0,1146880,11873536,384,197248,11755520,5888,8253440,268435456,268435456,11808428,1036,1152,11808384,7929856
.long 315392,8290304,1507776,3015552,448,15650816,268435456,147712,11874000,141312,147456,149504,155648,157696,163840,165888
.long 0,0,1146880,11873792,384,197376,11755520,5632,8609792,268435456,268435456,11808440,1032,1032,11808512,7929856
.long 331776,8290304,1540480,3080960,384,15654912,268435456,147840,11874016,172032,174080,180224,182272,188416,190464,196608
.long 0,0,1146880,11874048,384,197504,11755520,5888,8613888,268435456,268435456,11808444,1036,1152,11808640,7929856
.long 348160,8290304,1540544,3081088,448,15659008,268435456,147840,11874032,198656,204800,206848,212992,215040,221184,223232
.long 0,0,1376256,11877376,384,196608,11689984,7680,11067392,268435456,268435456,11812008,1032,1032,11811840,11173888
.long 233472,10813440,1966464,3932928,384,16564224,268435456,147456,11877568,0,2048,8192,10240,16384,18432,24576
.long 0,0,1376256,11877632,384,196736,11689984,7936,11071488,268435456,268435456,11812012,1036,1152,11811968,11173888
.long 249856,10813440,1966528,3933056,448,16568320,268435456,147456,11877584,26624,32768,34816,40960,43008,49152,51200
.long 0,0,1376256,11877888,384,196864,11689984,7680,11427840,268435456,268435456,11812024,1032,1032,11812096,11173888
.long 266240,10813440,1999232,3998464,384,16572416,268435456,147584,11877600,57344,59392,65536,67584,73728,75776,81920
.long 0,0,1376256,11878144,384,196992,11689984,7936,11431936,268435456,268435456,11812028,1036,1152,11812224,11173888
.long 282624,10813440,1999296,3998592,448,16576512,268435456,147584,11877616,83968,90112,92160,98304,100352,106496,108544
.long 0,0,1605632,11877376,384,197120,11755520,7680,11132928,268435456,268435456,11812520,1032,1032,11812352,10813440
.long 299008,11173888,2032000,4064000,384,16695296,268435456,147712,11878080,114688,116736,122880,124928,131072,133120,139264
.long 0,0,1605632,11877632,384,197248,11755520,7936,11137024,268435456,268435456,11812524,1036,1152,11812480,10813440
.long 315392,11173888,2032064,4064128,448,16699392,268435456,147712,11878096,141312,147456,149504,155648,157696,163840,165888
.long 0,0,1605632,11877888,384,197376,11755520,7680,11493376,268435456,268435456,11812536,1032,1032,11812608,10813440
.long 331776,11173888,2064768,4129536,384,16703488,268435456,147840,11878112,172032,174080,180224,182272,188416,190464,196608
.long 0,0,1605632,11878144,384,197504,11755520,7936,11497472,268435456,268435456,11812540,1036,1152,11812736,10813440
.long 348160,11173888,2064832,4129664,448,16707584,268435456,147840,11878128,198656,204800,206848,212992,215040,221184,223232
.long 768,1834240,0,11862016,512,262144,11698176,0,262144,49152,11796480,11796768,140,140,11796480,360448
.long 237568,0,512,1024,512,12648448,268435456,147456,11862272,10240,16384,18432,24576,0,2048,8192
.long 58112,1776896,0,11862272,512,262272,11698176,256,266240,57344,11796480,11796772,256,256,11796608,360448
.long 253952,0,576,1152,576,12652544,268435456,147456,11862288,40960,43008,49152,51200,26624,32768,34816
.long 115456,1719552,0,11862528,512,262400,11698176,0,622592,409600,11796496,11796784,140,140,11796736,360448
.long 270336,0,33280,66560,512,12656640,268435456,147584,11862304,67584,73728,75776,81920,57344,59392,65536
.long 172800,1662208,0,11862784,512,262528,11698176,256,626688,417792,11796496,11796788,256,256,11796864,360448
.long 286720,0,33344,66688,576,12660736,268435456,147584,11862320,98304,100352,106496,108544,83968,90112,92160
.long 2560,1832448,229376,11862016,512,262656,11763712,0,327680,163840,11796480,11797280,652,652,11796992,0
.long 303104,360448,66048,132096,512,12779520,268435456,147712,11862784,124928,131072,133120,139264,114688,116736,122880
.long 59904,1775104,229376,11862272,512,262784,11763712,256,331776,172032,11796480,11797284,768,768,11797120,0
.long 319488,360448,66112,132224,576,12783616,268435456,147712,11862800,155648,157696,163840,165888,141312,147456,149504
.long 117248,1717760,229376,11862528,512,262912,11763712,0,688128,524288,11796496,11797296,652,652,11797248,0
.long 335872,360448,98816,197632,512,12787712,268435456,147840,11862816,182272,188416,190464,196608,172032,174080,180224
.long 174592,1660416,229376,11862784,512,263040,11763712,256,692224,532480,11796496,11797300,768,768,11797376,0
.long 352256,360448,98880,197760,576,12791808,268435456,147840,11862832,212992,215040,221184,223232,198656,204800,206848
.long 768,1834240,458752,11866112,512,262144,11698176,2048,3145728,2932736,11800576,11800864,140,140,11800576,3244032
.long 237568,2883584,524800,1049600,512,13697024,268435456,147456,11866368,10240,16384,18432,24576,0,2048,8192
.long 58112,1776896,458752,11866368,512,262272,11698176,2304,3149824,2940928,11800576,11800868,256,256,11800704,3244032
.long 253952,2883584,524864,1049728,576,13701120,268435456,147456,11866384,40960,43008,49152,51200,26624,32768,34816
.long 115456,1719552,458752,11866624,512,262400,11698176,2048,3506176,3293184,11800592,11800880,140,140,11800832,3244032
.long 270336,2883584,557568,1115136,512,13705216,268435456,147584,11866400,67584,73728,75776,81920,57344,59392,65536
.long 172800,1662208,458752,11866880,512,262528,11698176,2304,3510272,3301376,11800592,11800884,256,256,11800960,3244032
.long 286720,2883584,557632,1115264,576,13709312,268435456,147584,11866416,98304,100352,106496,108544,83968,90112,92160
.long 2560,1832448,688128,11866112,512,262656,11763712,2048,3211264,3047424,11800576,11801376,652,652,11801088,2883584
.long 303104,3244032,590336,1180672,512,13828096,268435456,147712,11866880,124928,131072,133120,139264,114688,116736,122880
.long 59904,1775104,688128,11866368,512,262784,11763712,2304,3215360,3055616,11800576,11801380,768,768,11801216,2883584
.long 319488,3244032,590400,1180800,576,13832192,268435456,147712,11866896,155648,157696,163840,165888,141312,147456,149504
.long 117248,1717760,688128,11866624,512,262912,11763712,2048,3571712,3407872,11800592,11801392,652,652,11801344,2883584
.long 335872,3244032,623104,1246208,512,13836288,268435456,147840,11866912,182272,188416,190464,196608,172032,174080,180224
.long 174592,1660416,688128,11866880,512,263040,11763712,2304,3575808,3416064,11800592,11801396,768,768,11801472,2883584
.long 352256,3244032,623168,1246336,576,13840384,268435456,147840,11866928,212992,215040,221184,223232,198656,204800,206848
.long 768,1834240,917504,11870208,512,262144,11698176,4096,6029312,5816320,11804672,11804960,140,140,11804672,6127616
.long 237568,5767168,1049088,2098176,512,14745600,268435456,147456,11870464,10240,16384,18432,24576,0,2048,8192
.long 58112,1776896,917504,11870464,512,262272,11698176,4352,6033408,5824512,11804672,11804964,256,256,11804800,6127616
.long 253952,5767168,1049152,2098304,576,14749696,268435456,147456,11870480,40960,43008,49152,51200,26624,32768,34816
.long 115456,1719552,917504,11870720,512,262400,11698176,4096,6389760,6176768,11804688,11804976,140,140,11804928,6127616
.long 270336,5767168,1081856,2163712,512,14753792,268435456,147584,11870496,67584,73728,75776,81920,57344,59392,65536
.long 172800,1662208,917504,11870976,512,262528,11698176,4352,6393856,6184960,11804688,11804980,256,256,11805056,6127616
.long 286720,5767168,1081920,2163840,576,14757888,268435456,147584,11870512,98304,100352,106496,108544,83968,90112,92160
.long 2560,1832448,1146880,11870208,512,262656,11763712,4096,6094848,5931008,11804672,11805472,652,652,11805184,5767168
.long 303104,6127616,1114624,2229248,512,14876672,268435456,147712,11870976,124928,131072,133120,139264,114688,116736,122880
.long 59904,1775104,1146880,11870464,512,262784,11763712,4352,6098944,5939200,11804672,11805476,768,768,11805312,5767168
.long 319488,6127616,1114688,2229376,576,14880768,268435456,147712,11870992,155648,157696,163840,165888,141312,147456,149504
.long 117248,1717760,1146880,11870720,512,262912,11763712,4096,6455296,6291456,11804688,11805488,652,652,11805440,5767168
.long 335872,6127616,1147392,2294784,512,14884864,268435456,147840,11871008,182272,188416,190464,196608,172032,174080,180224
.long 174592,1660416,1146880,11870976,512,263040,11763712,4352,6459392,6299648,11804688,11805492,768,768,11805568,5767168
.long 352256,6127616,1147456,2294912,576,14888960,268435456,147840,11871024,212992,215040,221184,223232,198656,204800,206848
.long 768,1834240,1376256,11874304,512,262144,11698176,6144,8912896,8699904,11808768,11809056,140,140,11808768,9011200
.long 237568,8650752,1573376,3146752,512,15794176,268435456,147456,11874560,10240,16384,18432,24576,0,2048,8192
.long 58112,1776896,1376256,11874560,512,262272,11698176,6400,8916992,8708096,11808768,11809060,256,256,11808896,9011200
.long 253952,8650752,1573440,3146880,576,15798272,268435456,147456,11874576,40960,43008,49152,51200,26624,32768,34816
.long 115456,1719552,1376256,11874816,512,262400,11698176,6144,9273344,9060352,11808784,11809072,140,140,11809024,9011200
.long 270336,8650752,1606144,3212288,512,15802368,268435456,147584,11874592,67584,73728,75776,81920,57344,59392,65536
.long 172800,1662208,1376256,11875072,512,262528,11698176,6400,9277440,9068544,11808784,11809076,256,256,11809152,9011200
.long 286720,8650752,1606208,3212416,576,15806464,268435456,147584,11874608,98304,100352,106496,108544,83968,90112,92160
.long 2560,1832448,1605632,11874304,512,262656,11763712,6144,8978432,8814592,11808768,11809568,652,652,11809280,8650752
.long 303104,9011200,1638912,3277824,512,15925248,268435456,147712,11875072,124928,131072,133120,139264,114688,116736,122880
.long 59904,1775104,1605632,11874560,512,262784,11763712,6400,8982528,8822784,11808768,11809572,768,768,11809408,8650752
.long 319488,9011200,1638976,3277952,576,15929344,268435456,147712,11875088,155648,157696,163840,165888,141312,147456,149504
.long 117248,1717760,1605632,11874816,512,262912,11763712,6144,9338880,9175040,11808784,11809584,652,652,11809536,8650752
.long 335872,9011200,1671680,3343360,512,15933440,268435456,147840,11875104,182272,188416,190464,196608,172032,174080,180224
.long 174592,1660416,1605632,11875072,512,263040,11763712,6400,9342976,9183232,11808784,11809588,768,768,11809664,8650752
.long 352256,9011200,1671744,3343488,576,15937536,268435456,147840,11875120,212992,215040,221184,223232,198656,204800,206848
.long 768,1834240,0,11863040,512,262144,11698176,512,983040,770048,11797504,11797792,140,140,11797504,1081344
.long 239616,720896,131584,263168,512,12910592,268435456,147456,11863296,18432,24576,0,2048,8192,10240,16384
.long 58112,1776896,0,11863296,512,262272,11698176,768,987136,778240,11797504,11797796,256,256,11797632,1081344
.long 256000,720896,131648,263296,576,12914688,268435456,147456,11863312,49152,51200,26624,32768,34816,40960,43008
.long 115456,1719552,0,11863552,512,262400,11698176,512,1343488,1130496,11797520,11797808,140,140,11797760,1081344
.long 272384,720896,164352,328704,512,12918784,268435456,147584,11863328,75776,81920,57344,59392,65536,67584,73728
.long 172800,1662208,0,11863808,512,262528,11698176,768,1347584,1138688,11797520,11797812,256,256,11797888,1081344
.long 288768,720896,164416,328832,576,12922880,268435456,147584,11863344,106496,108544,83968,90112,92160,98304,100352
.long 2560,1832448,229376,11863040,512,262656,11763712,512,1048576,884736,11797504,11798304,652,652,11798016,720896
.long 305152,1081344,197120,394240,512,13041664,268435456,147712,11863808,133120,139264,114688,116736,122880,124928,131072
.long 59904,1775104,229376,11863296,512,262784,11763712,768,1052672,892928,11797504,11798308,768,768,11798144,720896
.long 321536,1081344,197184,394368,576,13045760,268435456,147712,11863824,163840,165888,141312,147456,149504,155648,157696
.long 117248,1717760,229376,11863552,512,262912,11763712,512,1409024,1245184,11797520,11798320,652,652,11798272,720896
.long 337920,1081344,229888,459776,512,13049856,268435456,147840,11863840,190464,196608,172032,174080,180224,182272,188416
.long 174592,1660416,229376,11863808,512,263040,11763712,768,1413120,1253376,11797520,11798324,768,768,11798400,720896
.long 354304,1081344,229952,459904,576,13053952,268435456,147840,11863856,221184,223232,198656,204800,206848,212992,215040
.long 768,1834240,458752,11867136,512,262144,11698176,2560,3866624,3653632,11801600,11801888,140,140,11801600,3964928
.long 239616,3604480,655872,1311744,512,13959168,268435456,147456,11867392,18432,24576,0,2048,8192,10240,16384
.long 58112,1776896,458752,11867392,512,262272,11698176,2816,3870720,3661824,11801600,11801892,256,256,11801728,3964928
.long 256000,3604480,655936,1311872,576,13963264,268435456,147456,11867408,49152,51200,26624,32768,34816,40960,43008
.long 115456,1719552,458752,11867648,512,262400,11698176,2560,4227072,4014080,11801616,11801904,140,140,11801856,3964928
.long 272384,3604480,688640,1377280,512,13967360,268435456,147584,11867424,75776,81920,57344,59392,65536,67584,73728
.long 172800,1662208,458752,11867904,512,262528,11698176,2816,4231168,4022272,11801616,11801908,256,256,11801984,3964928
.long 288768,3604480,688704,1377408,576,13971456,268435456,147584,11867440,106496,108544,83968,90112,92160,98304,100352
.long 2560,1832448,688128,11867136,512,262656,11763712,2560,3932160,3768320,11801600,11802400,652,652,11802112,3604480
.long 305152,3964928,721408,1442816,512,14090240,268435456,147712,11867904,133120,139264,114688,116736,122880,124928,131072
.long 59904,1775104,688128,11867392,512,262784,11763712,2816,3936256,3776512,11801600,11802404,768,768,11802240,3604480
.long 321536,3964928,721472,1442944,576,14094336,268435456,147712,11867920,163840,165888,141312,147456,149504,155648,157696
.long 117248,1717760,688128,11867648,512,262912,11763712,2560,4292608,4128768,11801616,11802416,652,652,11802368,3604480
.long 337920,3964928,754176,1508352,512,14098432,268435456,147840,11867936,190464,196608,172032,174080,180224,182272,188416
.long 174592,1660416,688128,11867904,512,263040,11763712,2816,4296704,4136960,11801616,11802420,768,768,11802496,3604480
.long 354304,3964928,754240,1508480,576,14102528,268435456,147840,11867952,221184,223232,198656,204800,206848,212992,215040
.long 768,1834240,917504,11871232,512,262144,11698176,4608,6750208,6537216,11805696,11805984,140,140,11805696,6848512
.long 239616,6488064,1180160,2360320,512,15007744,268435456,147456,11871488,18432,24576,0,2048,8192,10240,16384
.long 58112,1776896,917504,11871488,512,262272,11698176,4864,6754304,6545408,11805696,11805988,256,256,11805824,6848512
.long 256000,6488064,1180224,2360448,576,15011840,268435456,147456,11871504,49152,51200,26624,32768,34816,40960,43008
.long 115456,1719552,917504,11871744,512,262400,11698176,4608,7110656,6897664,11805712,11806000,140,140,11805952,6848512
.long 272384,6488064,1212928,2425856,512,15015936,268435456,147584,11871520,75776,81920,57344,59392,65536,67584,73728
.long 172800,1662208,917504,11872000,512,262528,11698176,4864,7114752,6905856,11805712,11806004,256,256,11806080,6848512
.long 288768,6488064,1212992,2425984,576,15020032,268435456,147584,11871536,106496,108544,83968,90112,92160,98304,100352
.long 2560,1832448,1146880,11871232,512,262656,11763712,4608,6815744,6651904,11805696,11806496,652,652,11806208,6488064
.long 305152,6848512,1245696,2491392,512,15138816,268435456,147712,11872000,133120,139264,114688,116736,122880,124928,131072
.long 59904,1775104,1146880,11871488,512,262784,11763712,4864,6819840,6660096,11805696,11806500,768,768,11806336,6488064
.long 321536,6848512,1245760,2491520,576,15142912,268435456,147712,11872016,163840,165888,141312,147456,149504,155648,157696
.long 117248,1717760,1146880,11871744,512,262912,11763712,4608,7176192,7012352,11805712,11806512,652,652,11806464,6488064
.long 337920,6848512,1278464,2556928,512,15147008,268435456,147840,11872032,190464,196608,172032,174080,180224,182272,188416
.long 174592,1660416,1146880,11872000,512,263040,11763712,4864,7180288,7020544,11805712,11806516,768,768,11806592,6488064
.long 354304,6848512,1278528,2557056,576,15151104,268435456,147840,11872048,221184,223232,198656,204800,206848,212992,215040
.long 768,1834240,1376256,11875328,512,262144,11698176,6656,9633792,9420800,11809792,11810080,140,140,11809792,9732096
.long 239616,9371648,1704448,3408896,512,16056320,268435456,147456,11875584,18432,24576,0,2048,8192,10240,16384
.long 58112,1776896,1376256,11875584,512,262272,11698176,6912,9637888,9428992,11809792,11810084,256,256,11809920,9732096
.long 256000,9371648,1704512,3409024,576,16060416,268435456,147456,11875600,49152,51200,26624,32768,34816,40960,43008
.long 115456,1719552,1376256,11875840,512,262400,11698176,6656,9994240,9781248,11809808,11810096,140,140,11810048,9732096
.long 272384,9371648,1737216,3474432,512,16064512,268435456,147584,11875616,75776,81920,57344,59392,65536,67584,73728
.long 172800,1662208,1376256,11876096,512,262528,11698176,6912,9998336,9789440,11809808,11810100,256,256,11810176,9732096
.long 288768,9371648,1737280,3474560,576,16068608,268435456,147584,11875632,106496,108544,83968,90112,92160,98304,100352
.long 2560,1832448,1605632,11875328,512,262656,11763712,6656,9699328,9535488,11809792,11810592,652,652,11810304,9371648
.long 305152,9732096,1769984,3539968,512,16187392,268435456,147712,11876096,133120,139264,114688,116736,122880,124928,131072
.long 59904,1775104,1605632,11875584,512,262784,11763712,6912,9703424,9543680,11809792,11810596,768,768,11810432,9371648
.long 321536,9732096,1770048,3540096,576,16191488,268435456,147712,11876112,163840,165888,141312,147456,149504,155648,157696
.long 117248,1717760,1605632,11875840,512,262912,11763712,6656,10059776,9895936,11809808,11810608,652,652,11810560,9371648
.long 337920,9732096,1802752,3605504,512,16195584,268435456,147840,11876128,190464,196608,172032,174080,180224,182272,188416
.long 174592,1660416,1605632,11876096,512,263040,11763712,6912,10063872,9904128,11809808,11810612,768,768,11810688,9371648
.long 354304,9732096,1802816,3605632,576,16199680,268435456,147840,11876144,221184,223232,198656,204800,206848,212992,215040
.long 768,1834240,0,11864064,512,262144,11698176,1024,1703936,1490944,11798528,11798816,140,140,11798528,1802240
.long 237568,1441792,262656,525312,512,13172736,268435456,147456,11864320,0,2048,8192,10240,16384,18432,24576
.long 58112,1776896,0,11864320,512,262272,11698176,1280,1708032,1499136,11798528,11798820,256,256,11798656,1802240
.long 253952,1441792,262720,525440,576,13176832,268435456,147456,11864336,26624,32768,34816,40960,43008,49152,51200
.long 115456,1719552,0,11864576,512,262400,11698176,1024,2064384,1851392,11798544,11798832,140,140,11798784,1802240
.long 270336,1441792,295424,590848,512,13180928,268435456,147584,11864352,57344,59392,65536,67584,73728,75776,81920
.long 172800,1662208,0,11864832,512,262528,11698176,1280,2068480,1859584,11798544,11798836,256,256,11798912,1802240
.long 286720,1441792,295488,590976,576,13185024,268435456,147584,11864368,83968,90112,92160,98304,100352,106496,108544
.long 2560,1832448,229376,11864064,512,262656,11763712,1024,1769472,1605632,11798528,11799328,652,652,11799040,1441792
.long 303104,1802240,328192,656384,512,13303808,268435456,147712,11864832,114688,116736,122880,124928,131072,133120,139264
.long 59904,1775104,229376,11864320,512,262784,11763712,1280,1773568,1613824,11798528,11799332,768,768,11799168,1441792
.long 319488,1802240,328256,656512,576,13307904,268435456,147712,11864848,141312,147456,149504,155648,157696,163840,165888
.long 117248,1717760,229376,11864576,512,262912,11763712,1024,2129920,1966080,11798544,11799344,652,652,11799296,1441792
.long 335872,1802240,360960,721920,512,13312000,268435456,147840,11864864,172032,174080,180224,182272,188416,190464,196608
.long 174592,1660416,229376,11864832,512,263040,11763712,1280,2134016,1974272,11798544,11799348,768,768,11799424,1441792
.long 352256,1802240,361024,722048,576,13316096,268435456,147840,11864880,198656,204800,206848,212992,215040,221184,223232
.long 768,1834240,458752,11868160,512,262144,11698176,3072,4587520,4374528,11802624,11802912,140,140,11802624,4685824
.long 237568,4325376,786944,1573888,512,14221312,268435456,147456,11868416,0,2048,8192,10240,16384,18432,24576
.long 58112,1776896,458752,11868416,512,262272,11698176,3328,4591616,4382720,11802624,11802916,256,256,11802752,4685824
.long 253952,4325376,787008,1574016,576,14225408,268435456,147456,11868432,26624,32768,34816,40960,43008,49152,51200
.long 115456,1719552,458752,11868672,512,262400,11698176,3072,4947968,4734976,11802640,11802928,140,140,11802880,4685824
.long 270336,4325376,819712,1639424,512,14229504,268435456,147584,11868448,57344,59392,65536,67584,73728,75776,81920
.long 172800,1662208,458752,11868928,512,262528,11698176,3328,4952064,4743168,11802640,11802932,256,256,11803008,4685824
.long 286720,4325376,819776,1639552,576,14233600,268435456,147584,11868464,83968,90112,92160,98304,100352,106496,108544
.long 2560,1832448,688128,11868160,512,262656,11763712,3072,4653056,4489216,11802624,11803424,652,652,11803136,4325376
.long 303104,4685824,852480,1704960,512,14352384,268435456,147712,11868928,114688,116736,122880,124928,131072,133120,139264
.long 59904,1775104,688128,11868416,512,262784,11763712,3328,4657152,4497408,11802624,11803428,768,768,11803264,4325376
.long 319488,4685824,852544,1705088,576,14356480,268435456,147712,11868944,141312,147456,149504,155648,157696,163840,165888
.long 117248,1717760,688128,11868672,512,262912,11763712,3072,5013504,4849664,11802640,11803440,652,652,11803392,4325376
.long 335872,4685824,885248,1770496,512,14360576,268435456,147840,11868960,172032,174080,180224,182272,188416,190464,196608
.long 174592,1660416,688128,11868928,512,263040,11763712,3328,5017600,4857856,11802640,11803444,768,768,11803520,4325376
.long 352256,4685824,885312,1770624,576,14364672,268435456,147840,11868976,198656,204800,206848,212992,215040,221184,223232
.long 768,1834240,917504,11872256,512,262144,11698176,5120,7471104,7258112,11806720,11807008,140,140,11806720,7569408
.long 237568,7208960,1311232,2622464,512,15269888,268435456,147456,11872512,0,2048,8192,10240,16384,18432,24576
.long 58112,1776896,917504,11872512,512,262272,11698176,5376,7475200,7266304,11806720,11807012,256,256,11806848,7569408
.long 253952,7208960,1311296,2622592,576,15273984,268435456,147456,11872528,26624,32768,34816,40960,43008,49152,51200
.long 115456,1719552,917504,11872768,512,262400,11698176,5120,7831552,7618560,11806736,11807024,140,140,11806976,7569408
.long 270336,7208960,1344000,2688000,512,15278080,268435456,147584,11872544,57344,59392,65536,67584,73728,75776,81920
.long 172800,1662208,917504,11873024,512,262528,11698176,5376,7835648,7626752,11806736,11807028,256,256,11807104,7569408
.long 286720,7208960,1344064,2688128,576,15282176,268435456,147584,11872560,83968,90112,92160,98304,100352,106496,108544
.long 2560,1832448,1146880,11872256,512,262656,11763712,5120,7536640,7372800,11806720,11807520,652,652,11807232,7208960
.long 303104,7569408,1376768,2753536,512,15400960,268435456,147712,11873024,114688,116736,122880,124928,131072,133120,139264
.long 59904,1775104,1146880,11872512,512,262784,11763712,5376,7540736,7380992,11806720,11807524,768,768,11807360,7208960
.long 319488,7569408,1376832,2753664,576,15405056,268435456,147712,11873040,141312,147456,149504,155648,157696,163840,165888
.long 117248,1717760,1146880,11872768,512,262912,11763712,5120,7897088,7733248,11806736,11807536,652,652,11807488,7208960
.long 335872,7569408,1409536,2819072,512,15409152,268435456,147840,11873056,172032,174080,180224,182272,188416,190464,196608
.long 174592,1660416,1146880,11873024,512,263040,11763712,5376,7901184,7741440,11806736,11807540,768,768,11807616,7208960
.long 352256,7569408,1409600,2819200,576,15413248,268435456,147840,11873072,198656,204800,206848,212992,215040,221184,223232
.long 768,1834240,1376256,11876352,512,262144,11698176,7168,10354688,10141696,11810816,11811104,140,140,11810816,10452992
.long 237568,10092544,1835520,3671040,512,16318464,268435456,147456,11876608,0,2048,8192,10240,16384,18432,24576
.long 58112,1776896,1376256,11876608,512,262272,11698176,7424,10358784,10149888,11810816,11811108,256,256,11810944,10452992
.long 253952,10092544,1835584,3671168,576,16322560,268435456,147456,11876624,26624,32768,34816,40960,43008,49152,51200
.long 115456,1719552,1376256,11876864,512,262400,11698176,7168,10715136,10502144,11810832,11811120,140,140,11811072,10452992
.long 270336,10092544,1868288,3736576,512,16326656,268435456,147584,11876640,57344,59392,65536,67584,73728,75776,81920
.long 172800,1662208,1376256,11877120,512,262528,11698176,7424,10719232,10510336,11810832,11811124,256,256,11811200,10452992
.long 286720,10092544,1868352,3736704,576,16330752,268435456,147584,11876656,83968,90112,92160,98304,100352,106496,108544
.long 2560,1832448,1605632,11876352,512,262656,11763712,7168,10420224,10256384,11810816,11811616,652,652,11811328,10092544
.long 303104,10452992,1901056,3802112,512,16449536,268435456,147712,11877120,114688,116736,122880,124928,131072,133120,139264
.long 59904,1775104,1605632,11876608,512,262784,11763712,7424,10424320,10264576,11810816,11811620,768,768,11811456,10092544
.long 319488,10452992,1901120,3802240,576,16453632,268435456,147712,11877136,141312,147456,149504,155648,157696,163840,165888
.long 117248,1717760,1605632,11876864,512,262912,11763712,7168,10780672,10616832,11810832,11811632,652,652,11811584,10092544
.long 335872,10452992,1933824,3867648,512,16457728,268435456,147840,11877152,172032,174080,180224,182272,188416,190464,196608
.long 174592,1660416,1605632,11877120,512,263040,11763712,7424,10784768,10625024,11810832,11811636,768,768,11811712,10092544
.long 352256,10452992,1933888,3867776,576,16461824,268435456,147840,11877168,198656,204800,206848,212992,215040,221184,223232
.long 768,1834240,0,11865088,512,262144,11698176,1536,2424832,2211840,11799552,11799840,140,140,11799552,2523136
.long 239616,2162688,393728,787456,512,13434880,268435456,147456,11865344,2048,8192,10240,16384,18432,24576,0
.long 58112,1776896,0,11865344,512,262272,11698176,1792,2428928,2220032,11799552,11799844,256,256,11799680,2523136
.long 256000,2162688,393792,787584,576,13438976,268435456,147456,11865360,32768,34816,40960,43008,49152,51200,26624
.long 115456,1719552,0,11865600,512,262400,11698176,1536,2785280,2572288,11799568,11799856,140,140,11799808,2523136
.long 272384,2162688,426496,852992,512,13443072,268435456,147584,11865376,59392,65536,67584,73728,75776,81920,57344
.long 172800,1662208,0,11865856,512,262528,11698176,1792,2789376,2580480,11799568,11799860,256,256,11799936,2523136
.long 288768,2162688,426560,853120,576,13447168,268435456,147584,11865392,90112,92160,98304,100352,106496,108544,83968
.long 2560,1832448,229376,11865088,512,262656,11763712,1536,2490368,2326528,11799552,11800352,652,652,11800064,2162688
.long 305152,2523136,459264,918528,512,13565952,268435456,147712,11865856,116736,122880,124928,131072,133120,139264,114688
.long 59904,1775104,229376,11865344,512,262784,11763712,1792,2494464,2334720,11799552,11800356,768,768,11800192,2162688
.long 321536,2523136,459328,918656,576,13570048,268435456,147712,11865872,147456,149504,155648,157696,163840,165888,141312
.long 117248,1717760,229376,11865600,512,262912,11763712,1536,2850816,2686976,11799568,11800368,652,652,11800320,2162688
.long 337920,2523136,492032,984064,512,13574144,268435456,147840,11865888,174080,180224,182272,188416,190464,196608,172032
.long 174592,1660416,229376,11865856,512,263040,11763712,1792,2854912,2695168,11799568,11800372,768,768,11800448,2162688
.long 354304,2523136,492096,984192,576,13578240,268435456,147840,11865904,204800,206848,212992,215040,221184,223232,198656
.long 768,1834240,458752,11869184,512,262144,11698176,3584,5308416,5095424,11803648,11803936,140,140,11803648,5406720
.long 239616,5046272,918016,1836032,512,14483456,268435456,147456,11869440,2048,8192,10240,16384,18432,24576,0
.long 58112,1776896,458752,11869440,512,262272,11698176,3840,5312512,5103616,11803648,11803940,256,256,11803776,5406720
.long 256000,5046272,918080,1836160,576,14487552,268435456,147456,11869456,32768,34816,40960,43008,49152,51200,26624
.long 115456,1719552,458752,11869696,512,262400,11698176,3584,5668864,5455872,11803664,11803952,140,140,11803904,5406720
.long 272384,5046272,950784,1901568,512,14491648,268435456,147584,11869472,59392,65536,67584,73728,75776,81920,57344
.long 172800,1662208,458752,11869952,512,262528,11698176,3840,5672960,5464064,11803664,11803956,256,256,11804032,5406720
.long 288768,5046272,950848,1901696,576,14495744,268435456,147584,11869488,90112,92160,98304,100352,106496,108544,83968
.long 2560,1832448,688128,11869184,512,262656,11763712,3584,5373952,5210112,11803648,11804448,652,652,11804160,5046272
.long 305152,5406720,983552,1967104,512,14614528,268435456,147712,11869952,116736,122880,124928,131072,133120,139264,114688
.long 59904,1775104,688128,11869440,512,262784,11763712,3840,5378048,5218304,11803648,11804452,768,768,11804288,5046272
.long 321536,5406720,983616,1967232,576,14618624,268435456,147712,11869968,147456,149504,155648,157696,163840,165888,141312
.long 117248,1717760,688128,11869696,512,262912,11763712,3584,5734400,5570560,11803664,11804464,652,652,11804416,5046272
.long 337920,5406720,1016320,2032640,512,14622720,268435456,147840,11869984,174080,180224,182272,188416,190464,196608,172032
.long 174592,1660416,688128,11869952,512,263040,11763712,3840,5738496,5578752,11803664,11804468,768,768,11804544,5046272
.long 354304,5406720,1016384,2032768,576,14626816,268435456,147840,11870000,204800,206848,212992,215040,221184,223232,198656
.long 768,1834240,917504,11873280,512,262144,11698176,5632,8192000,7979008,11807744,11808032,140,140,11807744,8290304
.long 239616,7929856,1442304,2884608,512,15532032,268435456,147456,11873536,2048,8192,10240,16384,18432,24576,0
.long 58112,1776896,917504,11873536,512,262272,11698176,5888,8196096,7987200,11807744,11808036,256,256,11807872,8290304
.long 256000,7929856,1442368,2884736,576,15536128,268435456,147456,11873552,32768,34816,40960,43008,49152,51200,26624
.long 115456,1719552,917504,11873792,512,262400,11698176,5632,8552448,8339456,11807760,11808048,140,140,11808000,8290304
.long 272384,7929856,1475072,2950144,512,15540224,268435456,147584,11873568,59392,65536,67584,73728,75776,81920,57344
.long 172800,1662208,917504,11874048,512,262528,11698176,5888,8556544,8347648,11807760,11808052,256,256,11808128,8290304
.long 288768,7929856,1475136,2950272,576,15544320,268435456,147584,11873584,90112,92160,98304,100352,106496,108544,83968
.long 2560,1832448,1146880,11873280,512,262656,11763712,5632,8257536,8093696,11807744,11808544,652,652,11808256,7929856
.long 305152,8290304,1507840,3015680,512,15663104,268435456,147712,11874048,116736,122880,124928,131072,133120,139264,114688
.long 59904,1775104,1146880,11873536,512,262784,11763712,5888,8261632,8101888,11807744,11808548,768,768,11808384,7929856
.long 321536,8290304,1507904,3015808,576,15667200,268435456,147712,11874064,147456,149504,155648,157696,163840,165888,141312
.long 117248,1717760,1146880,11873792,512,262912,11763712,5632,8617984,8454144,11807760,11808560,652,652,11808512,7929856
.long 337920,8290304,1540608,3081216,512,15671296,268435456,147840,11874080,174080,180224,182272,188416,190464,196608,172032
.long 174592,1660416,1146880,11874048,512,263040,11763712,5888,8622080,8462336,11807760,11808564,768,768,11808640,7929856
.long 354304,8290304,1540672,3081344,576,15675392,268435456,147840,11874096,204800,206848,212992,215040,221184,223232,198656
.long 768,1834240,1376256,11877376,512,262144,11698176,7680,11075584,10862592,11811840,11812128,140,140,11811840,11173888
.long 239616,10813440,1966592,3933184,512,16580608,268435456,147456,11877632,2048,8192,10240,16384,18432,24576,0
.long 58112,1776896,1376256,11877632,512,262272,11698176,7936,11079680,10870784,11811840,11812132,256,256,11811968,11173888
.long 256000,10813440,1966656,3933312,576,16584704,268435456,147456,11877648,32768,34816,40960,43008,49152,51200,26624
.long 115456,1719552,1376256,11877888,512,262400,11698176,7680,11436032,11223040,11811856,11812144,140,140,11812096,11173888
.long 272384,10813440,1999360,3998720,512,16588800,268435456,147584,11877664,59392,65536,67584,73728,75776,81920,57344
.long 172800,1662208,1376256,11878144,512,262528,11698176,7936,11440128,11231232,11811856,11812148,256,256,11812224,11173888
.long 288768,10813440,1999424,3998848,576,16592896,268435456,147584,11877680,90112,92160,98304,100352,106496,108544,83968
.long 2560,1832448,1605632,11877376,512,262656,11763712,7680,11141120,10977280,11811840,11812640,652,652,11812352,10813440
.long 305152,11173888,2032128,4064256,512,16711680,268435456,147712,11878144,116736,122880,124928,131072,133120,139264,114688
.long 59904,1775104,1605632,11877632,512,262784,11763712,7936,11145216,10985472,11811840,11812644,768,768,11812480,10813440
.long 321536,11173888,2032192,4064384,576,16715776,268435456,147712,11878160,147456,149504,155648,157696,163840,165888,141312
.long 117248,1717760,1605632,11877888,512,262912,11763712,7680,11501568,11337728,11811856,11812656,652,652,11812608,10813440
.long 337920,11173888,2064896,4129792,512,16719872,268435456,147840,11878176,174080,180224,182272,188416,190464,196608,172032
.long 174592,1660416,1605632,11878144,512,263040,11763712,7936,11505664,11345920,11811856,11812660,768,768,11812736,10813440
.long 354304,11173888,2064960,4129920,576,16723968,268435456,147840,11878192,204800,206848,212992,215040,221184,223232,198656
.long 1024,1833984,0,11862016,640,327680,11706368,0,270336,65536,11796480,11796776,260,260,11796480,360448
.long 239616,0,640,1280,640,12664832,268435456,147456,11862336,16384,18432,24576,0,2048,8192,10240
.long 58368,1776640,0,11862272,640,327808,11706368,256,274432,73728,11796480,11796780,264,264,11796608,360448
.long 256000,0,704,1408,704,12668928,268435456,147456,11862352,43008,49152,51200,26624,32768,34816,40960
.long 115712,1719296,0,11862528,640,327936,11706368,0,630784,425984,11796496,11796792,260,260,11796736,360448
.long 272384,0,33408,66816,640,12673024,268435456,147584,11862368,73728,75776,81920,57344,59392,65536,67584
.long 173056,1661952,0,11862784,640,328064,11706368,256,634880,434176,11796496,11796796,264,264,11796864,360448
.long 288768,0,33472,66944,704,12677120,268435456,147584,11862384,100352,106496,108544,83968,90112,92160,98304
.long 2816,1832192,229376,11862016,640,328192,11771904,0,335872,180224,11796480,11797288,772,772,11796992,0
.long 305152,360448,66176,132352,640,12795904,268435456,147712,11862848,131072,133120,139264,114688,116736,122880,124928
.long 60160,1774848,229376,11862272,640,328320,11771904,256,339968,188416,11796480,11797292,776,776,11797120,0
.long 321536,360448,66240,132480,704,12800000,268435456,147712,11862864,157696,163840,165888,141312,147456,149504,155648
.long 117504,1717504,229376,11862528,640,328448,11771904,0,696320,540672,11796496,11797304,772,772,11797248,0
.long 337920,360448,98944,197888,640,12804096,268435456,147840,11862880,188416,190464,196608,172032,174080,180224,182272
.long 174848,1660160,229376,11862784,640,328576,11771904,256,700416,548864,11796496,11797308,776,776,11797376,0
.long 354304,360448,99008,198016,704,12808192,268435456,147840,11862896,215040,221184,223232,198656,204800,206848,212992
.long 1024,1833984,458752,11866112,640,327680,11706368,2048,3153920,2949120,11800576,11800872,260,260,11800576,3244032
.long 239616,2883584,524928,1049856,640,13713408,268435456,147456,11866432,16384,18432,24576,0,2048,8192,10240
.long 58368,1776640,458752,11866368,640,327808,11706368,2304,3158016,2957312,11800576,11800876,264,264,11800704,3244032
.long 256000,2883584,524992,1049984,704,13717504,268435456,147456,11866448,43008,49152,51200,26624,32768,34816,40960
.long 115712,1719296,458752,11866624,640,327936,11706368,2048,3514368,3309568,11800592,11800888,260,260,11800832,3244032
.long 272384,2883584,557696,1115392,640,13721600,268435456,147584,11866464,73728,75776,81920,57344,59392,65536,67584
.long 173056,1661952,458752,11866880,640,328064,11706368,2304,3518464,3317760,11800592,11800892,264,264,11800960,3244032
.long 288768,2883584,557760,1115520,704,13725696,268435456,147584,11866480,100352,106496,108544,83968,90112,92160,98304
.long 2816,1832192,688128,11866112,640,328192,11771904,2048,3219456,3063808,11800576,11801384,772,772,11801088,2883584
.long 305152,3244032,590464,1180928,640,13844480,268435456,147712,11866944,131072,133120,139264,114688,116736,122880,124928
.long 60160,1774848,688128,11866368,640,328320,11771904,2304,3223552,3072000,11800576,11801388,776,776,11801216,2883584
.long 321536,3244032,590528,1181056,704,13848576,268435456,147712,11866960,157696,163840,165888,141312,147456,149504,155648
.long 117504,1717504,688128,11866624,640,328448,11771904,2048,3579904,3424256,11800592,11801400,772,772,11801344,2883584
.long 337920,3244032,623232,1246464,640,13852672,268435456,147840,11866976,188416,190464,196608,172032,174080,180224,182272
.long 174848,1660160,688128,11866880,640,328576,11771904,2304,3584000,3432448,11800592,11801404,776,776,11801472,2883584
.long 354304,3244032,623296,1246592,704,13856768,268435456,147840,11866992,215040,221184,223232,198656,204800,206848,212992
.long 1024,1833984,917504,11870208,640,327680,11706368,4096,6037504,5832704,11804672,11804968,260,260,11804672,6127616
.long 239616,5767168,1049216,2098432,640,14761984,268435456,147456,11870528,16384,18432,24576,0,2048,8192,10240
.long 58368,1776640,917504,11870464,640,327808,11706368,4352,6041600,5840896,11804672,11804972,264,264,11804800,6127616
.long 256000,5767168,1049280,2098560,704,14766080,268435456,147456,11870544,43008,49152,51200,26624,32768,34816,40960
.long 115712,1719296,917504,11870720,640,327936,11706368,4096,6397952,6193152,11804688,11804984,260,260,11804928,6127616
.long 272384,5767168,1081984,2163968,640,14770176,268435456,147584,11870560,73728,75776,81920,57344,59392,65536,67584
.long 173056,1661952,917504,11870976,640,328064,11706368,4352,6402048,6201344,11804688,11804988,264,264,11805056,6127616
.long 288768,5767168,1082048,2164096,704,14774272,268435456,147584,11870576,100352,106496,108544,83968,90112,92160,98304
.long 2816,1832192,1146880,11870208,640,328192,11771904,4096,6103040,5947392,11804672,11805480,772,772,11805184,5767168
.long 305152,6127616,1114752,2229504,640,14893056,268435456,147712,11871040,131072,133120,139264,114688,116736,122880,124928
.long 60160,1774848,1146880,11870464,640,328320,11771904,4352,6107136,5955584,11804672,11805484,776,776,11805312,5767168
.long 321536,6127616,1114816,2229632,704,14897152,268435456,147712,11871056,157696,163840,165888,141312,147456,149504,155648
.long 117504,1717504,1146880,11870720,640,328448,11771904,4096,6463488,6307840,11804688,11805496,772,772,11805440,5767168
.long 337920,6127616,1147520,2295040,640,14901248,268435456,147840,11871072,188416,190464,196608,172032,174080,180224,182272
.long 174848,1660160,1146880,11870976,640,328576,11771904,4352,6467584,6316032,11804688,11805500,776,776,11805568,5767168
.long 354304,6127616,1147584,2295168,704,14905344,268435456,147840,11871088,215040,221184,223232,198656,204800,206848,212992
.long 1024,1833984,1376256,11874304,640,327680,11706368,6144,8921088,8716288,11808768,11809064,260,260,11808768,9011200
.long 239616,8650752,1573504,3147008,640,15810560,268435456,147456,11874624,16384,18432,24576,0,2048,8192,10240
.long 58368,1776640,1376256,11874560,640,327808,11706368,6400,8925184,8724480,11808768,11809068,264,264,11808896,9011200
.long 256000,8650752,1573568,3147136,704,15814656,268435456,147456,11874640,43008,49152,51200,26624,32768,34816,40960
.long 115712,1719296,1376256,11874816,640,327936,11706368,6144,9281536,9076736,11808784,11809080,260,260,11809024,9011200
.long 272384,8650752,1606272,3212544,640,15818752,268435456,147584,11874656,73728,75776,81920,57344,59392,65536,67584
.long 173056,1661952,1376256,11875072,640,328064,11706368,6400,9285632,9084928,11808784,11809084,264,264,11809152,9011200
.long 288768,8650752,1606336,3212672,704,15822848,268435456,147584,11874672,100352,106496,108544,83968,90112,92160,98304
.long 2816,1832192,1605632,11874304,640,328192,11771904,6144,8986624,8830976,11808768,11809576,772,772,11809280,8650752
.long 305152,9011200,1639040,3278080,640,15941632,268435456,147712,11875136,131072,133120,139264,114688,116736,122880,124928
.long 60160,1774848,1605632,11874560,640,328320,11771904,6400,8990720,8839168,11808768,11809580,776,776,11809408,8650752
.long 321536,9011200,1639104,3278208,704,15945728,268435456,147712,11875152,157696,163840,165888,141312,147456,149504,155648
.long 117504,1717504,1605632,11874816,640,328448,11771904,6144,9347072,9191424,11808784,11809592,772,772,11809536,8650752
.long 337920,9011200,1671808,3343616,640,15949824,268435456,147840,11875168,188416,190464,196608,172032,174080,180224,182272
.long 174848,1660160,1605632,11875072,640,328576,11771904,6400,9351168,9199616,11808784,11809596,776,776,11809664,8650752
.long 354304,9011200,1671872,3343744,704,15953920,268435456,147840,11875184,215040,221184,223232,198656,204800,206848,212992
.long 1024,1833984,0,11863040,640,327680,11706368,512,991232,786432,11797504,11797800,260,260,11797504,1081344
.long 237568,720896,131712,263424,640,12926976,268435456,147456,11863360,24576,0,2048,8192,10240,16384,18432
.long 58368,1776640,0,11863296,640,327808,11706368,768,995328,794624,11797504,11797804,264,264,11797632,1081344
.long 253952,720896,131776,263552,704,12931072,268435456,147456,11863376,51200,26624,32768,34816,40960,43008,49152
.long 115712,1719296,0,11863552,640,327936,11706368,512,1351680,1146880,11797520,11797816,260,260,11797760,1081344
.long 270336,720896,164480,328960,640,12935168,268435456,147584,11863392,81920,57344,59392,65536,67584,73728,75776
.long 173056,1661952,0,11863808,640,328064,11706368,768,1355776,1155072,11797520,11797820,264,264,11797888,1081344
.long 286720,720896,164544,329088,704,12939264,268435456,147584,11863408,108544,83968,90112,92160,98304,100352,106496
.long 2816,1832192,229376,11863040,640,328192,11771904,512,1056768,901120,11797504,11798312,772,772,11798016,720896
.long 303104,1081344,197248,394496,640,13058048,268435456,147712,11863872,139264,114688,116736,122880,124928,131072,133120
.long 60160,1774848,229376,11863296,640,328320,11771904,768,1060864,909312,11797504,11798316,776,776,11798144,720896
.long 319488,1081344,197312,394624,704,13062144,268435456,147712,11863888,165888,141312,147456,149504,155648,157696,163840
.long 117504,1717504,229376,11863552,640,328448,11771904,512,1417216,1261568,11797520,11798328,772,772,11798272,720896
.long 335872,1081344,230016,460032,640,13066240,268435456,147840,11863904,196608,172032,174080,180224,182272,188416,190464
.long 174848,1660160,229376,11863808,640,328576,11771904,768,1421312,1269760,11797520,11798332,776,776,11798400,720896
.long 352256,1081344,230080,460160,704,13070336,268435456,147840,11863920,223232,198656,204800,206848,212992,215040,221184
.long 1024,1833984,458752,11867136,640,327680,11706368,2560,3874816,3670016,11801600,11801896,260,260,11801600,3964928
.long 237568,3604480,656000,1312000,640,13975552,268435456,147456,11867456,24576,0,2048,8192,10240,16384,18432
.long 58368,1776640,458752,11867392,640,327808,11706368,2816,3878912,3678208,11801600,11801900,264,264,11801728,3964928
.long 253952,3604480,656064,1312128,704,13979648,268435456,147456,11867472,51200,26624,32768,34816,40960,43008,49152
.long 115712,1719296,458752,11867648,640,327936,11706368,2560,4235264,4030464,11801616,11801912,260,260,11801856,3964928
.long 270336,3604480,688768,1377536,640,13983744,268435456,147584,11867488,81920,57344,59392,65536,67584,73728,75776
.long 173056,1661952,458752,11867904,640,328064,11706368,2816,4239360,4038656,11801616,11801916,264,264,11801984,3964928
.long 286720,3604480,688832,1377664,704,13987840,268435456,147584,11867504,108544,83968,90112,92160,98304,100352,106496
.long 2816,1832192,688128,11867136,640,328192,11771904,2560,3940352,3784704,11801600,11802408,772,772,11802112,3604480
.long 303104,3964928,721536,1443072,640,14106624,268435456,147712,11867968,139264,114688,116736,122880,124928,131072,133120
.long 60160,1774848,688128,11867392,640,328320,11771904,2816,3944448,3792896,11801600,11802412,776,776,11802240,3604480
.long 319488,3964928,721600,1443200,704,14110720,268435456,147712,11867984,165888,141312,147456,149504,155648,157696,163840
.long 117504,1717504,688128,11867648,640,328448,11771904,2560,4300800,4145152,11801616,11802424,772,772,11802368,3604480
.long 335872,3964928,754304,1508608,640,14114816,268435456,147840,11868000,196608,172032,174080,180224,182272,188416,190464
.long 174848,1660160,688128,11867904,640,328576,11771904,2816,4304896,4153344,11801616,11802428,776,776,11802496,3604480
.long 352256,3964928,754368,1508736,704,14118912,268435456,147840,11868016,223232,198656,204800,206848,212992,215040,221184
.long 1024,1833984,917504,11871232,640,327680,11706368,4608,6758400,6553600,11805696,11805992,260,260,11805696,6848512
.long 237568,6488064,1180288,2360576,640,15024128,268435456,147456,11871552,24576,0,2048,8192,10240,16384,18432
.long 58368,1776640,917504,11871488,640,327808,11706368,4864,6762496,6561792,11805696,11805996,264,264,11805824,6848512
.long 253952,6488064,1180352,2360704,704,15028224,268435456,147456,11871568,51200,26624,32768,34816,40960,43008,49152
.long 115712,1719296,917504,11871744,640,327936,11706368,4608,7118848,6914048,11805712,11806008,260,260,11805952,6848512
.long 270336,6488064,1213056,2426112,640,15032320,268435456,147584,11871584,81920,57344,59392,65536,67584,73728,75776
.long 173056,1661952,917504,11872000,640,328064,11706368,4864,7122944,6922240,11805712,11806012,264,264,11806080,6848512
.long 286720,6488064,1213120,2426240,704,15036416,268435456,147584,11871600,108544,83968,90112,92160,98304,100352,106496
.long 2816,1832192,1146880,11871232,640,328192,11771904,4608,6823936,6668288,11805696,11806504,772,772,11806208,6488064
.long 303104,6848512,1245824,2491648,640,15155200,268435456,147712,11872064,139264,114688,116736,122880,124928,131072,133120
.long 60160,1774848,1146880,11871488,640,328320,11771904,4864,6828032,6676480,11805696,11806508,776,776,11806336,6488064
.long 319488,6848512,1245888,2491776,704,15159296,268435456,147712,11872080,165888,141312,147456,149504,155648,157696,163840
.long 117504,1717504,1146880,11871744,640,328448,11771904,4608,7184384,7028736,11805712,11806520,772,772,11806464,6488064
.long 335872,6848512,1278592,2557184,640,15163392,268435456,147840,11872096,196608,172032,174080,180224,182272,188416,190464
.long 174848,1660160,1146880,11872000,640,328576,11771904,4864,7188480,7036928,11805712,11806524,776,776,11806592,6488064
.long 352256,6848512,1278656,2557312,704,15167488,268435456,147840,11872112,223232,198656,204800,206848,212992,215040,221184
.long 1024,1833984,1376256,11875328,640,327680,11706368,6656,9641984,9437184,11809792,11810088,260,260,11809792,9732096
.long 237568,9371648,1704576,3409152,640,16072704,268435456,147456,11875648,24576,0,2048,8192,10240,16384,18432
.long 58368,1776640,1376256,11875584,640,327808,11706368,6912,9646080,9445376,11809792,11810092,264,264,11809920,9732096
.long 253952,9371648,1704640,3409280,704,16076800,268435456,147456,11875664,51200,26624,32768,34816,40960,43008,49152
.long 115712,1719296,1376256,11875840,640,327936,11706368,6656,10002432,9797632,11809808,11810104,260,260,11810048,9732096
.long 270336,9371648,1737344,3474688,640,16080896,268435456,147584,11875680,81920,57344,59392,65536,67584,73728,75776
.long 173056,1661952,1376256,11876096,640,328064,11706368,6912,10006528,9805824,11809808,11810108,264,264,11810176,9732096
.long 286720,9371648,1737408,3474816,704,16084992,268435456,147584,11875696,108544,83968,90112,92160,98304,100352,106496
.long 2816,1832192,1605632,11875328,640,328192,11771904,6656,9707520,9551872,11809792,11810600,772,772,11810304,9371648
.long 303104,9732096,1770112,3540224,640,16203776,268435456,147712,11876160,139264,114688,116736,122880,124928,131072,133120
.long 60160,1774848,1605632,11875584,640,328320,11771904,6912,9711616,9560064,11809792,11810604,776,776,11810432,9371648
.long 319488,9732096,1770176,3540352,704,16207872,268435456,147712,11876176,165888,141312,147456,149504,155648,157696,163840
.long 117504,1717504,1605632,11875840,640,328448,11771904,6656,10067968,9912320,11809808,11810616,772,772,11810560,9371648
.long 335872,9732096,1802880,3605760,640,16211968,268435456,147840,11876192,196608,172032,174080,180224,182272,188416,190464
.long 174848,1660160,1605632,11876096,640,328576,11771904,6912,10072064,9920512,11809808,11810620,776,776,11810688,9371648
.long 352256,9732096,1802944,3605888,704,16216064,268435456,147840,11876208,223232,198656,204800,206848,212992,215040,221184
.long 1024,1833984,0,11864064,640,327680,11706368,1024,1712128,1507328,11798528,11798824,260,260,11798528,1802240
.long 239616,1441792,262784,525568,640,13189120,268435456,147456,11864384,0,2048,8192,10240,16384,18432,24576
.long 58368,1776640,0,11864320,640,327808,11706368,1280,1716224,1515520,11798528,11798828,264,264,11798656,1802240
.long 256000,1441792,262848,525696,704,13193216,268435456,147456,11864400,26624,32768,34816,40960,43008,49152,51200
.long 115712,1719296,0,11864576,640,327936,11706368,1024,2072576,1867776,11798544,11798840,260,260,11798784,1802240
.long 272384,1441792,295552,591104,640,13197312,268435456,147584,11864416,57344,59392,65536,67584,73728,75776,81920
.long 173056,1661952,0,11864832,640,328064,11706368,1280,2076672,1875968,11798544,11798844,264,264,11798912,1802240
.long 288768,1441792,295616,591232,704,13201408,268435456,147584,11864432,83968,90112,92160,98304,100352,106496,108544
.long 2816,1832192,229376,11864064,640,328192,11771904,1024,1777664,1622016,11798528,11799336,772,772,11799040,1441792
.long 305152,1802240,328320,656640,640,13320192,268435456,147712,11864896,114688,116736,122880,124928,131072,133120,139264
.long 60160,1774848,229376,11864320,640,328320,11771904,1280,1781760,1630208,11798528,11799340,776,776,11799168,1441792
.long 321536,1802240,328384,656768,704,13324288,268435456,147712,11864912,141312,147456,149504,155648,157696,163840,165888
.long 117504,1717504,229376,11864576,640,328448,11771904,1024,2138112,1982464,11798544,11799352,772,772,11799296,1441792
.long 337920,1802240,361088,722176,640,13328384,268435456,147840,11864928,172032,174080,180224,182272,188416,190464,196608
.long 174848,1660160,229376,11864832,640,328576,11771904,1280,2142208,1990656,11798544,11799356,776,776,11799424,1441792
.long 354304,1802240,361152,722304,704,13332480,268435456,147840,11864944,198656,204800,206848,212992,215040,221184,223232
.long 1024,1833984,458752,11868160,640,327680,11706368,3072,4595712,4390912,11802624,11802920,260,260,11802624,4685824
.long 239616,4325376,787072,1574144,640,14237696,268435456,147456,11868480,0,2048,8192,10240,16384,18432,24576
.long 58368,1776640,458752,11868416,640,327808,11706368,3328,4599808,4399104,11802624,11802924,264,264,11802752,4685824
.long 256000,4325376,787136,1574272,704,14241792,268435456,147456,11868496,26624,32768,34816,40960,43008,49152,51200
.long 115712,1719296,458752,11868672,640,327936,11706368,3072,4956160,4751360,11802640,11802936,260,260,11802880,4685824
.long 272384,4325376,819840,1639680,640,14245888,268435456,147584,11868512,57344,59392,65536,67584,73728,75776,81920
.long 173056,1661952,458752,11868928,640,328064,11706368,3328,4960256,4759552,11802640,11802940,264,264,11803008,4685824
.long 288768,4325376,819904,1639808,704,14249984,268435456,147584,11868528,83968,90112,92160,98304,100352,106496,108544
.long 2816,1832192,688128,11868160,640,328192,11771904,3072,4661248,4505600,11802624,11803432,772,772,11803136,4325376
.long 305152,4685824,852608,1705216,640,14368768,268435456,147712,11868992,114688,116736,122880,124928,131072,133120,139264
.long 60160,1774848,688128,11868416,640,328320,11771904,3328,4665344,4513792,11802624,11803436,776,776,11803264,4325376
.long 321536,4685824,852672,1705344,704,14372864,268435456,147712,11869008,141312,147456,149504,155648,157696,163840,165888
.long 117504,1717504,688128,11868672,640,328448,11771904,3072,5021696,4866048,11802640,11803448,772,772,11803392,4325376
.long 337920,4685824,885376,1770752,640,14376960,268435456,147840,11869024,172032,174080,180224,182272,188416,190464,196608
.long 174848,1660160,688128,11868928,640,328576,11771904,3328,5025792,4874240,11802640,11803452,776,776,11803520,4325376
.long 354304,4685824,885440,1770880,704,14381056,268435456,147840,11869040,198656,204800,206848,212992,215040,221184,223232
.long 1024,1833984,917504,11872256,640,327680,11706368,5120,7479296,7274496,11806720,11807016,260,260,11806720,7569408
.long 239616,7208960,1311360,2622720,640,15286272,268435456,147456,11872576,0,2048,8192,10240,16384,18432,24576
.long 58368,1776640,917504,11872512,640,327808,11706368,5376,7483392,7282688,11806720,11807020,264,264,11806848,7569408
.long 256000,7208960,1311424,2622848,704,15290368,268435456,147456,11872592,26624,32768,34816,40960,43008,49152,51200
.long 115712,1719296,917504,11872768,640,327936,11706368,5120,7839744,7634944,11806736,11807032,260,260,11806976,7569408
.long 272384,7208960,1344128,2688256,640,15294464,268435456,147584,11872608,57344,59392,65536,67584,73728,75776,81920
.long 173056,1661952,917504,11873024,640,328064,11706368,5376,7843840,7643136,11806736,11807036,264,264,11807104,7569408
.long 288768,7208960,1344192,2688384,704,15298560,268435456,147584,11872624,83968,90112,92160,98304,100352,106496,108544
.long 2816,1832192,1146880,11872256,640,328192,11771904,5120,7544832,7389184,11806720,11807528,772,772,11807232,7208960
.long 305152,7569408,1376896,2753792,640,15417344,268435456,147712,11873088,114688,116736,122880,124928,131072,133120,139264
.long 60160,1774848,1146880,11872512,640,328320,11771904,5376,7548928,7397376,11806720,11807532,776,776,11807360,7208960
.long 321536,7569408,1376960,2753920,704,15421440,268435456,147712,11873104,141312,147456,149504,155648,157696,163840,165888
.long 117504,1717504,1146880,11872768,640,328448,11771904,5120,7905280,7749632,11806736,11807544,772,772,11807488,7208960
.long 337920,7569408,1409664,2819328,640,15425536,268435456,147840,11873120,172032,174080,180224,182272,188416,190464,196608
.long 174848,1660160,1146880,11873024,640,328576,11771904,5376,7909376,7757824,11806736,11807548,776,776,11807616,7208960
.long 354304,7569408,1409728,2819456,704,15429632,268435456,147840,11873136,198656,204800,206848,212992,215040,221184,223232
.long 1024,1833984,1376256,11876352,640,327680,11706368,7168,10362880,10158080,11810816,11811112,260,260,11810816,10452992
.long 239616,10092544,1835648,3671296,640,16334848,268435456,147456,11876672,0,2048,8192,10240,16384,18432,24576
.long 58368,1776640,1376256,11876608,640,327808,11706368,7424,10366976,10166272,11810816,11811116,264,264,11810944,10452992
.long 256000,10092544,1835712,3671424,704,16338944,268435456,147456,11876688,26624,32768,34816,40960,43008,49152,51200
.long 115712,1719296,1376256,11876864,640,327936,11706368,7168,10723328,10518528,11810832,11811128,260,260,11811072,10452992
.long 272384,10092544,1868416,3736832,640,16343040,268435456,147584,11876704,57344,59392,65536,67584,73728,75776,81920
.long 173056,1661952,1376256,11877120,640,328064,11706368,7424,10727424,10526720,11810832,11811132,264,264,11811200,10452992
.long 288768,10092544,1868480,3736960,704,16347136,268435456,147584,11876720,83968,90112,92160,98304,100352,106496,108544
.long 2816,1832192,1605632,11876352,640,328192,11771904,7168,10428416,10272768,11810816,11811624,772,772,11811328,10092544
.long 305152,10452992,1901184,3802368,640,16465920,268435456,147712,11877184,114688,116736,122880,124928,131072,133120,139264
.long 60160,1774848,1605632,11876608,640,328320,11771904,7424,10432512,10280960,11810816,11811628,776,776,11811456,10092544
.long 321536,10452992,1901248,3802496,704,16470016,268435456,147712,11877200,141312,147456,149504,155648,157696,163840,165888
.long 117504,1717504,1605632,11876864,640,328448,11771904,7168,10788864,10633216,11810832,11811640,772,772,11811584,10092544
.long 337920,10452992,1933952,3867904,640,16474112,268435456,147840,11877216,172032,174080,180224,182272,188416,190464,196608
.long 174848,1660160,1605632,11877120,640,328576,11771904,7424,10792960,10641408,11810832,11811644,776,776,11811712,10092544
.long 354304,10452992,1934016,3868032,704,16478208,268435456,147840,11877232,198656,204800,206848,212992,215040,221184,223232
.long 1024,1833984,0,11865088,640,327680,11706368,1536,2433024,2228224,11799552,11799848,260,260,11799552,2523136
.long 237568,2162688,393856,787712,640,13451264,268435456,147456,11865408,8192,10240,16384,18432,24576,0,2048
.long 58368,1776640,0,11865344,640,327808,11706368,1792,2437120,2236416,11799552,11799852,264,264,11799680,2523136
.long 253952,2162688,393920,787840,704,13455360,268435456,147456,11865424,34816,40960,43008,49152,51200,26624,32768
.long 115712,1719296,0,11865600,640,327936,11706368,1536,2793472,2588672,11799568,11799864,260,260,11799808,2523136
.long 270336,2162688,426624,853248,640,13459456,268435456,147584,11865440,65536,67584,73728,75776,81920,57344,59392
.long 173056,1661952,0,11865856,640,328064,11706368,1792,2797568,2596864,11799568,11799868,264,264,11799936,2523136
.long 286720,2162688,426688,853376,704,13463552,268435456,147584,11865456,92160,98304,100352,106496,108544,83968,90112
.long 2816,1832192,229376,11865088,640,328192,11771904,1536,2498560,2342912,11799552,11800360,772,772,11800064,2162688
.long 303104,2523136,459392,918784,640,13582336,268435456,147712,11865920,122880,124928,131072,133120,139264,114688,116736
.long 60160,1774848,229376,11865344,640,328320,11771904,1792,2502656,2351104,11799552,11800364,776,776,11800192,2162688
.long 319488,2523136,459456,918912,704,13586432,268435456,147712,11865936,149504,155648,157696,163840,165888,141312,147456
.long 117504,1717504,229376,11865600,640,328448,11771904,1536,2859008,2703360,11799568,11800376,772,772,11800320,2162688
.long 335872,2523136,492160,984320,640,13590528,268435456,147840,11865952,180224,182272,188416,190464,196608,172032,174080
.long 174848,1660160,229376,11865856,640,328576,11771904,1792,2863104,2711552,11799568,11800380,776,776,11800448,2162688
.long 352256,2523136,492224,984448,704,13594624,268435456,147840,11865968,206848,212992,215040,221184,223232,198656,204800
.long 1024,1833984,458752,11869184,640,327680,11706368,3584,5316608,5111808,11803648,11803944,260,260,11803648,5406720
.long 237568,5046272,918144,1836288,640,14499840,268435456,147456,11869504,8192,10240,16384,18432,24576,0,2048
.long 58368,1776640,458752,11869440,640,327808,11706368,3840,5320704,5120000,11803648,11803948,264,264,11803776,5406720
.long 253952,5046272,918208,1836416,704,14503936,268435456,147456,11869520,34816,40960,43008,49152,51200,26624,32768
.long 115712,1719296,458752,11869696,640,327936,11706368,3584,5677056,5472256,11803664,11803960,260,260,11803904,5406720
.long 270336,5046272,950912,1901824,640,14508032,268435456,147584,11869536,65536,67584,73728,75776,81920,57344,59392
.long 173056,1661952,458752,11869952,640,328064,11706368,3840,5681152,5480448,11803664,11803964,264,264,11804032,5406720
.long 286720,5046272,950976,1901952,704,14512128,268435456,147584,11869552,92160,98304,100352,106496,108544,83968,90112
.long 2816,1832192,688128,11869184,640,328192,11771904,3584,5382144,5226496,11803648,11804456,772,772,11804160,5046272
.long 303104,5406720,983680,1967360,640,14630912,268435456,147712,11870016,122880,124928,131072,133120,139264,114688,116736
.long 60160,1774848,688128,11869440,640,328320,11771904,3840,5386240,5234688,11803648,11804460,776,776,11804288,5046272
.long 319488,5406720,983744,1967488,704,14635008,268435456,147712,11870032,149504,155648,157696,163840,165888,141312,147456
.long 117504,1717504,688128,11869696,640,328448,11771904,3584,5742592,5586944,11803664,11804472,772,772,11804416,5046272
.long 335872,5406720,1016448,2032896,640,14639104,268435456,147840,11870048,180224,182272,188416,190464,196608,172032,174080
.long 174848,1660160,688128,11869952,640,328576,11771904,3840,5746688,5595136,11803664,11804476,776,776,11804544,5046272
.long 352256,5406720,1016512,2033024,704,14643200,268435456,147840,11870064,206848,212992,215040,221184,223232,198656,204800
.long 1024,1833984,917504,11873280,640,327680,11706368,5632,8200192,7995392,11807744,11808040,260,260,11807744,8290304
.long 237568,7929856,1442432,2884864,640,15548416,268435456,147456,11873600,8192,10240,16384,18432,24576,0,2048
.long 58368,1776640,917504,11873536,640,327808,11706368,5888,8204288,8003584,11807744,11808044,264,264,11807872,8290304
.long 253952,7929856,1442496,2884992,704,15552512,268435456,147456,11873616,34816,40960,43008,49152,51200,26624,32768
.long 115712,1719296,917504,11873792,640,327936,11706368,5632,8560640,8355840,11807760,11808056,260,260,11808000,8290304
.long 270336,7929856,1475200,2950400,640,15556608,268435456,147584,11873632,65536,67584,73728,75776,81920,57344,59392
.long 173056,1661952,917504,11874048,640,328064,11706368,5888,8564736,8364032,11807760,11808060,264,264,11808128,8290304
.long 286720,7929856,1475264,2950528,704,15560704,268435456,147584,11873648,92160,98304,100352,106496,108544,83968,90112
.long 2816,1832192,1146880,11873280,640,328192,11771904,5632,8265728,8110080,11807744,11808552,772,772,11808256,7929856
.long 303104,8290304,1507968,3015936,640,15679488,268435456,147712,11874112,122880,124928,131072,133120,139264,114688,116736
.long 60160,1774848,1146880,11873536,640,328320,11771904,5888,8269824,8118272,11807744,11808556,776,776,11808384,7929856
.long 319488,8290304,1508032,3016064,704,15683584,268435456,147712,11874128,149504,155648,157696,163840,165888,141312,147456
.long 117504,1717504,1146880,11873792,640,328448,11771904,5632,8626176,8470528,11807760,11808568,772,772,11808512,7929856
.long 335872,8290304,1540736,3081472,640,15687680,268435456,147840,11874144,180224,182272,188416,190464,196608,172032,174080
.long 174848,1660160,1146880,11874048,640,328576,11771904,5888,8630272,8478720,11807760,11808572,776,776,11808640,7929856
.long 352256,8290304,1540800,3081600,704,15691776,268435456,147840,11874160,206848,212992,215040,221184,223232,198656,204800
.long 1024,1833984,1376256,11877376,640,327680,11706368,7680,11083776,10878976,11811840,11812136,260,260,11811840,11173888
.long 237568,10813440,1966720,3933440,640,16596992,268435456,147456,11877696,8192,10240,16384,18432,24576,0,2048
.long 58368,1776640,1376256,11877632,640,327808,11706368,7936,11087872,10887168,11811840,11812140,264,264,11811968,11173888
.long 253952,10813440,1966784,3933568,704,16601088,268435456,147456,11877712,34816,40960,43008,49152,51200,26624,32768
.long 115712,1719296,1376256,11877888,640,327936,11706368,7680,11444224,11239424,11811856,11812152,260,260,11812096,11173888
.long 270336,10813440,1999488,3998976,640,16605184,268435456,147584,11877728,65536,67584,73728,75776,81920,57344,59392
.long 173056,1661952,1376256,11878144,640,328064,11706368,7936,11448320,11247616,11811856,11812156,264,264,11812224,11173888
.long 286720,10813440,1999552,3999104,704,16609280,268435456,147584,11877744,92160,98304,100352,106496,108544,83968,90112
.long 2816,1832192,1605632,11877376,640,328192,11771904,7680,11149312,10993664,11811840,11812648,772,772,11812352,10813440
.long 303104,11173888,2032256,4064512,640,16728064,268435456,147712,11878208,122880,124928,131072,133120,139264,114688,116736
.long 60160,1774848,1605632,11877632,640,328320,11771904,7936,11153408,11001856,11811840,11812652,776,776,11812480,10813440
.long 319488,11173888,2032320,4064640,704,16732160,268435456,147712,11878224,149504,155648,157696,163840,165888,141312,147456
.long 117504,1717504,1605632,11877888,640,328448,11771904,7680,11509760,11354112,11811856,11812664,772,772,11812608,10813440
.long 335872,11173888,2065024,4130048,640,16736256,268435456,147840,11878240,180224,182272,188416,190464,196608,172032,174080
.long 174848,1660160,1605632,11878144,640,328576,11771904,7936,11513856,11362304,11811856,11812668,776,776,11812736,10813440
.long 352256,11173888,2065088,4130176,704,16740352,268435456,147840,11878256,206848,212992,215040,221184,223232,198656,204800
.long 1280,1833728,0,11862016,768,393216,11714560,0,278528,81920,11796480,11796896,268,384,11796480,360448
.long 241664,0,768,1536,768,12681216,268435456,147456,11862400,18432,24576,0,2048,8192,10240,16384
.long 58624,1776384,0,11862272,768,393344,11714560,256,282624,90112,11796480,11796900,388,388,11796608,360448
.long 258048,0,832,1664,832,12685312,268435456,147456,11862416,49152,51200,26624,32768,34816,40960,43008
.long 115968,1719040,0,11862528,768,393472,11714560,0,638976,442368,11796496,11796912,268,384,11796736,360448
.long 274432,0,33536,67072,768,12689408,268435456,147584,11862432,75776,81920,57344,59392,65536,67584,73728
.long 173312,1661696,0,11862784,768,393600,11714560,256,643072,450560,11796496,11796916,388,388,11796864,360448
.long 290816,0,33600,67200,832,12693504,268435456,147584,11862448,106496,108544,83968,90112,92160,98304,100352
.long 3072,1831936,229376,11862016,768,393728,11780096,0,344064,196608,11796480,11797408,780,896,11796992,0
.long 307200,360448,66304,132608,768,12812288,268435456,147712,11862912,133120,139264,114688,116736,122880,124928,131072
.long 60416,1774592,229376,11862272,768,393856,11780096,256,348160,204800,11796480,11797412,900,900,11797120,0
.long 323584,360448,66368,132736,832,12816384,268435456,147712,11862928,163840,165888,141312,147456,149504,155648,157696
.long 117760,1717248,229376,11862528,768,393984,11780096,0,704512,557056,11796496,11797424,780,896,11797248,0
.long 339968,360448,99072,198144,768,12820480,268435456,147840,11862944,190464,196608,172032,174080,180224,182272,188416
.long 175104,1659904,229376,11862784,768,394112,11780096,256,708608,565248,11796496,11797428,900,900,11797376,0
.long 356352,360448,99136,198272,832,12824576,268435456,147840,11862960,221184,223232,198656,204800,206848,212992,215040
.long 1280,1833728,458752,11866112,768,393216,11714560,2048,3162112,2965504,11800576,11800992,268,384,11800576,3244032
.long 241664,2883584,525056,1050112,768,13729792,268435456,147456,11866496,18432,24576,0,2048,8192,10240,16384
.long 58624,1776384,458752,11866368,768,393344,11714560,2304,3166208,2973696,11800576,11800996,388,388,11800704,3244032
.long 258048,2883584,525120,1050240,832,13733888,268435456,147456,11866512,49152,51200,26624,32768,34816,40960,43008
.long 115968,1719040,458752,11866624,768,393472,11714560,2048,3522560,3325952,11800592,11801008,268,384,11800832,3244032
.long 274432,2883584,557824,1115648,768,13737984,268435456,147584,11866528,75776,81920,57344,59392,65536,67584,73728
.long 173312,1661696,458752,11866880,768,393600,11714560,2304,3526656,3334144,11800592,11801012,388,388,11800960,3244032
.long 290816,2883584,557888,1115776,832,13742080,268435456,147584,11866544,106496,108544,83968,90112,92160,98304,100352
.long 3072,1831936,688128,11866112,768,393728,11780096,2048,3227648,3080192,11800576,11801504,780,896,11801088,2883584
.long 307200,3244032,590592,1181184,768,13860864,268435456,147712,11867008,133120,139264,114688,116736,122880,124928,131072
.long 60416,1774592,688128,11866368,768,393856,11780096,2304,3231744,3088384,11800576,11801508,900,900,11801216,2883584
.long 323584,3244032,590656,1181312,832,13864960,268435456,147712,11867024,163840,165888,141312,147456,149504,155648,157696
.long 117760,1717248,688128,11866624,768,393984,11780096,2048,3588096,3440640,11800592,11801520,780,896,11801344,2883584
.long 339968,3244032,623360,1246720,768,13869056,268435456,147840,11867040,190464,196608,172032,174080,180224,182272,188416
.long 175104,1659904,688128,11866880,768,394112,11780096,2304,3592192,3448832,11800592,11801524,900,900,11801472,2883584
.long 356352,3244032,623424,1246848,832,13873152,268435456,147840,11867056,221184,223232,198656,204800,206848,212992,215040
.long 1280,1833728,917504,11870208,768,393216,11714560,4096,6045696,5849088,11804672,11805088,268,384,11804672,6127616
.long 241664,5767168,1049344,2098688,768,14778368,268435456,147456,11870592,18432,24576,0,2048,8192,10240,16384
.long 58624,1776384,917504,11870464,768,393344,11714560,4352,6049792,5857280,11804672,11805092,388,388,11804800,6127616
.long 258048,5767168,1049408,2098816,832,14782464,268435456,147456,11870608,49152,51200,26624,32768,34816,40960,43008
.long 115968,1719040,917504,11870720,768,393472,11714560,4096,6406144,6209536,11804688,11805104,268,384,11804928,6127616
.long 274432,5767168,1082112,2164224,768,14786560,268435456,147584,11870624,75776,81920,57344,59392,65536,67584,73728
.long 173312,1661696,917504,11870976,768,393600,11714560,4352,6410240,6217728,11804688,11805108,388,388,11805056,6127616
.long 290816,5767168,1082176,2164352,832,14790656,268435456,147584,11870640,106496,108544,83968,90112,92160,98304,100352
.long 3072,1831936,1146880,11870208,768,393728,11780096,4096,6111232,5963776,11804672,11805600,780,896,11805184,5767168
.long 307200,6127616,1114880,2229760,768,14909440,268435456,147712,11871104,133120,139264,114688,116736,122880,124928,131072
.long 60416,1774592,1146880,11870464,768,393856,11780096,4352,6115328,5971968,11804672,11805604,900,900,11805312,5767168
.long 323584,6127616,1114944,2229888,832,14913536,268435456,147712,11871120,163840,165888,141312,147456,149504,155648,157696
.long 117760,1717248,1146880,11870720,768,393984,11780096,4096,6471680,6324224,11804688,11805616,780,896,11805440,5767168
.long 339968,6127616,1147648,2295296,768,14917632,268435456,147840,11871136,190464,196608,172032,174080,180224,182272,188416
.long 175104,1659904,1146880,11870976,768,394112,11780096,4352,6475776,6332416,11804688,11805620,900,900,11805568,5767168
.long 356352,6127616,1147712,2295424,832,14921728,268435456,147840,11871152,221184,223232,198656,204800,206848,212992,215040
.long 1280,1833728,1376256,11874304,768,393216,11714560,6144,8929280,8732672,11808768,11809184,268,384,11808768,9011200
.long 241664,8650752,1573632,3147264,768,15826944,268435456,147456,11874688,18432,24576,0,2048,8192,10240,16384
.long 58624,1776384,1376256,11874560,768,393344,11714560,6400,8933376,8740864,11808768,11809188,388,388,11808896,9011200
.long 258048,8650752,1573696,3147392,832,15831040,268435456,147456,11874704,49152,51200,26624,32768,34816,40960,43008
.long 115968,1719040,1376256,11874816,768,393472,11714560,6144,9289728,9093120,11808784,11809200,268,384,11809024,9011200
.long 274432,8650752,1606400,3212800,768,15835136,268435456,147584,11874720,75776,81920,57344,59392,65536,67584,73728
.long 173312,1661696,1376256,11875072,768,393600,11714560,6400,9293824,9101312,11808784,11809204,388,388,11809152,9011200
.long 290816,8650752,1606464,3212928,832,15839232,268435456,147584,11874736,106496,108544,83968,90112,92160,98304,100352
.long 3072,1831936,1605632,11874304,768,393728,11780096,6144,8994816,8847360,11808768,11809696,780,896,11809280,8650752
.long 307200,9011200,1639168,3278336,768,15958016,268435456,147712,11875200,133120,139264,114688,116736,122880,124928,131072
.long 60416,1774592,1605632,11874560,768,393856,11780096,6400,8998912,8855552,11808768,11809700,900,900,11809408,8650752
.long 323584,9011200,1639232,3278464,832,15962112,268435456,147712,11875216,163840,165888,141312,147456,149504,155648,157696
.long 117760,1717248,1605632,11874816,768,393984,11780096,6144,9355264,9207808,11808784,11809712,780,896,11809536,8650752
.long 339968,9011200,1671936,3343872,768,15966208,268435456,147840,11875232,190464,196608,172032,174080,180224,182272,188416
.long 175104,1659904,1605632,11875072,768,394112,11780096,6400,9359360,9216000,11808784,11809716,900,900,11809664,8650752
.long 356352,9011200,1672000,3344000,832,15970304,268435456,147840,11875248,221184,223232,198656,204800,206848,212992,215040
.long 1280,1833728,0,11863040,768,393216,11714560,512,999424,802816,11797504,11797920,268,384,11797504,1081344
.long 243712,720896,131840,263680,768,12943360,268435456,147456,11863424,0,2048,8192,10240,16384,18432,24576
.long 58624,1776384,0,11863296,768,393344,11714560,768,1003520,811008,11797504,11797924,388,388,11797632,1081344
.long 260096,720896,131904,263808,832,12947456,268435456,147456,11863440,26624,32768,34816,40960,43008,49152,51200
.long 115968,1719040,0,11863552,768,393472,11714560,512,1359872,1163264,11797520,11797936,268,384,11797760,1081344
.long 276480,720896,164608,329216,768,12951552,268435456,147584,11863456,57344,59392,65536,67584,73728,75776,81920
.long 173312,1661696,0,11863808,768,393600,11714560,768,1363968,1171456,11797520,11797940,388,388,11797888,1081344
.long 292864,720896,164672,329344,832,12955648,268435456,147584,11863472,83968,90112,92160,98304,100352,106496,108544
.long 3072,1831936,229376,11863040,768,393728,11780096,512,1064960,917504,11797504,11798432,780,896,11798016,720896
.long 309248,1081344,197376,394752,768,13074432,268435456,147712,11863936,114688,116736,122880,124928,131072,133120,139264
.long 60416,1774592,229376,11863296,768,393856,11780096,768,1069056,925696,11797504,11798436,900,900,11798144,720896
.long 325632,1081344,197440,394880,832,13078528,268435456,147712,11863952,141312,147456,149504,155648,157696,163840,165888
.long 117760,1717248,229376,11863552,768,393984,11780096,512,1425408,1277952,11797520,11798448,780,896,11798272,720896
.long 342016,1081344,230144,460288,768,13082624,268435456,147840,11863968,172032,174080,180224,182272,188416,190464,196608
.long 175104,1659904,229376,11863808,768,394112,11780096,768,1429504,1286144,11797520,11798452,900,900,11798400,720896
.long 358400,1081344,230208,460416,832,13086720,268435456,147840,11863984,198656,204800,206848,212992,215040,221184,223232
.long 1280,1833728,458752,11867136,768,393216,11714560,2560,3883008,3686400,11801600,11802016,268,384,11801600,3964928
.long 243712,3604480,656128,1312256,768,13991936,268435456,147456,11867520,0,2048,8192,10240,16384,18432,24576
.long 58624,1776384,458752,11867392,768,393344,11714560,2816,3887104,3694592,11801600,11802020,388,388,11801728,3964928
.long 260096,3604480,656192,1312384,832,13996032,268435456,147456,11867536,26624,32768,34816,40960,43008,49152,51200
.long 115968,1719040,458752,11867648,768,393472,11714560,2560,4243456,4046848,11801616,11802032,268,384,11801856,3964928
.long 276480,3604480,688896,1377792,768,14000128,268435456,147584,11867552,57344,59392,65536,67584,73728,75776,81920
.long 173312,1661696,458752,11867904,768,393600,11714560,2816,4247552,4055040,11801616,11802036,388,388,11801984,3964928
.long 292864,3604480,688960,1377920,832,14004224,268435456,147584,11867568,83968,90112,92160,98304,100352,106496,108544
.long 3072,1831936,688128,11867136,768,393728,11780096,2560,3948544,3801088,11801600,11802528,780,896,11802112,3604480
.long 309248,3964928,721664,1443328,768,14123008,268435456,147712,11868032,114688,116736,122880,124928,131072,133120,139264
.long 60416,1774592,688128,11867392,768,393856,11780096,2816,3952640,3809280,11801600,11802532,900,900,11802240,3604480
.long 325632,3964928,721728,1443456,832,14127104,268435456,147712,11868048,141312,147456,149504,155648,157696,163840,165888
.long 117760,1717248,688128,11867648,768,393984,11780096,2560,4308992,4161536,11801616,11802544,780,896,11802368,3604480
.long 342016,3964928,754432,1508864,768,14131200,268435456,147840,11868064,172032,174080,180224,182272,188416,190464,196608
.long 175104,1659904,688128,11867904,768,394112,11780096,2816,4313088,4169728,11801616,11802548,900,900,11802496,3604480
.long 358400,3964928,754496,1508992,832,14135296,268435456,147840,11868080,198656,204800,206848,212992,215040,221184,223232
.long 1280,1833728,917504,11871232,768,393216,11714560,4608,6766592,6569984,11805696,11806112,268,384,11805696,6848512
.long 243712,6488064,1180416,2360832,768,15040512,268435456,147456,11871616,0,2048,8192,10240,16384,18432,24576
.long 58624,1776384,917504,11871488,768,393344,11714560,4864,6770688,6578176,11805696,11806116,388,388,11805824,6848512
.long 260096,6488064,1180480,2360960,832,15044608,268435456,147456,11871632,26624,32768,34816,40960,43008,49152,51200
.long 115968,1719040,917504,11871744,768,393472,11714560,4608,7127040,6930432,11805712,11806128,268,384,11805952,6848512
.long 276480,6488064,1213184,2426368,768,15048704,268435456,147584,11871648,57344,59392,65536,67584,73728,75776,81920
.long 173312,1661696,917504,11872000,768,393600,11714560,4864,7131136,6938624,11805712,11806132,388,388,11806080,6848512
.long 292864,6488064,1213248,2426496,832,15052800,268435456,147584,11871664,83968,90112,92160,98304,100352,106496,108544
.long 3072,1831936,1146880,11871232,768,393728,11780096,4608,6832128,6684672,11805696,11806624,780,896,11806208,6488064
.long 309248,6848512,1245952,2491904,768,15171584,268435456,147712,11872128,114688,116736,122880,124928,131072,133120,139264
.long 60416,1774592,1146880,11871488,768,393856,11780096,4864,6836224,6692864,11805696,11806628,900,900,11806336,6488064
.long 325632,6848512,1246016,2492032,832,15175680,268435456,147712,11872144,141312,147456,149504,155648,157696,163840,165888
.long 117760,1717248,1146880,11871744,768,393984,11780096,4608,7192576,7045120,11805712,11806640,780,896,11806464,6488064
.long 342016,6848512,1278720,2557440,768,15179776,268435456,147840,11872160,172032,174080,180224,182272,188416,190464,196608
.long 175104,1659904,1146880,11872000,768,394112,11780096,4864,7196672,7053312,11805712,11806644,900,900,11806592,6488064
.long 358400,6848512,1278784,2557568,832,15183872,268435456,147840,11872176,198656,204800,206848,212992,215040,221184,223232
.long 1280,1833728,1376256,11875328,768,393216,11714560,6656,9650176,9453568,11809792,11810208,268,384,11809792,9732096
.long 243712,9371648,1704704,3409408,768,16089088,268435456,147456,11875712,0,2048,8192,10240,16384,18432,24576
.long 58624,1776384,1376256,11875584,768,393344,11714560,6912,9654272,9461760,11809792,11810212,388,388,11809920,9732096
.long 260096,9371648,1704768,3409536,832,16093184,268435456,147456,11875728,26624,32768,34816,40960,43008,49152,51200
.long 115968,1719040,1376256,11875840,768,393472,11714560,6656,10010624,9814016,11809808,11810224,268,384,11810048,9732096
.long 276480,9371648,1737472,3474944,768,16097280,268435456,147584,11875744,57344,59392,65536,67584,73728,75776,81920
.long 173312,1661696,1376256,11876096,768,393600,11714560,6912,10014720,9822208,11809808,11810228,388,388,11810176,9732096
.long 292864,9371648,1737536,3475072,832,16101376,268435456,147584,11875760,83968,90112,92160,98304,100352,106496,108544
.long 3072,1831936,1605632,11875328,768,393728,11780096,6656,9715712,9568256,11809792,11810720,780,896,11810304,9371648
.long 309248,9732096,1770240,3540480,768,16220160,268435456,147712,11876224,114688,116736,122880,124928,131072,133120,139264
.long 60416,1774592,1605632,11875584,768,393856,11780096,6912,9719808,9576448,11809792,11810724,900,900,11810432,9371648
.long 325632,9732096,1770304,3540608,832,16224256,268435456,147712,11876240,141312,147456,149504,155648,157696,163840,165888
.long 117760,1717248,1605632,11875840,768,393984,11780096,6656,10076160,9928704,11809808,11810736,780,896,11810560,9371648
.long 342016,9732096,1803008,3606016,768,16228352,268435456,147840,11876256,172032,174080,180224,182272,188416,190464,196608
.long 175104,1659904,1605632,11876096,768,394112,11780096,6912,10080256,9936896,11809808,11810740,900,900,11810688,9371648
.long 358400,9732096,1803072,3606144,832,16232448,268435456,147840,11876272,198656,204800,206848,212992,215040,221184,223232
.long 1280,1833728,0,11864064,768,393216,11714560,1024,1720320,1523712,11798528,11798944,268,384,11798528,1802240
.long 241664,1441792,262912,525824,768,13205504,268435456,147456,11864448,2048,8192,10240,16384,18432,24576,0
.long 58624,1776384,0,11864320,768,393344,11714560,1280,1724416,1531904,11798528,11798948,388,388,11798656,1802240
.long 258048,1441792,262976,525952,832,13209600,268435456,147456,11864464,32768,34816,40960,43008,49152,51200,26624
.long 115968,1719040,0,11864576,768,393472,11714560,1024,2080768,1884160,11798544,11798960,268,384,11798784,1802240
.long 274432,1441792,295680,591360,768,13213696,268435456,147584,11864480,59392,65536,67584,73728,75776,81920,57344
.long 173312,1661696,0,11864832,768,393600,11714560,1280,2084864,1892352,11798544,11798964,388,388,11798912,1802240
.long 290816,1441792,295744,591488,832,13217792,268435456,147584,11864496,90112,92160,98304,100352,106496,108544,83968
.long 3072,1831936,229376,11864064,768,393728,11780096,1024,1785856,1638400,11798528,11799456,780,896,11799040,1441792
.long 307200,1802240,328448,656896,768,13336576,268435456,147712,11864960,116736,122880,124928,131072,133120,139264,114688
.long 60416,1774592,229376,11864320,768,393856,11780096,1280,1789952,1646592,11798528,11799460,900,900,11799168,1441792
.long 323584,1802240,328512,657024,832,13340672,268435456,147712,11864976,147456,149504,155648,157696,163840,165888,141312
.long 117760,1717248,229376,11864576,768,393984,11780096,1024,2146304,1998848,11798544,11799472,780,896,11799296,1441792
.long 339968,1802240,361216,722432,768,13344768,268435456,147840,11864992,174080,180224,182272,188416,190464,196608,172032
.long 175104,1659904,229376,11864832,768,394112,11780096,1280,2150400,2007040,11798544,11799476,900,900,11799424,1441792
.long 356352,1802240,361280,722560,832,13348864,268435456,147840,11865008,204800,206848,212992,215040,221184,223232,198656
.long 1280,1833728,458752,11868160,768,393216,11714560,3072,4603904,4407296,11802624,11803040,268,384,11802624,4685824
.long 241664,4325376,787200,1574400,768,14254080,268435456,147456,11868544,2048,8192,10240,16384,18432,24576,0
.long 58624,1776384,458752,11868416,768,393344,11714560,3328,4608000,4415488,11802624,11803044,388,388,11802752,4685824
.long 258048,4325376,787264,1574528,832,14258176,268435456,147456,11868560,32768,34816,40960,43008,49152,51200,26624
.long 115968,1719040,458752,11868672,768,393472,11714560,3072,4964352,4767744,11802640,11803056,268,384,11802880,4685824
.long 274432,4325376,819968,1639936,768,14262272,268435456,147584,11868576,59392,65536,67584,73728,75776,81920,57344
.long 173312,1661696,458752,11868928,768,393600,11714560,3328,4968448,4775936,11802640,11803060,388,388,11803008,4685824
.long 290816,4325376,820032,1640064,832,14266368,268435456,147584,11868592,90112,92160,98304,100352,106496,108544,83968
.long 3072,1831936,688128,11868160,768,393728,11780096,3072,4669440,4521984,11802624,11803552,780,896,11803136,4325376
.long 307200,4685824,852736,1705472,768,14385152,268435456,147712,11869056,116736,122880,124928,131072,133120,139264,114688
.long 60416,1774592,688128,11868416,768,393856,11780096,3328,4673536,4530176,11802624,11803556,900,900,11803264,4325376
.long 323584,4685824,852800,1705600,832,14389248,268435456,147712,11869072,147456,149504,155648,157696,163840,165888,141312
.long 117760,1717248,688128,11868672,768,393984,11780096,3072,5029888,4882432,11802640,11803568,780,896,11803392,4325376
.long 339968,4685824,885504,1771008,768,14393344,268435456,147840,11869088,174080,180224,182272,188416,190464,196608,172032
.long 175104,1659904,688128,11868928,768,394112,11780096,3328,5033984,4890624,11802640,11803572,900,900,11803520,4325376
.long 356352,4685824,885568,1771136,832,14397440,268435456,147840,11869104,204800,206848,212992,215040,221184,223232,198656
.long 1280,1833728,917504,11872256,768,393216,11714560,5120,7487488,7290880,11806720,11807136,268,384,11806720,7569408
.long 241664,7208960,1311488,2622976,768,15302656,268435456,147456,11872640,2048,8192,10240,16384,18432,24576,0
.long 58624,1776384,917504,11872512,768,393344,11714560,5376,7491584,7299072,11806720,11807140,388,388,11806848,7569408
.long 258048,7208960,1311552,2623104,832,15306752,268435456,147456,11872656,32768,34816,40960,43008,49152,51200,26624
.long 115968,1719040,917504,11872768,768,393472,11714560,5120,7847936,7651328,11806736,11807152,268,384,11806976,7569408
.long 274432,7208960,1344256,2688512,768,15310848,268435456,147584,11872672,59392,65536,67584,73728,75776,81920,57344
.long 173312,1661696,917504,11873024,768,393600,11714560,5376,7852032,7659520,11806736,11807156,388,388,11807104,7569408
.long 290816,7208960,1344320,2688640,832,15314944,268435456,147584,11872688,90112,92160,98304,100352,106496,108544,83968
.long 3072,1831936,1146880,11872256,768,393728,11780096,5120,7553024,7405568,11806720,11807648,780,896,11807232,7208960
.long 307200,7569408,1377024,2754048,768,15433728,268435456,147712,11873152,116736,122880,124928,131072,133120,139264,114688
.long 60416,1774592,1146880,11872512,768,393856,11780096,5376,7557120,7413760,11806720,11807652,900,900,11807360,7208960
.long 323584,7569408,1377088,2754176,832,15437824,268435456,147712,11873168,147456,149504,155648,157696,163840,165888,141312
.long 117760,1717248,1146880,11872768,768,393984,11780096,5120,7913472,7766016,11806736,11807664,780,896,11807488,7208960
.long 339968,7569408,1409792,2819584,768,15441920,268435456,147840,11873184,174080,180224,182272,188416,190464,196608,172032
.long 175104,1659904,1146880,11873024,768,394112,11780096,5376,7917568,7774208,11806736,11807668,900,900,11807616,7208960
.long 356352,7569408,1409856,2819712,832,15446016,268435456,147840,11873200,204800,206848,212992,215040,221184,223232,198656
.long 1280,1833728,1376256,11876352,768,393216,11714560,7168,10371072,10174464,11810816,11811232,268,384,11810816,10452992
.long 241664,10092544,1835776,3671552,768,16351232,268435456,147456,11876736,2048,8192,10240,16384,18432,24576,0
.long 58624,1776384,1376256,11876608,768,393344,11714560,7424,10375168,10182656,11810816,11811236,388,388,11810944,10452992
.long 258048,10092544,1835840,3671680,832,16355328,268435456,147456,11876752,32768,34816,40960,43008,49152,51200,26624
.long 115968,1719040,1376256,11876864,768,393472,11714560,7168,10731520,10534912,11810832,11811248,268,384,11811072,10452992
.long 274432,10092544,1868544,3737088,768,16359424,268435456,147584,11876768,59392,65536,67584,73728,75776,81920,57344
.long 173312,1661696,1376256,11877120,768,393600,11714560,7424,10735616,10543104,11810832,11811252,388,388,11811200,10452992
.long 290816,10092544,1868608,3737216,832,16363520,268435456,147584,11876784,90112,92160,98304,100352,106496,108544,83968
.long 3072,1831936,1605632,11876352,768,393728,11780096,7168,10436608,10289152,11810816,11811744,780,896,11811328,10092544
.long 307200,10452992,1901312,3802624,768,16482304,268435456,147712,11877248,116736,122880,124928,131072,133120,139264,114688
.long 60416,1774592,1605632,11876608,768,393856,11780096,7424,10440704,10297344,11810816,11811748,900,900,11811456,10092544
.long 323584,10452992,1901376,3802752,832,16486400,268435456,147712,11877264,147456,149504,155648,157696,163840,165888,141312
.long 117760,1717248,1605632,11876864,768,393984,11780096,7168,10797056,10649600,11810832,11811760,780,896,11811584,10092544
.long 339968,10452992,1934080,3868160,768,16490496,268435456,147840,11877280,174080,180224,182272,188416,190464,196608,172032
.long 175104,1659904,1605632,11877120,768,394112,11780096,7424,10801152,10657792,11810832,11811764,900,900,11811712,10092544
.long 356352,10452992,1934144,3868288,832,16494592,268435456,147840,11877296,204800,206848,212992,215040,221184,223232,198656
.long 1280,1833728,0,11865088,768,393216,11714560,1536,2441216,2244608,11799552,11799968,268,384,11799552,2523136
.long 243712,2162688,393984,787968,768,13467648,268435456,147456,11865472,10240,16384,18432,24576,0,2048,8192
.long 58624,1776384,0,11865344,768,393344,11714560,1792,2445312,2252800,11799552,11799972,388,388,11799680,2523136
.long 260096,2162688,394048,788096,832,13471744,268435456,147456,11865488,40960,43008,49152,51200,26624,32768,34816
.long 115968,1719040,0,11865600,768,393472,11714560,1536,2801664,2605056,11799568,11799984,268,384,11799808,2523136
.long 276480,2162688,426752,853504,768,13475840,268435456,147584,11865504,67584,73728,75776,81920,57344,59392,65536
.long 173312,1661696,0,11865856,768,393600,11714560,1792,2805760,2613248,11799568,11799988,388,388,11799936,2523136
.long 292864,2162688,426816,853632,832,13479936,268435456,147584,11865520,98304,100352,106496,108544,83968,90112,92160
.long 3072,1831936,229376,11865088,768,393728,11780096,1536,2506752,2359296,11799552,11800480,780,896,11800064,2162688
.long 309248,2523136,459520,919040,768,13598720,268435456,147712,11865984,124928,131072,133120,139264,114688,116736,122880
.long 60416,1774592,229376,11865344,768,393856,11780096,1792,2510848,2367488,11799552,11800484,900,900,11800192,2162688
.long 325632,2523136,459584,919168,832,13602816,268435456,147712,11866000,155648,157696,163840,165888,141312,147456,149504
.long 117760,1717248,229376,11865600,768,393984,11780096,1536,2867200,2719744,11799568,11800496,780,896,11800320,2162688
.long 342016,2523136,492288,984576,768,13606912,268435456,147840,11866016,182272,188416,190464,196608,172032,174080,180224
.long 175104,1659904,229376,11865856,768,394112,11780096,1792,2871296,2727936,11799568,11800500,900,900,11800448,2162688
.long 358400,2523136,492352,984704,832,13611008,268435456,147840,11866032,212992,215040,221184,223232,198656,204800,206848
.long 1280,1833728,458752,11869184,768,393216,11714560,3584,5324800,5128192,11803648,11804064,268,384,11803648,5406720
.long 243712,5046272,918272,1836544,768,14516224,268435456,147456,11869568,10240,16384,18432,24576,0,2048,8192
.long 58624,1776384,458752,11869440,768,393344,11714560,3840,5328896,5136384,11803648,11804068,388,388,11803776,5406720
.long 260096,5046272,918336,1836672,832,14520320,268435456,147456,11869584,40960,43008,49152,51200,26624,32768,34816
.long 115968,1719040,458752,11869696,768,393472,11714560,3584,5685248,5488640,11803664,11804080,268,384,11803904,5406720
.long 276480,5046272,951040,1902080,768,14524416,268435456,147584,11869600,67584,73728,75776,81920,57344,59392,65536
.long 173312,1661696,458752,11869952,768,393600,11714560,3840,5689344,5496832,11803664,11804084,388,388,11804032,5406720
.long 292864,5046272,951104,1902208,832,14528512,268435456,147584,11869616,98304,100352,106496,108544,83968,90112,92160
.long 3072,1831936,688128,11869184,768,393728,11780096,3584,5390336,5242880,11803648,11804576,780,896,11804160,5046272
.long 309248,5406720,983808,1967616,768,14647296,268435456,147712,11870080,124928,131072,133120,139264,114688,116736,122880
.long 60416,1774592,688128,11869440,768,393856,11780096,3840,5394432,5251072,11803648,11804580,900,900,11804288,5046272
.long 325632,5406720,983872,1967744,832,14651392,268435456,147712,11870096,155648,157696,163840,165888,141312,147456,149504
.long 117760,1717248,688128,11869696,768,393984,11780096,3584,5750784,5603328,11803664,11804592,780,896,11804416,5046272
.long 342016,5406720,1016576,2033152,768,14655488,268435456,147840,11870112,182272,188416,190464,196608,172032,174080,180224
.long 175104,1659904,688128,11869952,768,394112,11780096,3840,5754880,5611520,11803664,11804596,900,900,11804544,5046272
.long 358400,5406720,1016640,2033280,832,14659584,268435456,147840,11870128,212992,215040,221184,223232,198656,204800,206848
.long 1280,1833728,917504,11873280,768,393216,11714560,5632,8208384,8011776,11807744,11808160,268,384,11807744,8290304
.long 243712,7929856,1442560,2885120,768,15564800,268435456,147456,11873664,10240,16384,18432,24576,0,2048,8192
.long 58624,1776384,917504,11873536,768,393344,11714560,5888,8212480,8019968,11807744,11808164,388,388,11807872,8290304
.long 260096,7929856,1442624,2885248,832,15568896,268435456,147456,11873680,40960,43008,49152,51200,26624,32768,34816
.long 115968,1719040,917504,11873792,768,393472,11714560,5632,8568832,8372224,11807760,11808176,268,384,11808000,8290304
.long 276480,7929856,1475328,2950656,768,15572992,268435456,147584,11873696,67584,73728,75776,81920,57344,59392,65536
.long 173312,1661696,917504,11874048,768,393600,11714560,5888,8572928,8380416,11807760,11808180,388,388,11808128,8290304
.long 292864,7929856,1475392,2950784,832,15577088,268435456,147584,11873712,98304,100352,106496,108544,83968,90112,92160
.long 3072,1831936,1146880,11873280,768,393728,11780096,5632,8273920,8126464,11807744,11808672,780,896,11808256,7929856
.long 309248,8290304,1508096,3016192,768,15695872,268435456,147712,11874176,124928,131072,133120,139264,114688,116736,122880
.long 60416,1774592,1146880,11873536,768,393856,11780096,5888,8278016,8134656,11807744,11808676,900,900,11808384,7929856
.long 325632,8290304,1508160,3016320,832,15699968,268435456,147712,11874192,155648,157696,163840,165888,141312,147456,149504
.long 117760,1717248,1146880,11873792,768,393984,11780096,5632,8634368,8486912,11807760,11808688,780,896,11808512,7929856
.long 342016,8290304,1540864,3081728,768,15704064,268435456,147840,11874208,182272,188416,190464,196608,172032,174080,180224
.long 175104,1659904,1146880,11874048,768,394112,11780096,5888,8638464,8495104,11807760,11808692,900,900,11808640,7929856
.long 358400,8290304,1540928,3081856,832,15708160,268435456,147840,11874224,212992,215040,221184,223232,198656,204800,206848
.long 1280,1833728,1376256,11877376,768,393216,11714560,7680,11091968,10895360,11811840,11812256,268,384,11811840,11173888
.long 243712,10813440,1966848,3933696,768,16613376,268435456,147456,11877760,10240,16384,18432,24576,0,2048,8192
.long 58624,1776384,1376256,11877632,768,393344,11714560,7936,11096064,10903552,11811840,11812260,388,388,11811968,11173888
.long 260096,10813440,1966912,3933824,832,16617472,268435456,147456,11877776,40960,43008,49152,51200,26624,32768,34816
.long 115968,1719040,1376256,11877888,768,393472,11714560,7680,11452416,11255808,11811856,11812272,268,384,11812096,11173888
.long 276480,10813440,1999616,3999232,768,16621568,268435456,147584,11877792,67584,73728,75776,81920,57344,59392,65536
.long 173312,1661696,1376256,11878144,768,393600,11714560,7936,11456512,11264000,11811856,11812276,388,388,11812224,11173888
.long 292864,10813440,1999680,3999360,832,16625664,268435456,147584,11877808,98304,100352,106496,108544,83968,90112,92160
.long 3072,1831936,1605632,11877376,768,393728,11780096,7680,11157504,11010048,11811840,11812768,780,896,11812352,10813440
.long 309248,11173888,2032384,4064768,768,16744448,268435456,147712,11878272,124928,131072,133120,139264,114688,116736,122880
.long 60416,1774592,1605632,11877632,768,393856,11780096,7936,11161600,11018240,11811840,11812772,900,900,11812480,10813440
.long 325632,11173888,2032448,4064896,832,16748544,268435456,147712,11878288,155648,157696,163840,165888,141312,147456,149504
.long 117760,1717248,1605632,11877888,768,393984,11780096,7680,11517952,11370496,11811856,11812784,780,896,11812608,10813440
.long 342016,11173888,2065152,4130304,768,16752640,268435456,147840,11878304,182272,188416,190464,196608,172032,174080,180224
.long 175104,1659904,1605632,11878144,768,394112,11780096,7936,11522048,11378688,11811856,11812788,900,900,11812736,10813440
.long 358400,11173888,2065216,4130432,832,16756736,268435456,147840,11878320,212992,215040,221184,223232,198656,204800,206848
.long 1536,1833472,0,11862016,896,458752,11722752,0,286720,98304,11796480,11796904,392,392,11796480,360448
.long 243712,0,896,1792,896,12697600,268435456,147456,11862464,24576,0,2048,8192,10240,16384,18432
.long 58880,1776128,0,11862272,896,458880,11722752,256,290816,106496,11796480,11796908,396,396,11796608,360448
.long 260096,0,960,1920,960,12701696,268435456,147456,11862480,51200,26624,32768,34816,40960,43008,49152
.long 116224,1718784,0,11862528,896,459008,11722752,0,647168,458752,11796496,11796920,392,392,11796736,360448
.long 276480,0,33664,67328,896,12705792,268435456,147584,11862496,81920,57344,59392,65536,67584,73728,75776
.long 173568,1661440,0,11862784,896,459136,11722752,256,651264,466944,11796496,11796924,396,396,11796864,360448
.long 292864,0,33728,67456,960,12709888,268435456,147584,11862512,108544,83968,90112,92160,98304,100352,106496
.long 3328,1831680,229376,11862016,896,459264,11788288,0,352256,212992,11796480,11797416,904,904,11796992,0
.long 309248,360448,66432,132864,896,12828672,268435456,147712,11862976,139264,114688,116736,122880,124928,131072,133120
.long 60672,1774336,229376,11862272,896,459392,11788288,256,356352,221184,11796480,11797420,908,908,11797120,0
.long 325632,360448,66496,132992,960,12832768,268435456,147712,11862992,165888,141312,147456,149504,155648,157696,163840
.long 118016,1716992,229376,11862528,896,459520,11788288,0,712704,573440,11796496,11797432,904,904,11797248,0
.long 342016,360448,99200,198400,896,12836864,268435456,147840,11863008,196608,172032,174080,180224,182272,188416,190464
.long 175360,1659648,229376,11862784,896,459648,11788288,256,716800,581632,11796496,11797436,908,908,11797376,0
.long 358400,360448,99264,198528,960,12840960,268435456,147840,11863024,223232,198656,204800,206848,212992,215040,221184
.long 1536,1833472,458752,11866112,896,458752,11722752,2048,3170304,2981888,11800576,11801000,392,392,11800576,3244032
.long 243712,2883584,525184,1050368,896,13746176,268435456,147456,11866560,24576,0,2048,8192,10240,16384,18432
.long 58880,1776128,458752,11866368,896,458880,11722752,2304,3174400,2990080,11800576,11801004,396,396,11800704,3244032
.long 260096,2883584,525248,1050496,960,13750272,268435456,147456,11866576,51200,26624,32768,34816,40960,43008,49152
.long 116224,1718784,458752,11866624,896,459008,11722752,2048,3530752,3342336,11800592,11801016,392,392,11800832,3244032
.long 276480,2883584,557952,1115904,896,13754368,268435456,147584,11866592,81920,57344,59392,65536,67584,73728,75776
.long 173568,1661440,458752,11866880,896,459136,11722752,2304,3534848,3350528,11800592,11801020,396,396,11800960,3244032
.long 292864,2883584,558016,1116032,960,13758464,268435456,147584,11866608,108544,83968,90112,92160,98304,100352,106496
.long 3328,1831680,688128,11866112,896,459264,11788288,2048,3235840,3096576,11800576,11801512,904,904,11801088,2883584
.long 309248,3244032,590720,1181440,896,13877248,268435456,147712,11867072,139264,114688,116736,122880,124928,131072,133120
.long 60672,1774336,688128,11866368,896,459392,11788288,2304,3239936,3104768,11800576,11801516,908,908,11801216,2883584
.long 325632,3244032,590784,1181568,960,13881344,268435456,147712,11867088,165888,141312,147456,149504,155648,157696,163840
.long 118016,1716992,688128,11866624,896,459520,11788288,2048,3596288,3457024,11800592,11801528,904,904,11801344,2883584
.long 342016,3244032,623488,1246976,896,13885440,268435456,147840,11867104,196608,172032,174080,180224,182272,188416,190464
.long 175360,1659648,688128,11866880,896,459648,11788288,2304,3600384,3465216,11800592,11801532,908,908,11801472,2883584
.long 358400,3244032,623552,1247104,960,13889536,268435456,147840,11867120,223232,198656,204800,206848,212992,215040,221184
.long 1536,1833472,917504,11870208,896,458752,11722752,4096,6053888,5865472,11804672,11805096,392,392,11804672,6127616
.long 243712,5767168,1049472,2098944,896,14794752,268435456,147456,11870656,24576,0,2048,8192,10240,16384,18432
.long 58880,1776128,917504,11870464,896,458880,11722752,4352,6057984,5873664,11804672,11805100,396,396,11804800,6127616
.long 260096,5767168,1049536,2099072,960,14798848,268435456,147456,11870672,51200,26624,32768,34816,40960,43008,49152
.long 116224,1718784,917504,11870720,896,459008,11722752,4096,6414336,6225920,11804688,11805112,392,392,11804928,6127616
.long 276480,5767168,1082240,2164480,896,14802944,268435456,147584,11870688,81920,57344,59392,65536,67584,73728,75776
.long 173568,1661440,917504,11870976,896,459136,11722752,4352,6418432,6234112,11804688,11805116,396,396,11805056,6127616
.long 292864,5767168,1082304,2164608,960,14807040,268435456,147584,11870704,108544,83968,90112,92160,98304,100352,106496
.long 3328,1831680,1146880,11870208,896,459264,11788288,4096,6119424,5980160,11804672,11805608,904,904,11805184,5767168
.long 309248,6127616,1115008,2230016,896,14925824,268435456,147712,11871168,139264,114688,116736,122880,124928,131072,133120
.long 60672,1774336,1146880,11870464,896,459392,11788288,4352,6123520,5988352,11804672,11805612,908,908,11805312,5767168
.long 325632,6127616,1115072,2230144,960,14929920,268435456,147712,11871184,165888,141312,147456,149504,155648,157696,163840
.long 118016,1716992,1146880,11870720,896,459520,11788288,4096,6479872,6340608,11804688,11805624,904,904,11805440,5767168
.long 342016,6127616,1147776,2295552,896,14934016,268435456,147840,11871200,196608,172032,174080,180224,182272,188416,190464
.long 175360,1659648,1146880,11870976,896,459648,11788288,4352,6483968,6348800,11804688,11805628,908,908,11805568,5767168
.long 358400,6127616,1147840,2295680,960,14938112,268435456,147840,11871216,223232,198656,204800,206848,212992,215040,221184
.long 1536,1833472,1376256,11874304,896,458752,11722752,6144,8937472,8749056,11808768,11809192,392,392,11808768,9011200
.long 243712,8650752,1573760,3147520,896,15843328,268435456,147456,11874752,24576,0,2048,8192,10240,16384,18432
.long 58880,1776128,1376256,11874560,896,458880,11722752,6400,8941568,8757248,11808768,11809196,396,396,11808896,9011200
.long 260096,8650752,1573824,3147648,960,15847424,268435456,147456,11874768,51200,26624,32768,34816,40960,43008,49152
.long 116224,1718784,1376256,11874816,896,459008,11722752,6144,9297920,9109504,11808784,11809208,392,392,11809024,9011200
.long 276480,8650752,1606528,3213056,896,15851520,268435456,147584,11874784,81920,57344,59392,65536,67584,73728,75776
.long 173568,1661440,1376256,11875072,896,459136,11722752,6400,9302016,9117696,11808784,11809212,396,396,11809152,9011200
.long 292864,8650752,1606592,3213184,960,15855616,268435456,147584,11874800,108544,83968,90112,92160,98304,100352,106496
.long 3328,1831680,1605632,11874304,896,459264,11788288,6144,9003008,8863744,11808768,11809704,904,904,11809280,8650752
.long 309248,9011200,1639296,3278592,896,15974400,268435456,147712,11875264,139264,114688,116736,122880,124928,131072,133120
.long 60672,1774336,1605632,11874560,896,459392,11788288,6400,9007104,8871936,11808768,11809708,908,908,11809408,8650752
.long 325632,9011200,1639360,3278720,960,15978496,268435456,147712,11875280,165888,141312,147456,149504,155648,157696,163840
.long 118016,1716992,1605632,11874816,896,459520,11788288,6144,9363456,9224192,11808784,11809720,904,904,11809536,8650752
.long 342016,9011200,1672064,3344128,896,15982592,268435456,147840,11875296,196608,172032,174080,180224,182272,188416,190464
.long 175360,1659648,1605632,11875072,896,459648,11788288,6400,9367552,9232384,11808784,11809724,908,908,11809664,8650752
.long 358400,9011200,1672128,3344256,960,15986688,268435456,147840,11875312,223232,198656,204800,206848,212992,215040,221184
.long 1536,1833472,0,11863040,896,458752,11722752,512,1007616,819200,11797504,11797928,392,392,11797504,1081344
.long 241664,720896,131968,263936,896,12959744,268435456,147456,11863488,0,2048,8192,10240,16384,18432,24576
.long 58880,1776128,0,11863296,896,458880,11722752,768,1011712,827392,11797504,11797932,396,396,11797632,1081344
.long 258048,720896,132032,264064,960,12963840,268435456,147456,11863504,26624,32768,34816,40960,43008,49152,51200
.long 116224,1718784,0,11863552,896,459008,11722752,512,1368064,1179648,11797520,11797944,392,392,11797760,1081344
.long 274432,720896,164736,329472,896,12967936,268435456,147584,11863520,57344,59392,65536,67584,73728,75776,81920
.long 173568,1661440,0,11863808,896,459136,11722752,768,1372160,1187840,11797520,11797948,396,396,11797888,1081344
.long 290816,720896,164800,329600,960,12972032,268435456,147584,11863536,83968,90112,92160,98304,100352,106496,108544
.long 3328,1831680,229376,11863040,896,459264,11788288,512,1073152,933888,11797504,11798440,904,904,11798016,720896
.long 307200,1081344,197504,395008,896,13090816,268435456,147712,11864000,114688,116736,122880,124928,131072,133120,139264
.long 60672,1774336,229376,11863296,896,459392,11788288,768,1077248,942080,11797504,11798444,908,908,11798144,720896
.long 323584,1081344,197568,395136,960,13094912,268435456,147712,11864016,141312,147456,149504,155648,157696,163840,165888
.long 118016,1716992,229376,11863552,896,459520,11788288,512,1433600,1294336,11797520,11798456,904,904,11798272,720896
.long 339968,1081344,230272,460544,896,13099008,268435456,147840,11864032,172032,174080,180224,182272,188416,190464,196608
.long 175360,1659648,229376,11863808,896,459648,11788288,768,1437696,1302528,11797520,11798460,908,908,11798400,720896
.long 356352,1081344,230336,460672,960,13103104,268435456,147840,11864048,198656,204800,206848,212992,215040,221184,223232
.long 1536,1833472,458752,11867136,896,458752,11722752,2560,3891200,3702784,11801600,11802024,392,392,11801600,3964928
.long 241664,3604480,656256,1312512,896,14008320,268435456,147456,11867584,0,2048,8192,10240,16384,18432,24576
.long 58880,1776128,458752,11867392,896,458880,11722752,2816,3895296,3710976,11801600,11802028,396,396,11801728,3964928
.long 258048,3604480,656320,1312640,960,14012416,268435456,147456,11867600,26624,32768,34816,40960,43008,49152,51200
.long 116224,1718784,458752,11867648,896,459008,11722752,2560,4251648,4063232,11801616,11802040,392,392,11801856,3964928
.long 274432,3604480,689024,1378048,896,14016512,268435456,147584,11867616,57344,59392,65536,67584,73728,75776,81920
.long 173568,1661440,458752,11867904,896,459136,11722752,2816,4255744,4071424,11801616,11802044,396,396,11801984,3964928
.long 290816,3604480,689088,1378176,960,14020608,268435456,147584,11867632,83968,90112,92160,98304,100352,106496,108544
.long 3328,1831680,688128,11867136,896,459264,11788288,2560,3956736,3817472,11801600,11802536,904,904,11802112,3604480
.long 307200,3964928,721792,1443584,896,14139392,268435456,147712,11868096,114688,116736,122880,124928,131072,133120,139264
.long 60672,1774336,688128,11867392,896,459392,11788288,2816,3960832,3825664,11801600,11802540,908,908,11802240,3604480
.long 323584,3964928,721856,1443712,960,14143488,268435456,147712,11868112,141312,147456,149504,155648,157696,163840,165888
.long 118016,1716992,688128,11867648,896,459520,11788288,2560,4317184,4177920,11801616,11802552,904,904,11802368,3604480
.long 339968,3964928,754560,1509120,896,14147584,268435456,147840,11868128,172032,174080,180224,182272,188416,190464,196608
.long 175360,1659648,688128,11867904,896,459648,11788288,2816,4321280,4186112,11801616,11802556,908,908,11802496,3604480
.long 356352,3964928,754624,1509248,960,14151680,268435456,147840,11868144,198656,204800,206848,212992,215040,221184,223232
.long 1536,1833472,917504,11871232,896,458752,11722752,4608,6774784,6586368,11805696,11806120,392,392,11805696,6848512
.long 241664,6488064,1180544,2361088,896,15056896,268435456,147456,11871680,0,2048,8192,10240,16384,18432,24576
.long 58880,1776128,917504,11871488,896,458880,11722752,4864,6778880,6594560,11805696,11806124,396,396,11805824,6848512
.long 258048,6488064,1180608,2361216,960,15060992,268435456,147456,11871696,26624,32768,34816,40960,43008,49152,51200
.long 116224,1718784,917504,11871744,896,459008,11722752,4608,7135232,6946816,11805712,11806136,392,392,11805952,6848512
.long 274432,6488064,1213312,2426624,896,15065088,268435456,147584,11871712,57344,59392,65536,67584,73728,75776,81920
.long 173568,1661440,917504,11872000,896,459136,11722752,4864,7139328,6955008,11805712,11806140,396,396,11806080,6848512
.long 290816,6488064,1213376,2426752,960,15069184,268435456,147584,11871728,83968,90112,92160,98304,100352,106496,108544
.long 3328,1831680,1146880,11871232,896,459264,11788288,4608,6840320,6701056,11805696,11806632,904,904,11806208,6488064
.long 307200,6848512,1246080,2492160,896,15187968,268435456,147712,11872192,114688,116736,122880,124928,131072,133120,139264
.long 60672,1774336,1146880,11871488,896,459392,11788288,4864,6844416,6709248,11805696,11806636,908,908,11806336,6488064
.long 323584,6848512,1246144,2492288,960,15192064,268435456,147712,11872208,141312,147456,149504,155648,157696,163840,165888
.long 118016,1716992,1146880,11871744,896,459520,11788288,4608,7200768,7061504,11805712,11806648,904,904,11806464,6488064
.long 339968,6848512,1278848,2557696,896,15196160,268435456,147840,11872224,172032,174080,180224,182272,188416,190464,196608
.long 175360,1659648,1146880,11872000,896,459648,11788288,4864,7204864,7069696,11805712,11806652,908,908,11806592,6488064
.long 356352,6848512,1278912,2557824,960,15200256,268435456,147840,11872240,198656,204800,206848,212992,215040,221184,223232
.long 1536,1833472,1376256,11875328,896,458752,11722752,6656,9658368,9469952,11809792,11810216,392,392,11809792,9732096
.long 241664,9371648,1704832,3409664,896,16105472,268435456,147456,11875776,0,2048,8192,10240,16384,18432,24576
.long 58880,1776128,1376256,11875584,896,458880,11722752,6912,9662464,9478144,11809792,11810220,396,396,11809920,9732096
.long 258048,9371648,1704896,3409792,960,16109568,268435456,147456,11875792,26624,32768,34816,40960,43008,49152,51200
.long 116224,1718784,1376256,11875840,896,459008,11722752,6656,10018816,9830400,11809808,11810232,392,392,11810048,9732096
.long 274432,9371648,1737600,3475200,896,16113664,268435456,147584,11875808,57344,59392,65536,67584,73728,75776,81920
.long 173568,1661440,1376256,11876096,896,459136,11722752,6912,10022912,9838592,11809808,11810236,396,396,11810176,9732096
.long 290816,9371648,1737664,3475328,960,16117760,268435456,147584,11875824,83968,90112,92160,98304,100352,106496,108544
.long 3328,1831680,1605632,11875328,896,459264,11788288,6656,9723904,9584640,11809792,11810728,904,904,11810304,9371648
.long 307200,9732096,1770368,3540736,896,16236544,268435456,147712,11876288,114688,116736,122880,124928,131072,133120,139264
.long 60672,1774336,1605632,11875584,896,459392,11788288,6912,9728000,9592832,11809792,11810732,908,908,11810432,9371648
.long 323584,9732096,1770432,3540864,960,16240640,268435456,147712,11876304,141312,147456,149504,155648,157696,163840,165888
.long 118016,1716992,1605632,11875840,896,459520,11788288,6656,10084352,9945088,11809808,11810744,904,904,11810560,9371648
.long 339968,9732096,1803136,3606272,896,16244736,268435456,147840,11876320,172032,174080,180224,182272,188416,190464,196608
.long 175360,1659648,1605632,11876096,896,459648,11788288,6912,10088448,9953280,11809808,11810748,908,908,11810688,9371648
.long 356352,9732096,1803200,3606400,960,16248832,268435456,147840,11876336,198656,204800,206848,212992,215040,221184,223232
.long 1536,1833472,0,11864064,896,458752,11722752,1024,1728512,1540096,11798528,11798952,392,392,11798528,1802240
.long 243712,1441792,263040,526080,896,13221888,268435456,147456,11864512,8192,10240,16384,18432,24576,0,2048
.long 58880,1776128,0,11864320,896,458880,11722752,1280,1732608,1548288,11798528,11798956,396,396,11798656,1802240
.long 260096,1441792,263104,526208,960,13225984,268435456,147456,11864528,34816,40960,43008,49152,51200,26624,32768
.long 116224,1718784,0,11864576,896,459008,11722752,1024,2088960,1900544,11798544,11798968,392,392,11798784,1802240
.long 276480,1441792,295808,591616,896,13230080,268435456,147584,11864544,65536,67584,73728,75776,81920,57344,59392
.long 173568,1661440,0,11864832,896,459136,11722752,1280,2093056,1908736,11798544,11798972,396,396,11798912,1802240
.long 292864,1441792,295872,591744,960,13234176,268435456,147584,11864560,92160,98304,100352,106496,108544,83968,90112
.long 3328,1831680,229376,11864064,896,459264,11788288,1024,1794048,1654784,11798528,11799464,904,904,11799040,1441792
.long 309248,1802240,328576,657152,896,13352960,268435456,147712,11865024,122880,124928,131072,133120,139264,114688,116736
.long 60672,1774336,229376,11864320,896,459392,11788288,1280,1798144,1662976,11798528,11799468,908,908,11799168,1441792
.long 325632,1802240,328640,657280,960,13357056,268435456,147712,11865040,149504,155648,157696,163840,165888,141312,147456
.long 118016,1716992,229376,11864576,896,459520,11788288,1024,2154496,2015232,11798544,11799480,904,904,11799296,1441792
.long 342016,1802240,361344,722688,896,13361152,268435456,147840,11865056,180224,182272,188416,190464,196608,172032,174080
.long 175360,1659648,229376,11864832,896,459648,11788288,1280,2158592,2023424,11798544,11799484,908,908,11799424,1441792
.long 358400,1802240,361408,722816,960,13365248,268435456,147840,11865072,206848,212992,215040,221184,223232,198656,204800
.long 1536,1833472,458752,11868160,896,458752,11722752,3072,4612096,4423680,11802624,11803048,392,392,11802624,4685824
.long 243712,4325376,787328,1574656,896,14270464,268435456,147456,11868608,8192,10240,16384,18432,24576,0,2048
.long 58880,1776128,458752,11868416,896,458880,11722752,3328,4616192,4431872,11802624,11803052,396,396,11802752,4685824
.long 260096,4325376,787392,1574784,960,14274560,268435456,147456,11868624,34816,40960,43008,49152,51200,26624,32768
.long 116224,1718784,458752,11868672,896,459008,11722752,3072,4972544,4784128,11802640,11803064,392,392,11802880,4685824
.long 276480,4325376,820096,1640192,896,14278656,268435456,147584,11868640,65536,67584,73728,75776,81920,57344,59392
.long 173568,1661440,458752,11868928,896,459136,11722752,3328,4976640,4792320,11802640,11803068,396,396,11803008,4685824
.long 292864,4325376,820160,1640320,960,14282752,268435456,147584,11868656,92160,98304,100352,106496,108544,83968,90112
.long 3328,1831680,688128,11868160,896,459264,11788288,3072,4677632,4538368,11802624,11803560,904,904,11803136,4325376
.long 309248,4685824,852864,1705728,896,14401536,268435456,147712,11869120,122880,124928,131072,133120,139264,114688,116736
.long 60672,1774336,688128,11868416,896,459392,11788288,3328,4681728,4546560,11802624,11803564,908,908,11803264,4325376
.long 325632,4685824,852928,1705856,960,14405632,268435456,147712,11869136,149504,155648,157696,163840,165888,141312,147456
.long 118016,1716992,688128,11868672,896,459520,11788288,3072,5038080,4898816,11802640,11803576,904,904,11803392,4325376
.long 342016,4685824,885632,1771264,896,14409728,268435456,147840,11869152,180224,182272,188416,190464,196608,172032,174080
.long 175360,1659648,688128,11868928,896,459648,11788288,3328,5042176,4907008,11802640,11803580,908,908,11803520,4325376
.long 358400,4685824,885696,1771392,960,14413824,268435456,147840,11869168,206848,212992,215040,221184,223232,198656,204800
.long 1536,1833472,917504,11872256,896,458752,11722752,5120,7495680,7307264,11806720,11807144,392,392,11806720,7569408
.long 243712,7208960,1311616,2623232,896,15319040,268435456,147456,11872704,8192,10240,16384,18432,24576,0,2048
.long 58880,1776128,917504,11872512,896,458880,11722752,5376,7499776,7315456,11806720,11807148,396,396,11806848,7569408
.long 260096,7208960,1311680,2623360,960,15323136,268435456,147456,11872720,34816,40960,43008,49152,51200,26624,32768
.long 116224,1718784,917504,11872768,896,459008,11722752,5120,7856128,7667712,11806736,11807160,392,392,11806976,7569408
.long 276480,7208960,1344384,2688768,896,15327232,268435456,147584,11872736,65536,67584,73728,75776,81920,57344,59392
.long 173568,1661440,917504,11873024,896,459136,11722752,5376,7860224,7675904,11806736,11807164,396,396,11807104,7569408
.long 292864,7208960,1344448,2688896,960,15331328,268435456,147584,11872752,92160,98304,100352,106496,108544,83968,90112
.long 3328,1831680,1146880,11872256,896,459264,11788288,5120,7561216,7421952,11806720,11807656,904,904,11807232,7208960
.long 309248,7569408,1377152,2754304,896,15450112,268435456,147712,11873216,122880,124928,131072,133120,139264,114688,116736
.long 60672,1774336,1146880,11872512,896,459392,11788288,5376,7565312,7430144,11806720,11807660,908,908,11807360,7208960
.long 325632,7569408,1377216,2754432,960,15454208,268435456,147712,11873232,149504,155648,157696,163840,165888,141312,147456
.long 118016,1716992,1146880,11872768,896,459520,11788288,5120,7921664,7782400,11806736,11807672,904,904,11807488,7208960
.long 342016,7569408,1409920,2819840,896,15458304,268435456,147840,11873248,180224,182272,188416,190464,196608,172032,174080
.long 175360,1659648,1146880,11873024,896,459648,11788288,5376,7925760,7790592,11806736,11807676,908,908,11807616,7208960
.long 358400,7569408,1409984,2819968,960,15462400,268435456,147840,11873264,206848,212992,215040,221184,223232,198656,204800
.long 1536,1833472,1376256,11876352,896,458752,11722752,7168,10379264,10190848,11810816,11811240,392,392,11810816,10452992
.long 243712,10092544,1835904,3671808,896,16367616,268435456,147456,11876800,8192,10240,16384,18432,24576,0,2048
.long 58880,1776128,1376256,11876608,896,458880,11722752,7424,10383360,10199040,11810816,11811244,396,396,11810944,10452992
.long 260096,10092544,1835968,3671936,960,16371712,268435456,147456,11876816,34816,40960,43008,49152,51200,26624,32768
.long 116224,1718784,1376256,11876864,896,459008,11722752,7168,10739712,10551296,11810832,11811256,392,392,11811072,10452992
.long 276480,10092544,1868672,3737344,896,16375808,268435456,147584,11876832,65536,67584,73728,75776,81920,57344,59392
.long 173568,1661440,1376256,11877120,896,459136,11722752,7424,10743808,10559488,11810832,11811260,396,396,11811200,10452992
.long 292864,10092544,1868736,3737472,960,16379904,268435456,147584,11876848,92160,98304,100352,106496,108544,83968,90112
.long 3328,1831680,1605632,11876352,896,459264,11788288,7168,10444800,10305536,11810816,11811752,904,904,11811328,10092544
.long 309248,10452992,1901440,3802880,896,16498688,268435456,147712,11877312,122880,124928,131072,133120,139264,114688,116736
.long 60672,1774336,1605632,11876608,896,459392,11788288,7424,10448896,10313728,11810816,11811756,908,908,11811456,10092544
.long 325632,10452992,1901504,3803008,960,16502784,268435456,147712,11877328,149504,155648,157696,163840,165888,141312,147456
.long 118016,1716992,1605632,11876864,896,459520,11788288,7168,10805248,10665984,11810832,11811768,904,904,11811584,10092544
.long 342016,10452992,1934208,3868416,896,16506880,268435456,147840,11877344,180224,182272,188416,190464,196608,172032,174080
.long 175360,1659648,1605632,11877120,896,459648,11788288,7424,10809344,10674176,11810832,11811772,908,908,11811712,10092544
.long 358400,10452992,1934272,3868544,960,16510976,268435456,147840,11877360,206848,212992,215040,221184,223232,198656,204800
.long 1536,1833472,0,11865088,896,458752,11722752,1536,2449408,2260992,11799552,11799976,392,392,11799552,2523136
.long 241664,2162688,394112,788224,896,13484032,268435456,147456,11865536,16384,18432,24576,0,2048,8192,10240
.long 58880,1776128,0,11865344,896,458880,11722752,1792,2453504,2269184,11799552,11799980,396,396,11799680,2523136
.long 258048,2162688,394176,788352,960,13488128,268435456,147456,11865552,43008,49152,51200,26624,32768,34816,40960
.long 116224,1718784,0,11865600,896,459008,11722752,1536,2809856,2621440,11799568,11799992,392,392,11799808,2523136
.long 274432,2162688,426880,853760,896,13492224,268435456,147584,11865568,73728,75776,81920,57344,59392,65536,67584
.long 173568,1661440,0,11865856,896,459136,11722752,1792,2813952,2629632,11799568,11799996,396,396,11799936,2523136
.long 290816,2162688,426944,853888,960,13496320,268435456,147584,11865584,100352,106496,108544,83968,90112,92160,98304
.long 3328,1831680,229376,11865088,896,459264,11788288,1536,2514944,2375680,11799552,11800488,904,904,11800064,2162688
.long 307200,2523136,459648,919296,896,13615104,268435456,147712,11866048,131072,133120,139264,114688,116736,122880,124928
.long 60672,1774336,229376,11865344,896,459392,11788288,1792,2519040,2383872,11799552,11800492,908,908,11800192,2162688
.long 323584,2523136,459712,919424,960,13619200,268435456,147712,11866064,157696,163840,165888,141312,147456,149504,155648
.long 118016,1716992,229376,11865600,896,459520,11788288,1536,2875392,2736128,11799568,11800504,904,904,11800320,2162688
.long 339968,2523136,492416,984832,896,13623296,268435456,147840,11866080,188416,190464,196608,172032,174080,180224,182272
.long 175360,1659648,229376,11865856,896,459648,11788288,1792,2879488,2744320,11799568,11800508,908,908,11800448,2162688
.long 356352,2523136,492480,984960,960,13627392,268435456,147840,11866096,215040,221184,223232,198656,204800,206848,212992
.long 1536,1833472,458752,11869184,896,458752,11722752,3584,5332992,5144576,11803648,11804072,392,392,11803648,5406720
.long 241664,5046272,918400,1836800,896,14532608,268435456,147456,11869632,16384,18432,24576,0,2048,8192,10240
.long 58880,1776128,458752,11869440,896,458880,11722752,3840,5337088,5152768,11803648,11804076,396,396,11803776,5406720
.long 258048,5046272,918464,1836928,960,14536704,268435456,147456,11869648,43008,49152,51200,26624,32768,34816,40960
.long 116224,1718784,458752,11869696,896,459008,11722752,3584,5693440,5505024,11803664,11804088,392,392,11803904,5406720
.long 274432,5046272,951168,1902336,896,14540800,268435456,147584,11869664,73728,75776,81920,57344,59392,65536,67584
.long 173568,1661440,458752,11869952,896,459136,11722752,3840,5697536,5513216,11803664,11804092,396,396,11804032,5406720
.long 290816,5046272,951232,1902464,960,14544896,268435456,147584,11869680,100352,106496,108544,83968,90112,92160,98304
.long 3328,1831680,688128,11869184,896,459264,11788288,3584,5398528,5259264,11803648,11804584,904,904,11804160,5046272
.long 307200,5406720,983936,1967872,896,14663680,268435456,147712,11870144,131072,133120,139264,114688,116736,122880,124928
.long 60672,1774336,688128,11869440,896,459392,11788288,3840,5402624,5267456,11803648,11804588,908,908,11804288,5046272
.long 323584,5406720,984000,1968000,960,14667776,268435456,147712,11870160,157696,163840,165888,141312,147456,149504,155648
.long 118016,1716992,688128,11869696,896,459520,11788288,3584,5758976,5619712,11803664,11804600,904,904,11804416,5046272
.long 339968,5406720,1016704,2033408,896,14671872,268435456,147840,11870176,188416,190464,196608,172032,174080,180224,182272
.long 175360,1659648,688128,11869952,896,459648,11788288,3840,5763072,5627904,11803664,11804604,908,908,11804544,5046272
.long 356352,5406720,1016768,2033536,960,14675968,268435456,147840,11870192,215040,221184,223232,198656,204800,206848,212992
.long 1536,1833472,917504,11873280,896,458752,11722752,5632,8216576,8028160,11807744,11808168,392,392,11807744,8290304
.long 241664,7929856,1442688,2885376,896,15581184,268435456,147456,11873728,16384,18432,24576,0,2048,8192,10240
.long 58880,1776128,917504,11873536,896,458880,11722752,5888,8220672,8036352,11807744,11808172,396,396,11807872,8290304
.long 258048,7929856,1442752,2885504,960,15585280,268435456,147456,11873744,43008,49152,51200,26624,32768,34816,40960
.long 116224,1718784,917504,11873792,896,459008,11722752,5632,8577024,8388608,11807760,11808184,392,392,11808000,8290304
.long 274432,7929856,1475456,2950912,896,15589376,268435456,147584,11873760,73728,75776,81920,57344,59392,65536,67584
.long 173568,1661440,917504,11874048,896,459136,11722752,5888,8581120,8396800,11807760,11808188,396,396,11808128,8290304
.long 290816,7929856,1475520,2951040,960,15593472,268435456,147584,11873776,100352,106496,108544,83968,90112,92160,98304
.long 3328,1831680,1146880,11873280,896,459264,11788288,5632,8282112,8142848,11807744,11808680,904,904,11808256,7929856
.long 307200,8290304,1508224,3016448,896,15712256,268435456,147712,11874240,131072,133120,139264,114688,116736,122880,124928
.long 60672,1774336,1146880,11873536,896,459392,11788288,5888,8286208,8151040,11807744,11808684,908,908,11808384,7929856
.long 323584,8290304,1508288,3016576,960,15716352,268435456,147712,11874256,157696,163840,165888,141312,147456,149504,155648
.long 118016,1716992,1146880,11873792,896,459520,11788288,5632,8642560,8503296,11807760,11808696,904,904,11808512,7929856
.long 339968,8290304,1540992,3081984,896,15720448,268435456,147840,11874272,188416,190464,196608,172032,174080,180224,182272
.long 175360,1659648,1146880,11874048,896,459648,11788288,5888,8646656,8511488,11807760,11808700,908,908,11808640,7929856
.long 356352,8290304,1541056,3082112,960,15724544,268435456,147840,11874288,215040,221184,223232,198656,204800,206848,212992
.long 1536,1833472,1376256,11877376,896,458752,11722752,7680,11100160,10911744,11811840,11812264,392,392,11811840,11173888
.long 241664,10813440,1966976,3933952,896,16629760,268435456,147456,11877824,16384,18432,24576,0,2048,8192,10240
.long 58880,1776128,1376256,11877632,896,458880,11722752,7936,11104256,10919936,11811840,11812268,396,396,11811968,11173888
.long 258048,10813440,1967040,3934080,960,16633856,268435456,147456,11877840,43008,49152,51200,26624,32768,34816,40960
.long 116224,1718784,1376256,11877888,896,459008,11722752,7680,11460608,11272192,11811856,11812280,392,392,11812096,11173888
.long 274432,10813440,1999744,3999488,896,16637952,268435456,147584,11877856,73728,75776,81920,57344,59392,65536,67584
.long 173568,1661440,1376256,11878144,896,459136,11722752,7936,11464704,11280384,11811856,11812284,396,396,11812224,11173888
.long 290816,10813440,1999808,3999616,960,16642048,268435456,147584,11877872,100352,106496,108544,83968,90112,92160,98304
.long 3328,1831680,1605632,11877376,896,459264,11788288,7680,11165696,11026432,11811840,11812776,904,904,11812352,10813440
.long 307200,11173888,2032512,4065024,896,16760832,268435456,147712,11878336,131072,133120,139264,114688,116736,122880,124928
.long 60672,1774336,1605632,11877632,896,459392,11788288,7936,11169792,11034624,11811840,11812780,908,908,11812480,10813440
.long 323584,11173888,2032576,4065152,960,16764928,268435456,147712,11878352,157696,163840,165888,141312,147456,149504,155648
.long 118016,1716992,1605632,11877888,896,459520,11788288,7680,11526144,11386880,11811856,11812792,904,904,11812608,10813440
.long 339968,11173888,2065280,4130560,896,16769024,268435456,147840,11878368,188416,190464,196608,172032,174080,180224,182272
.long 175360,1659648,1605632,11878144,896,459648,11788288,7936,11530240,11395072,11811856,11812796,908,908,11812736,10813440
.long 356352,11173888,2065344,4130688,960,16773120,268435456,147840,11878384,215040,221184,223232,198656,204800,206848,212992
```
